```python
import torch

def _softmax(x, axis=-1):
    return torch.softmax(x, dim=axis)
def _gelu(x):
    return torch.nn.functional.gelu(x, approximate="tanh")
def _silu(x):
    return torch.nn.functional.silu(x)
def _sigmoid(x):
    return torch.sigmoid(x)
def _layernorm(x, axis=-1, eps=1e-5):
    m = x.mean(dim=axis, keepdim=True)
    v = x.var(dim=axis, keepdim=True, unbiased=False)
    return (x - m) / torch.sqrt(v + eps)
def _scatter_add(tgt, idx, src, axis=0):
    return tgt.clone().index_add_(axis, idx, src)
def _segment_sum(src, seg, n):
    out = torch.zeros((n,) + src.shape[1:], dtype=src.dtype)
    return out.index_add_(0, seg, src)
def _pad(x, pw):
    flat = tuple(v for pair in reversed(pw) for v in pair)
    return torch.nn.functional.pad(x, flat)

kernel_name = 'recurrent_scan__sliding_block_cached__glu_gated_glu__prompt'

def setup_inputs():

    _w = (lambda a: (lambda t: t.to(torch.bfloat16) if t.is_floating_point() else t)(torch.as_tensor(a)))
    def _A_setup():
        B, Sq, D = 1, 2048, 512
        Hq, Hkv, Sk, Dh = 32, 32, 2048, 128
        assert Hq % Hkv == 0, (Hq, Hkv)
        return {
            "x": _w((lambda *s: torch.randn(*s, dtype=torch.bfloat16) * 0.05)(B, Sq, D)),
            "k_cache": _w((lambda *s: torch.randn(*s, dtype=torch.bfloat16) * 0.8)(B, Hkv, Sk, Dh)),
            "v_cache": _w((lambda *s: torch.randn(*s, dtype=torch.bfloat16) * 0.2)(B, Hkv, Sk, Dh)),
            "wq": _w((lambda *s: torch.randn(*s, dtype=torch.bfloat16) * 0.8)(D, Hq * Dh) * (D ** -0.5)),
            "wo": _w((lambda *s: torch.randn(*s, dtype=torch.bfloat16) * 0.2)(Hq * Dh, D) * ((Hq * Dh) ** -0.5)),
        }
    _A_in = _A_setup()

    def _B_setup():
        B, S, D, F = 1, 2048, 512, 1376
        return {
            "x": _w((lambda *s: torch.randn(*s, dtype=torch.bfloat16) * 0.05)(B, S, D)),
            "w_gate": _w((lambda *s: torch.randn(*s, dtype=torch.bfloat16) * 0.2)(D, F)),
            "w_up": _w((lambda *s: torch.randn(*s, dtype=torch.bfloat16) * 0.1)(D, F)),
            "w_down": _w((lambda *s: torch.randn(*s, dtype=torch.bfloat16) * 0.1)(F, D)),
        }
    _B_in = _B_setup()

    return {
        "A_x": _A_in["x"],
        "A_k_cache": _A_in["k_cache"],
        "A_v_cache": _A_in["v_cache"],
        "A_wq": _A_in["wq"],
        "A_wo": _A_in["wo"],
        "B_x": _B_in["x"],
        "B_w_gate": _B_in["w_gate"],
        "B_w_up": _B_in["w_up"],
        "B_w_down": _B_in["w_down"],
    }

def reference(A_x, A_k_cache, A_v_cache, A_wq, A_wo, B_x, B_w_gate, B_w_up, B_w_down):
    def _A_ref(x, k_cache, v_cache, wq, wo):
        B, Sq, D = x.shape
        Hq, Dh = 32, 128
        Hkv, Sk = k_cache.shape[1], k_cache.shape[2]
        W = min(4096, max(256, Sk // 4))
        rep = Hq // Hkv
        q = (lambda x, *d: x.permute(*d))((x @ wq).reshape(B, Sq, Hq, Dh), 0, 2, 1, 3)
        k = (lambda x, n, axis: torch.repeat_interleave(x, n, dim=axis))(k_cache[:, :, Sk - W:, :], rep, axis=1)
        v = (lambda x, n, axis: torch.repeat_interleave(x, n, dim=axis))(v_cache[:, :, Sk - W:, :], rep, axis=1)
        scores = torch.einsum("bhqd,bhkd->bhqk", q, k) * (Dh ** -0.5)
        p = _softmax(scores, axis=-1)
        o = torch.einsum("bhqk,bhkd->bhqd", p, v)
        return (lambda x, *d: x.permute(*d))(o, 0, 2, 1, 3).reshape(B, Sq, Hq * Dh) @ wo

    def _B_ref(x, w_gate, w_up, w_down):
        g = torch.einsum("bsd,df->bsf", x, w_gate)
        u = torch.einsum("bsd,df->bsf", x, w_up)
        h = _sigmoid(g) * u
        return torch.einsum("bsf,fd->bsd", h, w_down)

    x = A_x
    xn = _layernorm(x, axis=-1)
    s = _A_ref(xn, A_k_cache, A_v_cache, A_wq, A_wo)
    g = _silu(_B_ref(xn, B_w_gate, B_w_up, B_w_down))
    return x + s * g
```

```asm
; @launch grid=(256,1,1) block=(256,1,1) lds=163840
.amdgcn_target "amdgcn-amd-amdhsa--gfx950"
.text
.globl recurrent_scan__sliding_block_cached__glu_gated_glu__prompt_kernel
.p2align 8
.type recurrent_scan__sliding_block_cached__glu_gated_glu__prompt_kernel,@function
recurrent_scan__sliding_block_cached__glu_gated_glu__prompt_kernel:
    s_cmp_ge_u32 s2, 256
    s_cbranch_scc1 K1_END
    s_load_dwordx4 s[64:67], s[0:1], 0
    s_load_dwordx4 s[68:71], s[0:1], 16
    s_load_dwordx4 s[72:75], s[0:1], 48
    s_load_dwordx2 s[76:77], s[0:1], 88
    v_lshrrev_b32 v1, 6, v0
    v_and_b32 v0, 63, v0
    s_and_b32 s3, s2, 7
    s_lshr_b32 s4, s2, 3
    v_readfirstlane_b32 s32, v1
    s_and_b32 s5, s4, 3
    s_lshl_b32 s3, s3, 2
    s_add_u32 s33, s3, s5
    s_lshr_b32 s34, s4, 2
    s_add_u32 s97, s5, s34
    s_and_b32 s97, s97, 1
    s_lshl_b32 s97, s97, 2
    s_mov_b32 s44, 0xffff0000
    v_lshrrev_b32 v2, 4, v0
    v_and_b32 v3, 15, v0
    v_lshlrev_b32 v29, 2, v2
    v_xor_b32 v29, v29, v3
    v_lshlrev_b32 v29, 4, v29
    v_lshl_add_u32 v20, v2, 8, v29
    v_lshl_add_u32 v104, v2, 13, v29
    v_add_u32 v105, 31744, v104
    v_add_u32 v106, 63488, v104
    v_add_u32 v107, 95232, v104
    s_mov_b32 s5, 43691
    s_mov_b32 s6, 2656
    v_add_u32 v29, 0, v0
    v_mul_u32_u24 v30, s5, v29
    v_lshrrev_b32 v30, 18, v30
    v_mul_u32_u24 v30, s6, v30
    v_lshl_add_u32 v29, v29, 4, v30
    v_subrev_u32 v108, 0, v29
    v_add_u32 v29, 64, v0
    v_mul_u32_u24 v30, s5, v29
    v_lshrrev_b32 v30, 18, v30
    v_mul_u32_u24 v30, s6, v30
    v_lshl_add_u32 v29, v29, 4, v30
    v_subrev_u32 v109, 1024, v29
    v_add_u32 v29, 128, v0
    v_mul_u32_u24 v30, s5, v29
    v_lshrrev_b32 v30, 18, v30
    v_mul_u32_u24 v30, s6, v30
    v_lshl_add_u32 v29, v29, 4, v30
    v_subrev_u32 v110, 2048, v29
    v_lshrrev_b32 v1, 3, v0
    v_lshlrev_b32 v1, 10, v1
    v_and_b32 v3, 7, v0
    v_xor_b32 v29, v3, v2
    v_xor_b32 v30, 4, v29
    v_lshl_add_u32 v29, v29, 4, v1
    v_lshl_add_u32 v30, v30, 4, v1
    v_add_u32 v96, 0, v29
    v_add_u32 v97, 7168, v30
    v_add_u32 v98, 14336, v29
    v_add_u32 v99, 21504, v30
    v_add_u32 v100, 32768, v29
    v_add_u32 v101, 39936, v30
    v_add_u32 v102, 47104, v29
    v_add_u32 v103, 54272, v30
    s_lshl_b32 s42, s32, 12
    s_lshl_b32 s62, s34, 18
    s_lshl_b32 s3, s32, 16
    s_add_u32 s62, s62, s3
    s_lshl_b32 s63, s32, 17
    s_lshl_b32 s3, s33, 8
    s_add_u32 s63, s63, s3
    s_and_b32 s3, s32, 1
    s_mul_i32 s96, s3, 88064
    s_mul_i32 s4, s33, 96
    s_add_u32 s96, s96, s4
    s_mul_i32 s41, s3, 3072
    s_lshr_b32 s3, s32, 1
    s_mul_i32 s3, s3, 6272
    s_add_u32 s41, s41, s3
    s_add_u32 s41, s41, 16384
    s_lshl_b32 s39, s32, 13
    s_mov_b32 s45, 65536
    s_lshl_b32 s47, s97, 7
    s_add_u32 s35, s62, s47
    s_lshl_b32 s47, s97, 19
    s_add_u32 s36, s63, s47
    s_mul_i32 s47, s97, 176128
    s_add_u32 s37, s96, s47
    s_add_u32 s97, s97, 1
    s_and_b32 s97, s97, 7
    s_add_u32 s98, s45, s41
    s_waitcnt lgkmcnt(0)
    s_mov_b32 s12, s70
    s_mov_b32 s13, s71
    s_mov_b32 s14, 4194304
    s_mov_b32 s15, 0x00020000
    s_cmp_lt_u32 s32, 2
    s_cselect_b32 s16, s72, s74
    s_cselect_b32 s17, s73, s75
    s_mov_b32 s18, 1409024
    s_mov_b32 s19, 0x00020000
    s_mov_b32 s8, s64
    s_mov_b32 s9, s65
    s_mov_b32 s10, 2097152
    s_mov_b32 s11, 0x00020000
    s_add_u32 m0, s45, s42
    s_nop 0
    buffer_load_dwordx4 v104, s[12:15], s36 offen lds
    buffer_load_dwordx4 v105, s[12:15], s36 offen offset:1024 lds
    buffer_load_dwordx4 v106, s[12:15], s36 offen offset:2048 lds
    buffer_load_dwordx4 v107, s[12:15], s36 offen offset:3072 lds
    s_mov_b32 m0, s98
    s_nop 0
    buffer_load_dwordx4 v108, s[16:19], s37 offen lds
    s_mov_b32 s20, s66
    s_mov_b32 s21, s67
    s_mov_b32 s22, 16777216
    s_mov_b32 s23, 0x00020000
    s_mov_b32 s24, s68
    s_mov_b32 s25, s69
    s_mov_b32 s26, 16777216
    s_mov_b32 s27, 0x00020000
    s_mov_b32 s28, s76
    s_mov_b32 s29, s77
    s_mov_b32 s30, 41943040
    s_mov_b32 s31, 0x00020000
    s_lshl_b32 s43, s33, 19
    s_add_u32 s43, s43, 393216
    s_add_u32 s43, s43, s42
    buffer_load_dwordx4 v109, s[16:19], s37 offen offset:1024 lds
    s_mov_b32 s57, 0
    s_load_dwordx2 s[66:67], s[0:1], 32
    s_load_dwordx4 s[68:71], s[0:1], 64
    s_load_dwordx2 s[72:73], s[0:1], 80
    s_bfe_u32 s51, s2, 0x20001
    s_and_b32 s3, s2, 1
    s_lshl_b32 s59, s34, 1
    s_add_u32 s3, s3, s59
    s_and_b32 s52, s33, 3
    s_lshl_b32 s59, s3, 2
    s_add_u32 s3, s59, s52
    s_add_u32 s59, s59, s32
    s_mul_i32 s53, s3, 196608
    s_mul_i32 s54, s32, 12288
    s_add_u32 s53, s53, s54
    s_add_u32 s53, s53, 25165824
    s_lshl_b32 s54, s3, 11
    s_lshl_b32 s3, s32, 7
    s_add_u32 s54, s54, s3
    s_add_u32 s54, s54, 38797312
    s_lshl_b32 s55, s34, 12
    s_add_u32 s55, s55, 39321600
    s_lshl_b32 s58, s34, 3
    s_lshl_b32 s3, s32, 1
    s_add_u32 s58, s58, s3
    s_mul_i32 s56, s58, 88064
    s_mul_i32 s3, s33, 3072
    s_add_u32 s56, s56, s3
    s_add_u32 s56, s56, 17825792
    s_lshl_b32 s78, s59, 15
    s_lshl_b32 s3, s52, 8
    s_add_u32 s78, s78, s3
    s_lshl_b32 s3, s51, 6
    s_add_u32 s78, s78, s3
    v_mov_b32 v56, 0
    buffer_load_dwordx4 v110, s[16:19], s37 offen offset:2048 lds
    v_mov_b32 v57, 0
    v_mov_b32 v58, 0
    v_mov_b32 v59, 0
    v_and_b32 v3, 15, v0
    v_xor_b32 v29, v3, v2
    v_xor_b32 v29, 0, v29
    s_mov_b32 m0, s39
    s_nop 0
    buffer_load_dwordx4 v96, s[8:11], s35 offen lds
    v_lshlrev_b32 v29, 4, v29
    v_lshl_add_u32 v16, v2, 8, v29
    v_xor_b32 v29, v3, v2
    v_xor_b32 v29, 4, v29
    v_lshlrev_b32 v29, 4, v29
    v_lshl_add_u32 v17, v2, 8, v29
    buffer_load_dwordx4 v97, s[8:11], s35 offen offset:1024 lds
    v_xor_b32 v29, v3, v2
    v_xor_b32 v29, 8, v29
    v_lshlrev_b32 v29, 4, v29
    v_lshl_add_u32 v18, v2, 8, v29
    v_xor_b32 v29, v3, v2
    v_xor_b32 v29, 12, v29
    buffer_load_dwordx4 v98, s[8:11], s35 offen offset:2048 lds
    v_lshlrev_b32 v29, 4, v29
    v_lshl_add_u32 v19, v2, 8, v29
    v_mfma_f32_32x32x16_bf16 v[128:143], v[56:59], v[56:59], 0
    v_mfma_f32_32x32x16_bf16 v[144:159], v[56:59], v[56:59], 0
    v_mfma_f32_32x32x16_bf16 v[160:175], v[56:59], v[56:59], 0
    v_mfma_f32_32x32x16_bf16 v[176:191], v[56:59], v[56:59], 0
    buffer_load_dwordx4 v99, s[8:11], s35 offen offset:3072 lds
    v_mfma_f32_32x32x16_bf16 v[192:207], v[56:59], v[56:59], 0
    v_mfma_f32_32x32x16_bf16 v[208:223], v[56:59], v[56:59], 0
    v_mfma_f32_32x32x16_bf16 v[224:239], v[56:59], v[56:59], 0
    v_mfma_f32_32x32x16_bf16 v[240:255], v[56:59], v[56:59], 0
    v_mfma_f32_32x32x16_bf16 a[0:15], v[56:59], v[56:59], 0
    v_mfma_f32_32x32x16_bf16 a[16:31], v[56:59], v[56:59], 0
    s_add_u32 m0, s39, 4096
    s_nop 0
    buffer_load_dwordx4 v100, s[8:11], s35 offen lds
    v_mfma_f32_32x32x16_bf16 a[32:47], v[56:59], v[56:59], 0
    v_mfma_f32_32x32x16_bf16 a[48:63], v[56:59], v[56:59], 0
    v_mfma_f32_32x32x16_bf16 a[64:79], v[56:59], v[56:59], 0
    v_mfma_f32_32x32x16_bf16 a[80:95], v[56:59], v[56:59], 0
    v_mfma_f32_32x32x16_bf16 a[224:239], v[56:59], v[56:59], 0
    v_mfma_f32_32x32x16_bf16 a[240:255], v[56:59], v[56:59], 0
    buffer_load_dwordx4 v101, s[8:11], s35 offen offset:1024 lds
    v_and_b32 v1, 31, v0
    v_lshrrev_b32 v31, 5, v0
    v_bfe_u32 v30, v0, 1, 3
    v_xor_b32 v30, v30, v31
    v_lshlrev_b32 v29, 7, v1
    s_lshl_b32 s3, s32, 13
    buffer_load_dwordx4 v102, s[8:11], s35 offen offset:2048 lds
    v_add_u32 v29, s3, v29
    v_xor_b32 v32, 0, v30
    v_lshl_add_u32 v32, v32, 4, v29
    v_xor_b32 v33, 2, v30
    v_lshl_add_u32 v33, v33, 4, v29
    v_xor_b32 v34, 4, v30
    buffer_load_dwordx4 v103, s[8:11], s35 offen offset:3072 lds
    v_lshl_add_u32 v34, v34, 4, v29
    v_xor_b32 v35, 6, v30
    v_lshl_add_u32 v35, v35, 4, v29
    v_xor_b32 v30, v3, v31
    v_lshlrev_b32 v29, 8, v1
    v_add_u32 v29, 131072, v29
    s_add_u32 s45, s45, 32768
    s_xor_b32 s39, s39, 32768
    s_lshl_b32 s47, s97, 7
    s_add_u32 s35, s62, s47
    s_lshl_b32 s47, s97, 19
    s_add_u32 s36, s63, s47
    s_mul_i32 s47, s97, 176128
    s_add_u32 s37, s96, s47
    s_add_u32 s97, s97, 1
    s_and_b32 s97, s97, 7
    s_add_u32 s98, s45, s41
    s_add_u32 m0, s45, s42
    s_nop 0
    buffer_load_dwordx4 v104, s[12:15], s36 offen lds
    v_xor_b32 v4, 0, v30
    v_lshl_add_u32 v4, v4, 4, v29
    v_xor_b32 v5, 2, v30
    v_lshl_add_u32 v5, v5, 4, v29
    v_xor_b32 v6, 4, v30
    v_lshl_add_u32 v6, v6, 4, v29
    buffer_load_dwordx4 v105, s[12:15], s36 offen offset:1024 lds
    v_xor_b32 v7, 6, v30
    v_lshl_add_u32 v7, v7, 4, v29
    v_xor_b32 v8, 8, v30
    v_lshl_add_u32 v8, v8, 4, v29
    v_xor_b32 v9, 10, v30
    v_lshl_add_u32 v9, v9, 4, v29
    buffer_load_dwordx4 v106, s[12:15], s36 offen offset:2048 lds
    v_xor_b32 v10, 12, v30
    v_lshl_add_u32 v10, v10, 4, v29
    v_xor_b32 v11, 14, v30
    v_lshl_add_u32 v11, v11, 4, v29
    v_bfe_u32 v3, v0, 2, 2
    v_and_b32 v29, 3, v0
    buffer_load_dwordx4 v107, s[12:15], s36 offen offset:3072 lds
    v_bfe_u32 v30, v0, 4, 1
    v_lshl_add_u32 v1, v31, 2, v3
    v_lshlrev_b32 v1, 8, v1
    v_lshl_add_u32 v1, v30, 5, v1
    v_lshl_add_u32 v1, v29, 3, v1
    v_add_u32 v1, 16384, v1
    s_mov_b32 m0, s98
    s_nop 0
    buffer_load_dwordx4 v108, s[16:19], s37 offen lds
    v_xor_b32 v12, 0, v3
    v_lshl_add_u32 v12, v12, 6, v1
    v_xor_b32 v13, 1, v3
    v_lshl_add_u32 v13, v13, 6, v1
    v_xor_b32 v14, 2, v3
    v_lshl_add_u32 v14, v14, 6, v1
    buffer_load_dwordx4 v109, s[16:19], s37 offen offset:1024 lds
    v_xor_b32 v15, 3, v3
    v_lshl_add_u32 v15, v15, 6, v1
    v_lshl_add_u32 v31, v31, 3, v3
    v_mul_u32_u24 v40, 96, v31
    v_mul_u32_u24 v1, 6272, v30
    v_add_u32 v40, v40, v1
    buffer_load_dwordx4 v110, s[16:19], s37 offen offset:2048 lds
    v_lshl_add_u32 v40, v29, 3, v40
    v_add_u32 v40, 81920, v40
    v_lshlrev_b32 v31, 8, v31
    v_lshl_add_u32 v31, v30, 5, v31
    v_and_b32 v1, 1, v0
    v_bfe_u32 v2, v0, 1, 1
    s_mov_b32 m0, s39
    s_nop 0
    buffer_load_dwordx4 v96, s[8:11], s35 offen lds
    v_lshl_add_u32 v1, v1, 1, v2
    v_lshl_add_u32 v31, v1, 3, v31
    v_add_u32 v31, 65536, v31
    v_xor_b32 v36, 0, v3
    v_lshl_add_u32 v36, v36, 6, v31
    v_xor_b32 v37, 1, v3
    buffer_load_dwordx4 v97, s[8:11], s35 offen offset:1024 lds
    v_lshl_add_u32 v37, v37, 6, v31
    v_xor_b32 v38, 2, v3
    v_lshl_add_u32 v38, v38, 6, v31
    v_xor_b32 v39, 3, v3
    v_lshl_add_u32 v39, v39, 6, v31
    v_and_b32 v1, 15, v0
    buffer_load_dwordx4 v98, s[8:11], s35 offen offset:2048 lds
    v_cmp_eq_u32 vcc, v1, v30
    v_mov_b32 v2, 1065369472
    v_mov_b32 v41, 1065369472
    s_nop 0
    v_cndmask_b32 v44, 0, v2, vcc
    v_cndmask_b32 v45, 0, v2, vcc
    buffer_load_dwordx4 v99, s[8:11], s35 offen offset:3072 lds
    v_cndmask_b32 v46, 0, v2, vcc
    v_cndmask_b32 v47, 0, v2, vcc
    v_mov_b32 v27, 4286578688
    v_mov_b32 v28, 4286578688
    s_mov_b32 s40, 0
    s_mov_b32 s38, 0
    s_add_u32 m0, s39, 4096
    s_nop 0
    buffer_load_dwordx4 v100, s[8:11], s35 offen lds
    s_mov_b32 s60, 214
    buffer_load_dwordx4 v101, s[8:11], s35 offen offset:1024 lds
    buffer_load_dwordx4 v102, s[8:11], s35 offen offset:2048 lds
    buffer_load_dwordx4 v103, s[8:11], s35 offen offset:3072 lds
    s_add_u32 s45, s45, 32768
    s_xor_b32 s39, s39, 32768
    s_lshl_b32 s47, s97, 7
    s_add_u32 s35, s62, s47
    s_lshl_b32 s47, s97, 19
    s_add_u32 s36, s63, s47
    s_mul_i32 s47, s97, 176128
    s_add_u32 s37, s96, s47
    s_add_u32 s97, s97, 1
    s_and_b32 s97, s97, 7
    s_add_u32 s98, s45, s41
    v_lshlrev_b32 v1, 2, v0
    s_lshl_b32 s3, s51, 9
    s_add_u32 s3, s3, s54
    s_mov_b32 exec_hi, 0
    buffer_store_dword v56, v1, s[28:31], s3 offen sc1
    s_mov_b64 exec, -1
    s_getpc_b64 s[4:5]
K1_PCB:
    v_lshlrev_b32 v2, 7, v0
    s_lshl_b32 s3, s32, 13
    v_add_u32 v2, s3, v2
    global_load_dword v127, v2, s[4:5]
    v_lshlrev_b32 v2, 7, v0
    s_lshl_b32 s3, s32, 11
    s_add_u32 s3, s3, 32768
    v_and_b32 v2, 2047, v2
    v_add_u32 v2, s3, v2
    v_min_u32 v2, K1_CODE_END-K1_PCB-128, v2
    global_load_dword v127, v2, s[4:5]
    s_lshl_b32 s3, s33, 13
    s_lshl_b32 s4, s32, 11
    s_add_u32 s3, s3, s4
    s_lshl_b32 s4, s34, 18
    s_add_u32 s3, s3, s4
    v_lshlrev_b32 v2, 4, v0
    buffer_load_dwordx4 v[112:115], v2, s[8:11], s3 offen offset:0
    buffer_load_dwordx4 v[116:119], v2, s[8:11], s3 offen offset:1024
    s_or_b32 s3, s33, s32
    s_cbranch_scc1 K1_NOZ
    v_lshlrev_b32 v2, 3, v0
    v_mov_b32 v126, 0
    buffer_atomic_swap v126, v1, s[28:31], s55 offen sc0 sc1
    v_mov_b32 v120, 0
    v_mov_b32 v121, 0
    buffer_atomic_swap_x2 v[120:121], v2, s[28:31], s55 offen offset:2048 sc0 sc1
    v_mov_b32 v122, 0
    v_mov_b32 v123, 0
    buffer_atomic_swap_x2 v[122:123], v2, s[28:31], s55 offen offset:2560 sc0 sc1
    v_mov_b32 v124, 0
    v_mov_b32 v125, 0
    buffer_atomic_swap_x2 v[124:125], v2, s[28:31], s55 offen offset:3072 sc0 sc1
    v_mov_b32 v42, 0
    v_mov_b32 v43, 0
    buffer_atomic_swap_x2 v[42:43], v2, s[28:31], s55 offen offset:3584 sc0 sc1
K1_NOZ:
    s_waitcnt lgkmcnt(0)
    s_waitcnt vmcnt(19)
    s_barrier
    ds_read_b128 v[64:67], v32 offset:0
    ds_read_b128 v[68:71], v32 offset:4096
    v_xor_b32 v32, 32768, v32
    ds_read_b128 v[72:75], v33 offset:0
    ds_read_b128 v[76:79], v33 offset:4096
    v_xor_b32 v33, 32768, v33
    ds_read_b128 v[80:83], v34 offset:0
    ds_read_b128 v[84:87], v34 offset:4096
    v_xor_b32 v34, 32768, v34
    ds_read_b64_tr_b16 a[96:97], v36 offset:0
    ds_read_b64_tr_b16 a[98:99], v36 offset:1024
    ds_read_b64_tr_b16 a[100:101], v37 offset:0
    ds_read_b64_tr_b16 a[102:103], v37 offset:1024
    ds_read_b64_tr_b16 a[104:105], v38 offset:0
    ds_read_b64_tr_b16 a[106:107], v38 offset:1024
    ds_read_b64_tr_b16 a[108:109], v39 offset:0
    ds_read_b64_tr_b16 a[110:111], v39 offset:1024
    ds_read_b64_tr_b16 a[112:113], v40 offset:0
    ds_read_b64_tr_b16 a[114:115], v40 offset:384
.p2align 6
K1_P1_LOOP:
    s_waitcnt lgkmcnt(8)
    v_mfma_f32_32x32x16_bf16 v[128:143], a[96:99], v[64:67], v[128:143]
    ds_read_b64_tr_b16 a[116:117], v40 offset:32
    ds_read_b128 v[88:91], v35 offset:0
    v_mfma_f32_32x32x16_bf16 v[192:207], a[96:99], v[68:71], v[192:207]
    ds_read_b64_tr_b16 a[118:119], v40 offset:416
    ds_read_b128 v[92:95], v35 offset:4096
    v_xor_b32 v35, 32768, v35
    s_bitcmp1_b32 s60, s38
    s_cbranch_scc1 K1_P1_SPECIAL
K1_P1_SPECIAL_RET:
    s_waitcnt lgkmcnt(10)
    v_mfma_f32_32x32x16_bf16 v[144:159], a[100:103], v[64:67], v[144:159]
    ds_read_b64_tr_b16 a[120:121], v40 offset:64
    s_add_u32 m0, s45, s42
    v_mfma_f32_32x32x16_bf16 v[208:223], a[100:103], v[68:71], v[208:223]
    ds_read_b64_tr_b16 a[122:123], v40 offset:448
    buffer_load_dwordx4 v104, s[12:15], s36 offen lds
    s_waitcnt lgkmcnt(10)
    v_mfma_f32_32x32x16_bf16 v[160:175], a[104:107], v[64:67], v[160:175]
    ds_read_b64_tr_b16 a[124:125], v36 offset:4096
    v_mfma_f32_32x32x16_bf16 v[224:239], a[104:107], v[68:71], v[224:239]
    ds_read_b64_tr_b16 a[126:127], v36 offset:5120
    buffer_load_dwordx4 v105, s[12:15], s36 offen offset:1024 lds
    s_waitcnt lgkmcnt(10)
    v_mfma_f32_32x32x16_bf16 v[176:191], a[108:111], v[64:67], v[176:191]
    ds_read_b64_tr_b16 a[128:129], v37 offset:4096
    v_mfma_f32_32x32x16_bf16 v[240:255], a[108:111], v[68:71], v[240:255]
    ds_read_b64_tr_b16 a[130:131], v37 offset:5120
    s_waitcnt lgkmcnt(10)
    v_mfma_f32_32x32x16_bf16 a[0:15], a[112:115], v[64:67], a[0:15]
    ds_read_b64_tr_b16 a[132:133], v38 offset:4096
    buffer_load_dwordx4 v106, s[12:15], s36 offen offset:2048 lds
    v_mfma_f32_32x32x16_bf16 a[48:63], a[112:115], v[68:71], a[48:63]
    ds_read_b64_tr_b16 a[134:135], v38 offset:5120
    s_waitcnt lgkmcnt(9)
    v_mfma_f32_32x32x16_bf16 a[16:31], a[116:119], v[64:67], a[16:31]
    ds_read_b64_tr_b16 a[136:137], v39 offset:4096
    buffer_load_dwordx4 v107, s[12:15], s36 offen offset:3072 lds
    v_mfma_f32_32x32x16_bf16 a[64:79], a[116:119], v[68:71], a[64:79]
    ds_read_b64_tr_b16 a[138:139], v39 offset:5120
    s_waitcnt lgkmcnt(8)
    v_mfma_f32_32x32x16_bf16 a[32:47], a[120:123], v[64:67], a[32:47]
    ds_read_b64_tr_b16 a[140:141], v40 offset:1536
    s_mov_b32 m0, s98
    v_mfma_f32_32x32x16_bf16 a[80:95], a[120:123], v[68:71], a[80:95]
    ds_read_b64_tr_b16 a[142:143], v40 offset:1920
    buffer_load_dwordx4 v108, s[16:19], s37 offen lds
    s_cmp_eq_u32 s32, 0
    s_cbranch_scc0 K1_CS0
    v_mfma_f32_16x16x32_bf16 a[224:227], a[96:99], v[44:47], a[224:227]
    v_mfma_f32_16x16x32_bf16 a[228:231], a[100:103], v[44:47], a[228:231]
    v_mfma_f32_16x16x32_bf16 a[232:235], a[104:107], v[44:47], a[232:235]
    v_mfma_f32_16x16x32_bf16 a[236:239], a[108:111], v[44:47], a[236:239]
    v_mfma_f32_16x16x32_bf16 a[240:243], a[112:115], v[44:47], a[240:243]
    v_mfma_f32_16x16x32_bf16 a[244:247], a[116:119], v[44:47], a[244:247]
    v_mfma_f32_16x16x32_bf16 a[248:251], a[120:123], v[44:47], a[248:251]
K1_CS0:
    s_waitcnt lgkmcnt(8)
    v_mfma_f32_32x32x16_bf16 v[128:143], a[124:127], v[72:75], v[128:143]
    ds_read_b64_tr_b16 a[144:145], v40 offset:1568
    v_mfma_f32_32x32x16_bf16 v[192:207], a[124:127], v[76:79], v[192:207]
    ds_read_b64_tr_b16 a[146:147], v40 offset:1952
    buffer_load_dwordx4 v109, s[16:19], s37 offen offset:1024 lds
    s_waitcnt lgkmcnt(8)
    v_mfma_f32_32x32x16_bf16 v[144:159], a[128:131], v[72:75], v[144:159]
    ds_read_b64_tr_b16 a[148:149], v40 offset:1600
    v_mfma_f32_32x32x16_bf16 v[208:223], a[128:131], v[76:79], v[208:223]
    ds_read_b64_tr_b16 a[150:151], v40 offset:1984
    s_waitcnt lgkmcnt(8)
    v_mfma_f32_32x32x16_bf16 v[160:175], a[132:135], v[72:75], v[160:175]
    ds_read_b64_tr_b16 a[96:97], v36 offset:8192
    buffer_load_dwordx4 v110, s[16:19], s37 offen offset:2048 lds
    v_mfma_f32_32x32x16_bf16 v[224:239], a[132:135], v[76:79], v[224:239]
    ds_read_b64_tr_b16 a[98:99], v36 offset:9216
    s_mov_b32 m0, s39
    s_waitcnt lgkmcnt(8)
    v_mfma_f32_32x32x16_bf16 v[176:191], a[136:139], v[72:75], v[176:191]
    ds_read_b64_tr_b16 a[100:101], v37 offset:8192
    buffer_load_dwordx4 v96, s[8:11], s35 offen lds
    v_mfma_f32_32x32x16_bf16 v[240:255], a[136:139], v[76:79], v[240:255]
    ds_read_b64_tr_b16 a[102:103], v37 offset:9216
    s_waitcnt lgkmcnt(8)
    v_mfma_f32_32x32x16_bf16 a[0:15], a[140:143], v[72:75], a[0:15]
    ds_read_b64_tr_b16 a[104:105], v38 offset:8192
    v_mfma_f32_32x32x16_bf16 a[48:63], a[140:143], v[76:79], a[48:63]
    ds_read_b64_tr_b16 a[106:107], v38 offset:9216
    buffer_load_dwordx4 v97, s[8:11], s35 offen offset:1024 lds
    s_waitcnt lgkmcnt(8)
    v_mfma_f32_32x32x16_bf16 a[16:31], a[144:147], v[72:75], a[16:31]
    ds_read_b64_tr_b16 a[108:109], v39 offset:8192
    v_mfma_f32_32x32x16_bf16 a[64:79], a[144:147], v[76:79], a[64:79]
    ds_read_b64_tr_b16 a[110:111], v39 offset:9216
    buffer_load_dwordx4 v98, s[8:11], s35 offen offset:2048 lds
    s_waitcnt lgkmcnt(8)
    v_mfma_f32_32x32x16_bf16 a[32:47], a[148:151], v[72:75], a[32:47]
    ds_read_b64_tr_b16 a[112:113], v40 offset:3072
    v_mfma_f32_32x32x16_bf16 a[80:95], a[148:151], v[76:79], a[80:95]
    ds_read_b64_tr_b16 a[114:115], v40 offset:3456
    s_cmp_eq_u32 s32, 1
    s_cbranch_scc0 K1_CS1
    v_mfma_f32_16x16x32_bf16 a[224:227], a[124:127], v[44:47], a[224:227]
    v_mfma_f32_16x16x32_bf16 a[228:231], a[128:131], v[44:47], a[228:231]
    v_mfma_f32_16x16x32_bf16 a[232:235], a[132:135], v[44:47], a[232:235]
    v_mfma_f32_16x16x32_bf16 a[236:239], a[136:139], v[44:47], a[236:239]
    v_mfma_f32_16x16x32_bf16 a[240:243], a[140:143], v[44:47], a[240:243]
    v_mfma_f32_16x16x32_bf16 a[244:247], a[144:147], v[44:47], a[244:247]
    v_mfma_f32_16x16x32_bf16 a[248:251], a[148:151], v[44:47], a[248:251]
K1_CS1:
    s_waitcnt lgkmcnt(8)
    v_mfma_f32_32x32x16_bf16 v[128:143], a[96:99], v[80:83], v[128:143]
    ds_read_b64_tr_b16 a[116:117], v40 offset:3104
    buffer_load_dwordx4 v99, s[8:11], s35 offen offset:3072 lds
    v_mfma_f32_32x32x16_bf16 v[192:207], a[96:99], v[84:87], v[192:207]
    ds_read_b64_tr_b16 a[118:119], v40 offset:3488
    s_add_u32 m0, s39, 4096
    s_waitcnt lgkmcnt(8)
    v_mfma_f32_32x32x16_bf16 v[144:159], a[100:103], v[80:83], v[144:159]
    ds_read_b64_tr_b16 a[120:121], v40 offset:3136
    buffer_load_dwordx4 v100, s[8:11], s35 offen lds
    v_mfma_f32_32x32x16_bf16 v[208:223], a[100:103], v[84:87], v[208:223]
    ds_read_b64_tr_b16 a[122:123], v40 offset:3520
    s_waitcnt lgkmcnt(8)
    v_mfma_f32_32x32x16_bf16 v[160:175], a[104:107], v[80:83], v[160:175]
    ds_read_b64_tr_b16 a[124:125], v36 offset:12288
    v_mfma_f32_32x32x16_bf16 v[224:239], a[104:107], v[84:87], v[224:239]
    ds_read_b64_tr_b16 a[126:127], v36 offset:13312
    buffer_load_dwordx4 v101, s[8:11], s35 offen offset:1024 lds
    s_waitcnt lgkmcnt(8)
    v_mfma_f32_32x32x16_bf16 v[176:191], a[108:111], v[80:83], v[176:191]
    ds_read_b64_tr_b16 a[128:129], v37 offset:12288
    v_mfma_f32_32x32x16_bf16 v[240:255], a[108:111], v[84:87], v[240:255]
    ds_read_b64_tr_b16 a[130:131], v37 offset:13312
    buffer_load_dwordx4 v102, s[8:11], s35 offen offset:2048 lds
    s_waitcnt lgkmcnt(8)
    v_mfma_f32_32x32x16_bf16 a[0:15], a[112:115], v[80:83], a[0:15]
    ds_read_b64_tr_b16 a[132:133], v38 offset:12288
    v_mfma_f32_32x32x16_bf16 a[48:63], a[112:115], v[84:87], a[48:63]
    ds_read_b64_tr_b16 a[134:135], v38 offset:13312
    s_waitcnt lgkmcnt(8)
    v_mfma_f32_32x32x16_bf16 a[16:31], a[116:119], v[80:83], a[16:31]
    ds_read_b64_tr_b16 a[136:137], v39 offset:12288
    buffer_load_dwordx4 v103, s[8:11], s35 offen offset:3072 lds
    v_mfma_f32_32x32x16_bf16 a[64:79], a[116:119], v[84:87], a[64:79]
    ds_read_b64_tr_b16 a[138:139], v39 offset:13312
    s_lshl_b32 s45, s40, 15
    s_add_u32 s45, s45, 65536
    s_add_u32 s40, s40, 1
    s_cmp_eq_u32 s40, 3
    s_cselect_b32 s46, s44, 32768
    s_cselect_b32 s40, 0, s40
    s_waitcnt lgkmcnt(8)
    v_mfma_f32_32x32x16_bf16 a[32:47], a[120:123], v[80:83], a[32:47]
    ds_read_b64_tr_b16 a[140:141], v40 offset:4608
    s_xor_b32 s39, s39, 32768
    s_lshl_b32 s47, s97, 7
    s_add_u32 s35, s62, s47
    s_lshl_b32 s47, s97, 19
    s_add_u32 s36, s63, s47
    s_mul_i32 s47, s97, 176128
    s_add_u32 s37, s96, s47
    s_add_u32 s97, s97, 1
    s_and_b32 s97, s97, 7
    s_add_u32 s98, s45, s41
    v_mfma_f32_32x32x16_bf16 a[80:95], a[120:123], v[84:87], a[80:95]
    ds_read_b64_tr_b16 a[142:143], v40 offset:4992
    s_cmp_eq_u32 s32, 2
    s_cbranch_scc0 K1_CS2
    v_mfma_f32_16x16x32_bf16 a[224:227], a[96:99], v[44:47], a[224:227]
    v_mfma_f32_16x16x32_bf16 a[228:231], a[100:103], v[44:47], a[228:231]
    v_mfma_f32_16x16x32_bf16 a[232:235], a[104:107], v[44:47], a[232:235]
    v_mfma_f32_16x16x32_bf16 a[236:239], a[108:111], v[44:47], a[236:239]
    v_mfma_f32_16x16x32_bf16 a[240:243], a[112:115], v[44:47], a[240:243]
    v_mfma_f32_16x16x32_bf16 a[244:247], a[116:119], v[44:47], a[244:247]
    v_mfma_f32_16x16x32_bf16 a[248:251], a[120:123], v[44:47], a[248:251]
K1_CS2:
    s_waitcnt vmcnt(15)
    s_waitcnt lgkmcnt(8)
    v_mfma_f32_32x32x16_bf16 v[128:143], a[124:127], v[88:91], v[128:143]
    ds_read_b64_tr_b16 a[144:145], v40 offset:4640
    ds_read_b128 v[64:67], v32 offset:0
    v_mfma_f32_32x32x16_bf16 v[192:207], a[124:127], v[92:95], v[192:207]
    ds_read_b64_tr_b16 a[146:147], v40 offset:5024
    ds_read_b128 v[68:71], v32 offset:4096
    v_xor_b32 v32, 32768, v32
    s_waitcnt lgkmcnt(10)
    v_mfma_f32_32x32x16_bf16 v[144:159], a[128:131], v[88:91], v[144:159]
    ds_read_b64_tr_b16 a[148:149], v40 offset:4672
    v_mfma_f32_32x32x16_bf16 v[208:223], a[128:131], v[92:95], v[208:223]
    ds_read_b64_tr_b16 a[150:151], v40 offset:5056
    v_add_u32 v36, s46, v36
    v_add_u32 v37, s46, v37
    v_add_u32 v38, s46, v38
    v_add_u32 v39, s46, v39
    v_add_u32 v40, s46, v40
    s_waitcnt lgkmcnt(10)
    v_mfma_f32_32x32x16_bf16 v[160:175], a[132:135], v[88:91], v[160:175]
    ds_read_b128 v[72:75], v33 offset:0
    ds_read_b128 v[76:79], v33 offset:4096
    v_xor_b32 v33, 32768, v33
    v_mfma_f32_32x32x16_bf16 v[224:239], a[132:135], v[92:95], v[224:239]
    ds_read_b128 v[80:83], v34 offset:0
    ds_read_b128 v[84:87], v34 offset:4096
    v_xor_b32 v34, 32768, v34
    s_waitcnt lgkmcnt(12)
    v_mfma_f32_32x32x16_bf16 v[176:191], a[136:139], v[88:91], v[176:191]
    s_waitcnt lgkmcnt(4)
    s_barrier
    ds_read_b64_tr_b16 a[96:97], v36 offset:0
    ds_read_b64_tr_b16 a[98:99], v36 offset:1024
    v_mfma_f32_32x32x16_bf16 v[240:255], a[136:139], v[92:95], v[240:255]
    ds_read_b64_tr_b16 a[100:101], v37 offset:0
    ds_read_b64_tr_b16 a[102:103], v37 offset:1024
    v_mfma_f32_32x32x16_bf16 a[0:15], a[140:143], v[88:91], a[0:15]
    ds_read_b64_tr_b16 a[104:105], v38 offset:0
    v_mfma_f32_32x32x16_bf16 a[48:63], a[140:143], v[92:95], a[48:63]
    ds_read_b64_tr_b16 a[106:107], v38 offset:1024
    v_mfma_f32_32x32x16_bf16 a[16:31], a[144:147], v[88:91], a[16:31]
    ds_read_b64_tr_b16 a[108:109], v39 offset:0
    v_mfma_f32_32x32x16_bf16 a[64:79], a[144:147], v[92:95], a[64:79]
    ds_read_b64_tr_b16 a[110:111], v39 offset:1024
    v_mfma_f32_32x32x16_bf16 a[32:47], a[148:151], v[88:91], a[32:47]
    ds_read_b64_tr_b16 a[112:113], v40 offset:0
    v_mfma_f32_32x32x16_bf16 a[80:95], a[148:151], v[92:95], a[80:95]
    s_cmp_eq_u32 s32, 3
    s_cbranch_scc0 K1_CS3
    v_mfma_f32_16x16x32_bf16 a[224:227], a[124:127], v[44:47], a[224:227]
    v_mfma_f32_16x16x32_bf16 a[228:231], a[128:131], v[44:47], a[228:231]
    v_mfma_f32_16x16x32_bf16 a[232:235], a[132:135], v[44:47], a[232:235]
    v_mfma_f32_16x16x32_bf16 a[236:239], a[136:139], v[44:47], a[236:239]
    v_mfma_f32_16x16x32_bf16 a[240:243], a[140:143], v[44:47], a[240:243]
    v_mfma_f32_16x16x32_bf16 a[244:247], a[144:147], v[44:47], a[244:247]
    v_mfma_f32_16x16x32_bf16 a[248:251], a[148:151], v[44:47], a[248:251]
K1_CS3:
    ds_read_b64_tr_b16 a[114:115], v40 offset:384
    s_add_u32 s38, s38, 1
    s_cmp_lt_u32 s38, 8
    s_cbranch_scc1 K1_P1_LOOP
K1_E1:
    s_waitcnt lgkmcnt(0)
    v_and_b32 v1, 15, v0
    v_lshrrev_b32 v2, 4, v0
    v_lshlrev_b32 v1, 6, v1
    v_lshl_add_u32 v1, v2, 4, v1
    s_mul_i32 s47, s32, 896
    s_add_u32 s47, s47, 147456
    v_add_u32 v1, s47, v1
    s_mov_b32 exec_lo, 0x00030003
    s_mov_b32 exec_hi, 0x00030003
    s_nop 3
    ds_write_b128 v1, a[224:227] offset:0
    ds_write_b128 v1, a[228:231] offset:128
    ds_write_b128 v1, a[232:235] offset:256
    ds_write_b128 v1, a[236:239] offset:384
    ds_write_b128 v1, a[240:243] offset:512
    ds_write_b128 v1, a[244:247] offset:640
    ds_write_b128 v1, a[248:251] offset:768
    s_mov_b64 exec, -1
    s_waitcnt lgkmcnt(0)
    s_barrier
    v_lshlrev_b32 v1, 4, v0
    v_add_u32 v2, 147456, v1
    ds_read_b128 v[32:35], v2 offset:0
    ds_read_b128 v[36:39], v2 offset:896
    ds_read_b128 v[40:43], v2 offset:1792
    ds_read_b128 v[44:47], v2 offset:2688
    s_waitcnt vmcnt(15)
K1_ST:
    v_min_u32 v3, v117, v119
    v_cmp_eq_u32 vcc, 0, v3
    v_mov_b32 v23, v116
    v_mov_b32 v25, v117
    v_mov_b32 v24, v118
    v_mov_b32 v26, v119
    s_cbranch_vccnz K1_ST_SPIN
    s_mov_b32 s63, s33
    s_lshl_b32 s35, s32, 10
    s_add_u32 s35, s35, 151552
    v_add_u32 v1, s35, v1
    v_mul_f32 v56, 1040356334, v25
    v_mul_f32 v60, 1040356334, v23
    v_mul_f32 v57, 1040356334, v25
    v_mul_f32 v61, 1040356334, v23
    v_mul_f32 v58, 1040356334, v26
    v_mul_f32 v62, 1040356334, v24
    v_mul_f32 v59, 1040356334, v26
    v_mul_f32 v63, 1040356334, v24
    v_and_b32 v3, 36, v0
    v_cmp_eq_u32 vcc, 32, v3
    v_mov_b32 v3, 3216550459
    s_nop 0
    v_cndmask_b32 v54, 1.0, v3, vcc
    v_cndmask_b32 v55, 1.0, v3, vcc
    s_waitcnt lgkmcnt(2)
    v_pk_add_f32 v[32:33], v[32:33], v[36:37]
    s_waitcnt lgkmcnt(0)
    v_pk_add_f32 v[40:41], v[40:41], v[44:45]
    v_pk_add_f32 v[34:35], v[34:35], v[38:39]
    v_pk_add_f32 v[42:43], v[42:43], v[46:47]
    v_pk_add_f32 v[32:33], v[32:33], v[40:41]
    v_pk_add_f32 v[34:35], v[34:35], v[42:43]
    v_pk_mul_f32 v[32:33], v[32:33], v[54:55]
    v_pk_mul_f32 v[34:35], v[34:35], v[54:55]
    ds_write_b128 v1, v[32:35]
    v_lshrrev_b32 v31, 5, v0
    v_lshlrev_b32 v31, 4, v31
    v_add_u32 v31, s35, v31
    s_waitcnt lgkmcnt(0)
    ds_read_b128 v[32:35], v31 offset:0
    ds_read_b128 v[36:39], v31 offset:32
    ds_read_b128 v[40:43], v31 offset:64
    ds_read_b128 v[44:47], v31 offset:96
    ds_read_b128 v[48:51], v31 offset:128
    s_add_u32 m0, s42, 114688
    s_add_u32 s46, s43, 32768
    buffer_load_dwordx4 v20, s[24:27], s46 offen lds
    s_waitcnt lgkmcnt(4)
    v_pk_mul_f32 v[52:53], v[32:33], v[60:61]
    v_pk_fma_f32 v[52:53], v[128:129], v[56:57], v[52:53]
    v_pk_mul_f32 v[54:55], v[34:35], v[60:61]
    v_pk_fma_f32 v[54:55], v[130:131], v[56:57], v[54:55]
    v_cvt_pk_bf16_f32 v64, v52, v53
    v_cvt_pk_bf16_f32 v65, v54, v55
    v_pk_mul_f32 v[52:53], v[32:33], v[62:63]
    v_pk_fma_f32 v[52:53], v[192:193], v[58:59], v[52:53]
    v_pk_mul_f32 v[54:55], v[34:35], v[62:63]
    v_pk_fma_f32 v[54:55], v[194:195], v[58:59], v[54:55]
    v_cvt_pk_bf16_f32 v96, v52, v53
    v_cvt_pk_bf16_f32 v97, v54, v55
    ds_read_b128 v[32:35], v31 offset:160
    buffer_load_dwordx4 v20, s[24:27], s46 offen offset:1024 lds
    s_waitcnt lgkmcnt(4)
    v_pk_mul_f32 v[52:53], v[36:37], v[60:61]
    v_pk_fma_f32 v[52:53], v[132:133], v[56:57], v[52:53]
    v_pk_mul_f32 v[54:55], v[38:39], v[60:61]
    v_pk_fma_f32 v[54:55], v[134:135], v[56:57], v[54:55]
    v_cvt_pk_bf16_f32 v66, v52, v53
    v_cvt_pk_bf16_f32 v67, v54, v55
    v_pk_mul_f32 v[52:53], v[36:37], v[62:63]
    v_pk_fma_f32 v[52:53], v[196:197], v[58:59], v[52:53]
    v_pk_mul_f32 v[54:55], v[38:39], v[62:63]
    v_pk_fma_f32 v[54:55], v[198:199], v[58:59], v[54:55]
    v_cvt_pk_bf16_f32 v98, v52, v53
    v_cvt_pk_bf16_f32 v99, v54, v55
    ds_read_b128 v[36:39], v31 offset:192
    buffer_load_dwordx4 v20, s[24:27], s46 offen offset:2048 lds
    s_waitcnt lgkmcnt(4)
    v_pk_mul_f32 v[52:53], v[40:41], v[60:61]
    v_pk_fma_f32 v[52:53], v[136:137], v[56:57], v[52:53]
    v_pk_mul_f32 v[54:55], v[42:43], v[60:61]
    v_pk_fma_f32 v[54:55], v[138:139], v[56:57], v[54:55]
    v_cvt_pk_bf16_f32 v68, v52, v53
    v_cvt_pk_bf16_f32 v69, v54, v55
    v_pk_mul_f32 v[52:53], v[40:41], v[62:63]
    v_pk_fma_f32 v[52:53], v[200:201], v[58:59], v[52:53]
    v_pk_mul_f32 v[54:55], v[42:43], v[62:63]
    v_pk_fma_f32 v[54:55], v[202:203], v[58:59], v[54:55]
    v_cvt_pk_bf16_f32 v100, v52, v53
    v_cvt_pk_bf16_f32 v101, v54, v55
    ds_read_b128 v[40:43], v31 offset:224
    buffer_load_dwordx4 v20, s[24:27], s46 offen offset:3072 lds
    s_waitcnt lgkmcnt(4)
    v_pk_mul_f32 v[52:53], v[44:45], v[60:61]
    v_pk_fma_f32 v[52:53], v[140:141], v[56:57], v[52:53]
    v_pk_mul_f32 v[54:55], v[46:47], v[60:61]
    v_pk_fma_f32 v[54:55], v[142:143], v[56:57], v[54:55]
    v_cvt_pk_bf16_f32 v70, v52, v53
    v_cvt_pk_bf16_f32 v71, v54, v55
    v_pk_mul_f32 v[52:53], v[44:45], v[62:63]
    v_pk_fma_f32 v[52:53], v[204:205], v[58:59], v[52:53]
    v_pk_mul_f32 v[54:55], v[46:47], v[62:63]
    v_pk_fma_f32 v[54:55], v[206:207], v[58:59], v[54:55]
    v_cvt_pk_bf16_f32 v102, v52, v53
    v_cvt_pk_bf16_f32 v103, v54, v55
    ds_read_b128 v[44:47], v31 offset:256
    s_add_u32 m0, s42, 98304
    s_add_u32 s46, s43, 65536
    buffer_load_dwordx4 v16, s[20:23], s46 offen lds
    s_waitcnt lgkmcnt(4)
    v_pk_mul_f32 v[52:53], v[48:49], v[60:61]
    v_pk_fma_f32 v[52:53], v[144:145], v[56:57], v[52:53]
    v_pk_mul_f32 v[54:55], v[50:51], v[60:61]
    v_pk_fma_f32 v[54:55], v[146:147], v[56:57], v[54:55]
    v_cvt_pk_bf16_f32 v72, v52, v53
    v_cvt_pk_bf16_f32 v73, v54, v55
    v_pk_mul_f32 v[52:53], v[48:49], v[62:63]
    v_pk_fma_f32 v[52:53], v[208:209], v[58:59], v[52:53]
    v_pk_mul_f32 v[54:55], v[50:51], v[62:63]
    v_pk_fma_f32 v[54:55], v[210:211], v[58:59], v[54:55]
    v_cvt_pk_bf16_f32 v104, v52, v53
    v_cvt_pk_bf16_f32 v105, v54, v55
    ds_read_b128 v[48:51], v31 offset:288
    buffer_load_dwordx4 v17, s[20:23], s46 offen offset:1024 lds
    s_waitcnt lgkmcnt(4)
    v_pk_mul_f32 v[52:53], v[32:33], v[60:61]
    v_pk_fma_f32 v[52:53], v[148:149], v[56:57], v[52:53]
    v_pk_mul_f32 v[54:55], v[34:35], v[60:61]
    v_pk_fma_f32 v[54:55], v[150:151], v[56:57], v[54:55]
    v_cvt_pk_bf16_f32 v74, v52, v53
    v_cvt_pk_bf16_f32 v75, v54, v55
    v_pk_mul_f32 v[52:53], v[32:33], v[62:63]
    v_pk_fma_f32 v[52:53], v[212:213], v[58:59], v[52:53]
    v_pk_mul_f32 v[54:55], v[34:35], v[62:63]
    v_pk_fma_f32 v[54:55], v[214:215], v[58:59], v[54:55]
    v_cvt_pk_bf16_f32 v106, v52, v53
    v_cvt_pk_bf16_f32 v107, v54, v55
    ds_read_b128 v[32:35], v31 offset:320
    buffer_load_dwordx4 v18, s[20:23], s46 offen offset:2048 lds
    s_waitcnt lgkmcnt(4)
    v_pk_mul_f32 v[52:53], v[36:37], v[60:61]
    v_pk_fma_f32 v[52:53], v[152:153], v[56:57], v[52:53]
    v_pk_mul_f32 v[54:55], v[38:39], v[60:61]
    v_pk_fma_f32 v[54:55], v[154:155], v[56:57], v[54:55]
    v_cvt_pk_bf16_f32 v76, v52, v53
    v_cvt_pk_bf16_f32 v77, v54, v55
    v_pk_mul_f32 v[52:53], v[36:37], v[62:63]
    v_pk_fma_f32 v[52:53], v[216:217], v[58:59], v[52:53]
    v_pk_mul_f32 v[54:55], v[38:39], v[62:63]
    v_pk_fma_f32 v[54:55], v[218:219], v[58:59], v[54:55]
    v_cvt_pk_bf16_f32 v108, v52, v53
    v_cvt_pk_bf16_f32 v109, v54, v55
    ds_read_b128 v[36:39], v31 offset:352
    buffer_load_dwordx4 v19, s[20:23], s46 offen offset:3072 lds
    s_waitcnt lgkmcnt(4)
    v_pk_mul_f32 v[52:53], v[40:41], v[60:61]
    v_pk_fma_f32 v[52:53], v[156:157], v[56:57], v[52:53]
    v_pk_mul_f32 v[54:55], v[42:43], v[60:61]
    v_pk_fma_f32 v[54:55], v[158:159], v[56:57], v[54:55]
    v_cvt_pk_bf16_f32 v78, v52, v53
    v_cvt_pk_bf16_f32 v79, v54, v55
    v_pk_mul_f32 v[52:53], v[40:41], v[62:63]
    v_pk_fma_f32 v[52:53], v[220:221], v[58:59], v[52:53]
    v_pk_mul_f32 v[54:55], v[42:43], v[62:63]
    v_pk_fma_f32 v[54:55], v[222:223], v[58:59], v[54:55]
    v_cvt_pk_bf16_f32 v110, v52, v53
    v_cvt_pk_bf16_f32 v111, v54, v55
    ds_read_b128 v[40:43], v31 offset:384
    s_add_u32 m0, s42, 81920
    s_add_u32 s46, s43, 49152
    buffer_load_dwordx4 v20, s[24:27], s46 offen lds
    s_waitcnt lgkmcnt(4)
    v_pk_mul_f32 v[52:53], v[44:45], v[60:61]
    v_pk_fma_f32 v[52:53], v[160:161], v[56:57], v[52:53]
    v_pk_mul_f32 v[54:55], v[46:47], v[60:61]
    v_pk_fma_f32 v[54:55], v[162:163], v[56:57], v[54:55]
    v_cvt_pk_bf16_f32 v80, v52, v53
    v_cvt_pk_bf16_f32 v81, v54, v55
    v_pk_mul_f32 v[52:53], v[44:45], v[62:63]
    v_pk_fma_f32 v[52:53], v[224:225], v[58:59], v[52:53]
    v_pk_mul_f32 v[54:55], v[46:47], v[62:63]
    v_pk_fma_f32 v[54:55], v[226:227], v[58:59], v[54:55]
    v_cvt_pk_bf16_f32 v112, v52, v53
    v_cvt_pk_bf16_f32 v113, v54, v55
    ds_read_b128 v[44:47], v31 offset:416
    buffer_load_dwordx4 v20, s[24:27], s46 offen offset:1024 lds
    s_waitcnt lgkmcnt(4)
    v_pk_mul_f32 v[52:53], v[48:49], v[60:61]
    v_pk_fma_f32 v[52:53], v[164:165], v[56:57], v[52:53]
    v_pk_mul_f32 v[54:55], v[50:51], v[60:61]
    v_pk_fma_f32 v[54:55], v[166:167], v[56:57], v[54:55]
    v_cvt_pk_bf16_f32 v82, v52, v53
    v_cvt_pk_bf16_f32 v83, v54, v55
    v_pk_mul_f32 v[52:53], v[48:49], v[62:63]
    v_pk_fma_f32 v[52:53], v[228:229], v[58:59], v[52:53]
    v_pk_mul_f32 v[54:55], v[50:51], v[62:63]
    v_pk_fma_f32 v[54:55], v[230:231], v[58:59], v[54:55]
    v_cvt_pk_bf16_f32 v114, v52, v53
    v_cvt_pk_bf16_f32 v115, v54, v55
    ds_read_b128 v[48:51], v31 offset:448
    buffer_load_dwordx4 v20, s[24:27], s46 offen offset:2048 lds
    s_waitcnt lgkmcnt(4)
    v_pk_mul_f32 v[52:53], v[32:33], v[60:61]
    v_pk_fma_f32 v[52:53], v[168:169], v[56:57], v[52:53]
    v_pk_mul_f32 v[54:55], v[34:35], v[60:61]
    v_pk_fma_f32 v[54:55], v[170:171], v[56:57], v[54:55]
    v_cvt_pk_bf16_f32 v84, v52, v53
    v_cvt_pk_bf16_f32 v85, v54, v55
    v_pk_mul_f32 v[52:53], v[32:33], v[62:63]
    v_pk_fma_f32 v[52:53], v[232:233], v[58:59], v[52:53]
    v_pk_mul_f32 v[54:55], v[34:35], v[62:63]
    v_pk_fma_f32 v[54:55], v[234:235], v[58:59], v[54:55]
    v_cvt_pk_bf16_f32 v116, v52, v53
    v_cvt_pk_bf16_f32 v117, v54, v55
    ds_read_b128 v[32:35], v31 offset:480
    buffer_load_dwordx4 v20, s[24:27], s46 offen offset:3072 lds
    s_waitcnt lgkmcnt(4)
    v_pk_mul_f32 v[52:53], v[36:37], v[60:61]
    v_pk_fma_f32 v[52:53], v[172:173], v[56:57], v[52:53]
    v_pk_mul_f32 v[54:55], v[38:39], v[60:61]
    v_pk_fma_f32 v[54:55], v[174:175], v[56:57], v[54:55]
    v_cvt_pk_bf16_f32 v86, v52, v53
    v_cvt_pk_bf16_f32 v87, v54, v55
    v_pk_mul_f32 v[52:53], v[36:37], v[62:63]
    v_pk_fma_f32 v[52:53], v[236:237], v[58:59], v[52:53]
    v_pk_mul_f32 v[54:55], v[38:39], v[62:63]
    v_pk_fma_f32 v[54:55], v[238:239], v[58:59], v[54:55]
    v_cvt_pk_bf16_f32 v118, v52, v53
    v_cvt_pk_bf16_f32 v119, v54, v55
    s_waitcnt lgkmcnt(3)
    v_pk_mul_f32 v[52:53], v[40:41], v[60:61]
    v_pk_fma_f32 v[52:53], v[176:177], v[56:57], v[52:53]
    v_pk_mul_f32 v[54:55], v[42:43], v[60:61]
    v_pk_fma_f32 v[54:55], v[178:179], v[56:57], v[54:55]
    v_cvt_pk_bf16_f32 v88, v52, v53
    v_cvt_pk_bf16_f32 v89, v54, v55
    v_pk_mul_f32 v[52:53], v[40:41], v[62:63]
    v_pk_fma_f32 v[52:53], v[240:241], v[58:59], v[52:53]
    v_pk_mul_f32 v[54:55], v[42:43], v[62:63]
    v_pk_fma_f32 v[54:55], v[242:243], v[58:59], v[54:55]
    v_cvt_pk_bf16_f32 v120, v52, v53
    v_cvt_pk_bf16_f32 v121, v54, v55
    s_waitcnt lgkmcnt(2)
    v_pk_mul_f32 v[52:53], v[44:45], v[60:61]
    v_pk_fma_f32 v[52:53], v[180:181], v[56:57], v[52:53]
    v_pk_mul_f32 v[54:55], v[46:47], v[60:61]
    v_pk_fma_f32 v[54:55], v[182:183], v[56:57], v[54:55]
    v_cvt_pk_bf16_f32 v90, v52, v53
    v_cvt_pk_bf16_f32 v91, v54, v55
    v_pk_mul_f32 v[52:53], v[44:45], v[62:63]
    v_pk_fma_f32 v[52:53], v[244:245], v[58:59], v[52:53]
    v_pk_mul_f32 v[54:55], v[46:47], v[62:63]
    v_pk_fma_f32 v[54:55], v[246:247], v[58:59], v[54:55]
    v_cvt_pk_bf16_f32 v122, v52, v53
    v_cvt_pk_bf16_f32 v123, v54, v55
    s_waitcnt lgkmcnt(1)
    v_pk_mul_f32 v[52:53], v[48:49], v[60:61]
    v_pk_fma_f32 v[52:53], v[184:185], v[56:57], v[52:53]
    v_pk_mul_f32 v[54:55], v[50:51], v[60:61]
    v_pk_fma_f32 v[54:55], v[186:187], v[56:57], v[54:55]
    v_cvt_pk_bf16_f32 v92, v52, v53
    v_cvt_pk_bf16_f32 v93, v54, v55
    v_pk_mul_f32 v[52:53], v[48:49], v[62:63]
    v_pk_fma_f32 v[52:53], v[248:249], v[58:59], v[52:53]
    v_pk_mul_f32 v[54:55], v[50:51], v[62:63]
    v_pk_fma_f32 v[54:55], v[250:251], v[58:59], v[54:55]
    v_cvt_pk_bf16_f32 v124, v52, v53
    v_cvt_pk_bf16_f32 v125, v54, v55
    s_waitcnt lgkmcnt(0)
    v_pk_mul_f32 v[52:53], v[32:33], v[60:61]
    v_pk_fma_f32 v[52:53], v[188:189], v[56:57], v[52:53]
    v_pk_mul_f32 v[54:55], v[34:35], v[60:61]
    v_pk_fma_f32 v[54:55], v[190:191], v[56:57], v[54:55]
    v_cvt_pk_bf16_f32 v94, v52, v53
    v_cvt_pk_bf16_f32 v95, v54, v55
    v_pk_mul_f32 v[52:53], v[32:33], v[62:63]
    v_pk_fma_f32 v[52:53], v[252:253], v[58:59], v[52:53]
    v_pk_mul_f32 v[54:55], v[34:35], v[62:63]
    v_pk_fma_f32 v[54:55], v[254:255], v[58:59], v[54:55]
    v_cvt_pk_bf16_f32 v126, v52, v53
    v_cvt_pk_bf16_f32 v127, v54, v55
    v_lshlrev_b32 v0, 4, v0
    v_mul_f32 v30, 3216550459, v25
    v_mul_f32 v31, 3216550459, v26
K1_P2_ENTRY:
    s_waitcnt vmcnt(40)
    s_barrier
    ds_read_b128 a[224:227], v4 offset:0
    ds_read_b128 a[228:231], v5 offset:0
    ds_read_b128 a[232:235], v6 offset:0
    ds_read_b128 a[236:239], v7 offset:0
    ds_read_b128 a[240:243], v8 offset:0
    ds_read_b128 a[244:247], v9 offset:0
    ds_read_b128 a[248:251], v10 offset:0
    ds_read_b128 a[252:255], v11 offset:0
    s_waitcnt lgkmcnt(7)
    v_mfma_f32_32x32x16_bf16 v[128:143], a[224:227], v[64:67], 0
    s_waitcnt lgkmcnt(6)
    v_mfma_f32_32x32x16_bf16 v[128:143], a[228:231], v[68:71], v[128:143]
    s_waitcnt lgkmcnt(5)
    v_mfma_f32_32x32x16_bf16 v[128:143], a[232:235], v[72:75], v[128:143]
    s_waitcnt lgkmcnt(4)
    v_mfma_f32_32x32x16_bf16 v[128:143], a[236:239], v[76:79], v[128:143]
    s_waitcnt lgkmcnt(3)
    v_mfma_f32_32x32x16_bf16 v[128:143], a[240:243], v[80:83], v[128:143]
    s_waitcnt lgkmcnt(2)
    v_mfma_f32_32x32x16_bf16 v[128:143], a[244:247], v[84:87], v[128:143]
    s_waitcnt lgkmcnt(1)
    v_mfma_f32_32x32x16_bf16 v[128:143], a[248:251], v[88:91], v[128:143]
    s_waitcnt lgkmcnt(0)
    v_mfma_f32_32x32x16_bf16 v[128:143], a[252:255], v[92:95], v[128:143]
    s_nop 3
    v_mfma_f32_32x32x16_bf16 v[144:159], a[224:227], v[96:99], 0
    ds_read_b128 a[224:227], v4 offset:8192
    s_nop 3
    v_mfma_f32_32x32x16_bf16 v[144:159], a[228:231], v[100:103], v[144:159]
    ds_read_b128 a[228:231], v5 offset:8192
    v_mfma_f32_32x32x16_bf16 v[144:159], a[232:235], v[104:107], v[144:159]
    ds_read_b128 a[232:235], v6 offset:8192
    v_max3_f32 v1, v128, v129, v27
    v_max3_f32 v1, v130, v131, v1
    v_max3_f32 v1, v132, v133, v1
    v_max3_f32 v1, v134, v135, v1
    v_max3_f32 v1, v136, v137, v1
    v_mfma_f32_32x32x16_bf16 v[144:159], a[236:239], v[108:111], v[144:159]
    ds_read_b128 a[236:239], v7 offset:8192
    v_max3_f32 v1, v138, v139, v1
    v_max3_f32 v1, v140, v141, v1
    v_max3_f32 v1, v142, v143, v1
    v_mov_b32 v3, v1
    v_mfma_f32_32x32x16_bf16 v[144:159], a[240:243], v[112:115], v[144:159]
    ds_read_b128 a[240:243], v8 offset:8192
    s_nop 1
    v_permlane32_swap_b32 v3, v1
    v_max_f32 v1, v1, v3
    v_sub_f32 v224, 0, v1
    v_mfma_f32_32x32x16_bf16 v[144:159], a[244:247], v[116:119], v[144:159]
    ds_read_b128 a[244:247], v9 offset:8192
    v_sub_f32 v225, 0, v1
    v_sub_f32 v226, 0, v1
    v_sub_f32 v227, 0, v1
    v_sub_f32 v228, 0, v1
    v_sub_f32 v229, 0, v1
    v_mfma_f32_32x32x16_bf16 v[144:159], a[248:251], v[120:123], v[144:159]
    ds_read_b128 a[248:251], v10 offset:8192
    v_sub_f32 v230, 0, v1
    v_sub_f32 v231, 0, v1
    v_sub_f32 v232, 0, v1
    v_sub_f32 v233, 0, v1
    v_sub_f32 v234, 0, v1
    v_sub_f32 v235, 0, v1
    v_sub_f32 v236, 0, v1
    v_sub_f32 v237, 0, v1
    v_sub_f32 v238, 0, v1
    v_sub_f32 v239, 0, v1
    v_mfma_f32_32x32x16_bf16 v[144:159], a[252:255], v[124:127], v[144:159]
    ds_read_b128 a[252:255], v11 offset:8192
    s_waitcnt lgkmcnt(7)
    v_mfma_f32_32x32x16_bf16 v[160:175], a[224:227], v[64:67], v[224:239]
    v_add_u32 v4, 4294836224, v4
    v_add_u32 v5, 4294836224, v5
    s_nop 2
    s_waitcnt lgkmcnt(6)
    v_mfma_f32_32x32x16_bf16 v[160:175], a[228:231], v[68:71], v[160:175]
    v_add_u32 v6, 4294836224, v6
    v_add_u32 v7, 4294836224, v7
    s_waitcnt lgkmcnt(5)
    v_mfma_f32_32x32x16_bf16 v[160:175], a[232:235], v[72:75], v[160:175]
    v_add_u32 v8, 4294836224, v8
    v_add_u32 v9, 4294836224, v9
    v_max3_f32 v2, v144, v145, v28
    v_max3_f32 v2, v146, v147, v2
    v_max3_f32 v2, v148, v149, v2
    v_max3_f32 v2, v150, v151, v2
    s_waitcnt lgkmcnt(4)
    v_mfma_f32_32x32x16_bf16 v[160:175], a[236:239], v[76:79], v[160:175]
    v_add_u32 v10, 4294836224, v10
    v_add_u32 v11, 4294836224, v11
    v_max3_f32 v2, v152, v153, v2
    v_max3_f32 v2, v154, v155, v2
    v_max3_f32 v2, v156, v157, v2
    v_max3_f32 v2, v158, v159, v2
    s_waitcnt lgkmcnt(3)
    v_mfma_f32_32x32x16_bf16 v[160:175], a[240:243], v[80:83], v[160:175]
    v_mov_b32 v29, v2
    s_nop 1
    v_permlane32_swap_b32 v29, v2
    v_max_f32 v2, v2, v29
    v_sub_f32 v240, 0, v2
    s_waitcnt lgkmcnt(2)
    v_mfma_f32_32x32x16_bf16 v[160:175], a[244:247], v[84:87], v[160:175]
    v_sub_f32 v241, 0, v2
    v_sub_f32 v242, 0, v2
    v_sub_f32 v243, 0, v2
    v_sub_f32 v244, 0, v2
    v_sub_f32 v245, 0, v2
    v_sub_f32 v246, 0, v2
    s_waitcnt lgkmcnt(1)
    v_mfma_f32_32x32x16_bf16 v[160:175], a[248:251], v[88:91], v[160:175]
    v_sub_f32 v247, 0, v2
    v_sub_f32 v248, 0, v2
    v_sub_f32 v249, 0, v2
    v_sub_f32 v250, 0, v2
    v_sub_f32 v251, 0, v2
    v_sub_f32 v252, 0, v2
    v_sub_f32 v253, 0, v2
    v_sub_f32 v254, 0, v2
    v_sub_f32 v255, 0, v2
    s_waitcnt lgkmcnt(0)
    v_mfma_f32_32x32x16_bf16 v[160:175], a[252:255], v[92:95], v[160:175]
    s_waitcnt vmcnt(29)
    s_barrier
    v_add_f32 v128, v128, v224
    v_add_f32 v129, v129, v224
    v_exp_f32 v128, v128
    v_mfma_f32_32x32x16_bf16 v[176:191], a[224:227], v[96:99], v[240:255]
    ds_read_b128 a[224:227], v4 offset:0
    s_add_u32 m0, s42, 131072
    s_add_u32 s46, s43, 81920
    buffer_load_dwordx4 v16, s[20:23], s46 offen lds
    v_exp_f32 v129, v129
    v_mfma_f32_32x32x16_bf16 v[176:191], a[228:231], v[100:103], v[176:191]
    ds_read_b128 a[228:231], v5 offset:0
    v_mov_b32 v21, v128
    v_cvt_pk_bf16_f32 v192, v128, v129
    v_add_f32 v21, v21, v129
    v_add_f32 v130, v130, v224
    v_add_f32 v131, v131, v224
    v_mfma_f32_32x32x16_bf16 v[176:191], a[232:235], v[104:107], v[176:191]
    ds_read_b128 a[232:235], v6 offset:0
    buffer_load_dwordx4 v17, s[20:23], s46 offen offset:1024 lds
    v_exp_f32 v130, v130
    v_exp_f32 v131, v131
    v_mfma_f32_32x32x16_bf16 v[176:191], a[236:239], v[108:111], v[176:191]
    ds_read_b128 a[236:239], v7 offset:0
    v_add_f32 v21, v21, v130
    v_cvt_pk_bf16_f32 v193, v130, v131
    v_add_f32 v21, v21, v131
    v_add_f32 v132, v132, v224
    v_add_f32 v133, v133, v224
    v_mfma_f32_32x32x16_bf16 v[176:191], a[240:243], v[112:115], v[176:191]
    ds_read_b128 a[240:243], v8 offset:0
    buffer_load_dwordx4 v18, s[20:23], s46 offen offset:2048 lds
    v_exp_f32 v132, v132
    v_exp_f32 v133, v133
    v_mfma_f32_32x32x16_bf16 v[176:191], a[244:247], v[116:119], v[176:191]
    ds_read_b128 a[244:247], v9 offset:0
    v_add_f32 v21, v21, v132
    v_cvt_pk_bf16_f32 v194, v132, v133
    v_add_f32 v21, v21, v133
    v_add_f32 v134, v134, v224
    v_add_f32 v135, v135, v224
    v_mfma_f32_32x32x16_bf16 v[176:191], a[248:251], v[120:123], v[176:191]
    ds_read_b128 a[248:251], v10 offset:0
    buffer_load_dwordx4 v19, s[20:23], s46 offen offset:3072 lds
    v_exp_f32 v134, v134
    v_exp_f32 v135, v135
    v_mfma_f32_32x32x16_bf16 v[176:191], a[252:255], v[124:127], v[176:191]
    ds_read_b128 a[252:255], v11 offset:0
    v_add_f32 v21, v21, v134
    v_cvt_pk_bf16_f32 v195, v134, v135
    v_add_f32 v21, v21, v135
    v_add_f32 v136, v136, v224
    v_add_f32 v137, v137, v224
    v_exp_f32 v136, v136
    v_exp_f32 v137, v137
    v_add_f32 v21, v21, v136
    v_cvt_pk_bf16_f32 v196, v136, v137
    v_add_f32 v21, v21, v137
    v_add_f32 v138, v138, v224
    v_add_f32 v139, v139, v224
    v_exp_f32 v138, v138
    v_exp_f32 v139, v139
    v_add_f32 v21, v21, v138
    v_cvt_pk_bf16_f32 v197, v138, v139
    v_add_f32 v21, v21, v139
    v_add_f32 v140, v140, v224
    v_add_f32 v141, v141, v224
    v_exp_f32 v140, v140
    v_exp_f32 v141, v141
    v_add_f32 v21, v21, v140
    v_cvt_pk_bf16_f32 v198, v140, v141
    v_add_f32 v21, v21, v141
    v_add_f32 v142, v142, v224
    v_add_f32 v143, v143, v224
    v_exp_f32 v142, v142
    v_exp_f32 v143, v143
    v_add_f32 v21, v21, v142
    v_cvt_pk_bf16_f32 v199, v142, v143
    v_add_f32 v21, v21, v143
    v_add_f32 v144, v144, v240
    v_add_f32 v145, v145, v240
    v_exp_f32 v144, v144
    v_exp_f32 v145, v145
    v_mov_b32 v22, v144
    v_cvt_pk_bf16_f32 v200, v144, v145
    v_add_f32 v22, v22, v145
    v_add_f32 v146, v146, v240
    v_add_f32 v147, v147, v240
    v_exp_f32 v146, v146
    v_exp_f32 v147, v147
    v_add_f32 v22, v22, v146
    v_cvt_pk_bf16_f32 v201, v146, v147
    v_add_f32 v22, v22, v147
    v_add_f32 v148, v148, v240
    v_add_f32 v149, v149, v240
    v_exp_f32 v148, v148
    v_exp_f32 v149, v149
    v_add_f32 v22, v22, v148
    v_cvt_pk_bf16_f32 v202, v148, v149
    v_add_f32 v22, v22, v149
    v_add_f32 v150, v150, v240
    v_add_f32 v151, v151, v240
    v_exp_f32 v150, v150
    v_exp_f32 v151, v151
    v_add_f32 v22, v22, v150
    v_cvt_pk_bf16_f32 v203, v150, v151
    v_add_f32 v22, v22, v151
    v_add_f32 v152, v152, v240
    v_add_f32 v153, v153, v240
    v_exp_f32 v152, v152
    v_exp_f32 v153, v153
    v_add_f32 v22, v22, v152
    v_cvt_pk_bf16_f32 v204, v152, v153
    v_add_f32 v22, v22, v153
    v_add_f32 v154, v154, v240
    v_add_f32 v155, v155, v240
    v_exp_f32 v154, v154
    v_exp_f32 v155, v155
    v_add_f32 v22, v22, v154
    v_cvt_pk_bf16_f32 v205, v154, v155
    v_add_f32 v22, v22, v155
    v_add_f32 v156, v156, v240
    v_add_f32 v157, v157, v240
    v_exp_f32 v156, v156
    v_exp_f32 v157, v157
    v_add_f32 v22, v22, v156
    v_cvt_pk_bf16_f32 v206, v156, v157
    v_add_f32 v22, v22, v157
    v_add_f32 v158, v158, v240
    v_add_f32 v159, v159, v240
    v_exp_f32 v158, v158
    v_exp_f32 v159, v159
    v_add_f32 v22, v22, v158
    v_cvt_pk_bf16_f32 v207, v158, v159
    v_add_f32 v22, v22, v159
    s_waitcnt lgkmcnt(7)
    v_mfma_f32_32x32x16_bf16 v[128:143], a[224:227], v[64:67], v[224:239]
    v_lshrrev_b32 v27, 5, v0
    v_and_b32 v27, 16, v27
    v_add_u32 v27, s35, v27
    ds_read_b128 v[48:51], v27 offset:512
    ds_read_b128 v[52:55], v27 offset:576
    s_waitcnt lgkmcnt(8)
    v_mfma_f32_32x32x16_bf16 v[128:143], a[228:231], v[68:71], v[128:143]
    v_lshlrev_b32 v28, 3, v0
    v_exp_f32 v160, v160
    v_accvgpr_read_b32 v60, a0
    v_accvgpr_read_b32 v1, a8
    s_waitcnt lgkmcnt(7)
    v_mfma_f32_32x32x16_bf16 v[128:143], a[232:235], v[72:75], v[128:143]
    v_exp_f32 v161, v161
    v_accvgpr_read_b32 v61, a1
    v_add_f32 v21, v21, v160
    v_accvgpr_read_b32 v2, a9
    v_cvt_pk_bf16_f32 v208, v160, v161
    v_add_f32 v21, v21, v161
    v_accvgpr_read_b32 v62, a2
    s_waitcnt lgkmcnt(6)
    v_mfma_f32_32x32x16_bf16 v[128:143], a[236:239], v[76:79], v[128:143]
    v_exp_f32 v162, v162
    v_accvgpr_read_b32 v3, a10
    v_exp_f32 v163, v163
    v_accvgpr_read_b32 v63, a3
    s_waitcnt lgkmcnt(5)
    v_mfma_f32_32x32x16_bf16 v[128:143], a[240:243], v[80:83], v[128:143]
    v_accvgpr_read_b32 v29, a11
    v_add_f32 v21, v21, v162
    v_cvt_pk_bf16_f32 v209, v162, v163
    s_waitcnt lgkmcnt(1)
    v_mul_f32 v48, v48, v23
    v_add_f32 v21, v21, v163
    s_waitcnt lgkmcnt(0)
    v_mul_f32 v52, v52, v23
    v_mfma_f32_32x32x16_bf16 v[128:143], a[244:247], v[84:87], v[128:143]
    v_exp_f32 v164, v164
    v_mul_f32 v49, v49, v23
    v_exp_f32 v165, v165
    v_mul_f32 v53, v53, v23
    v_add_f32 v21, v21, v164
    v_mul_f32 v50, v50, v23
    v_mfma_f32_32x32x16_bf16 v[128:143], a[248:251], v[88:91], v[128:143]
    v_cvt_pk_bf16_f32 v210, v164, v165
    v_mul_f32 v54, v54, v23
    v_add_f32 v21, v21, v165
    v_exp_f32 v166, v166
    v_mul_f32 v51, v51, v23
    v_mul_f32 v55, v55, v23
    v_mfma_f32_32x32x16_bf16 v[128:143], a[252:255], v[92:95], v[128:143]
    v_exp_f32 v167, v167
    v_fmac_f32 v48, v60, v30
    v_add_f32 v21, v21, v166
    v_fmac_f32 v52, v1, v25
    v_cvt_pk_bf16_f32 v211, v166, v167
    v_add_f32 v21, v21, v167
    v_mfma_f32_32x32x16_bf16 v[144:159], a[224:227], v[96:99], v[240:255]
    v_fmac_f32 v49, v61, v30
    v_exp_f32 v168, v168
    v_fmac_f32 v53, v2, v25
    v_exp_f32 v169, v169
    v_fmac_f32 v50, v62, v30
    v_mfma_f32_32x32x16_bf16 v[144:159], a[228:231], v[100:103], v[144:159]
    ds_read_b64_tr_b16 v[32:33], v12 offset:0
    v_fmac_f32 v54, v3, v25
    v_add_f32 v21, v21, v168
    v_cvt_pk_bf16_f32 v212, v168, v169
    v_fmac_f32 v51, v63, v30
    v_add_f32 v21, v21, v169
    v_mfma_f32_32x32x16_bf16 v[144:159], a[232:235], v[104:107], v[144:159]
    ds_read_b64_tr_b16 v[34:35], v12 offset:2048
    v_fmac_f32 v55, v29, v25
    v_exp_f32 v170, v170
    v_exp_f32 v60, v48
    v_mfma_f32_32x32x16_bf16 v[144:159], a[236:239], v[108:111], v[144:159]
    ds_read_b64_tr_b16 v[36:37], v13 offset:0
    v_exp_f32 v171, v171
    v_add_f32 v21, v21, v170
    v_exp_f32 v61, v49
    v_cvt_pk_bf16_f32 v213, v170, v171
    v_add_f32 v21, v21, v171
    v_mfma_f32_32x32x16_bf16 v[144:159], a[240:243], v[112:115], v[144:159]
    ds_read_b64_tr_b16 v[38:39], v13 offset:2048
    v_exp_f32 v172, v172
    v_exp_f32 v62, v50
    v_exp_f32 v173, v173
    v_mfma_f32_32x32x16_bf16 v[144:159], a[244:247], v[116:119], v[144:159]
    ds_read_b64_tr_b16 v[40:41], v14 offset:0
    v_exp_f32 v63, v51
    v_add_f32 v21, v21, v172
    v_cvt_pk_bf16_f32 v214, v172, v173
    v_add_f32 v21, v21, v173
    v_add_f32 v60, 1.0, v60
    v_mfma_f32_32x32x16_bf16 v[144:159], a[248:251], v[120:123], v[144:159]
    ds_read_b64_tr_b16 v[42:43], v14 offset:2048
    v_exp_f32 v174, v174
    v_add_f32 v61, 1.0, v61
    v_exp_f32 v175, v175
    v_add_f32 v62, 1.0, v62
    v_mfma_f32_32x32x16_bf16 v[144:159], a[252:255], v[124:127], v[144:159]
    ds_read_b64_tr_b16 v[44:45], v15 offset:0
    v_add_f32 v63, 1.0, v63
    v_add_f32 v21, v21, v174
    v_cvt_pk_bf16_f32 v215, v174, v175
    v_rcp_f32 v60, v60
    v_add_f32 v21, v21, v175
    s_waitcnt lgkmcnt(5)
    v_mfma_f32_32x32x16_bf16 a[96:111], v[32:35], v[192:195], 0
    ds_read_b64_tr_b16 v[46:47], v15 offset:2048
    v_exp_f32 v176, v176
    v_rcp_f32 v61, v61
    v_mfma_f32_32x32x16_bf16 a[160:175], v[32:35], v[200:203], 0
    ds_read_b64_tr_b16 v[32:33], v12 offset:4096
    v_exp_f32 v177, v177
    v_add_f32 v22, v22, v176
    v_rcp_f32 v62, v62
    v_cvt_pk_bf16_f32 v216, v176, v177
    v_add_f32 v22, v22, v177
    s_waitcnt lgkmcnt(5)
    v_mfma_f32_32x32x16_bf16 a[112:127], v[36:39], v[192:195], 0
    ds_read_b64_tr_b16 v[34:35], v12 offset:6144
    v_exp_f32 v178, v178
    v_rcp_f32 v63, v63
    v_exp_f32 v179, v179
    v_mfma_f32_32x32x16_bf16 a[176:191], v[36:39], v[200:203], 0
    ds_read_b64_tr_b16 v[36:37], v13 offset:4096
    v_mul_f32 v1, v60, v52
    v_add_f32 v22, v22, v178
    v_cvt_pk_bf16_f32 v217, v178, v179
    v_mul_f32 v2, v61, v53
    v_add_f32 v22, v22, v179
    v_mul_f32 v3, v62, v54
    s_waitcnt lgkmcnt(5)
    v_mfma_f32_32x32x16_bf16 a[128:143], v[40:43], v[192:195], 0
    ds_read_b64_tr_b16 v[38:39], v13 offset:6144
    v_exp_f32 v180, v180
    v_mul_f32 v29, v63, v55
    v_exp_f32 v181, v181
    v_mfma_f32_32x32x16_bf16 a[192:207], v[40:43], v[200:203], 0
    ds_read_b64_tr_b16 v[40:41], v14 offset:4096
    ds_read_b128 v[48:51], v27 offset:544
    ds_read_b128 v[52:55], v27 offset:608
    v_add_f32 v22, v22, v180
    v_cvt_pk_bf16_f32 v218, v180, v181
    v_cvt_pk_bf16_f32 v56, v1, v2
    v_add_f32 v22, v22, v181
    s_waitcnt lgkmcnt(7)
    v_mfma_f32_32x32x16_bf16 a[144:159], v[44:47], v[192:195], 0
    ds_read_b64_tr_b16 v[42:43], v14 offset:6144
    v_exp_f32 v182, v182
    v_cvt_pk_bf16_f32 v57, v3, v29
    v_accvgpr_read_b32 v60, a4
    v_exp_f32 v183, v183
    v_mfma_f32_32x32x16_bf16 a[208:223], v[44:47], v[200:203], 0
    ds_read_b64_tr_b16 v[44:45], v15 offset:4096
    v_accvgpr_read_b32 v1, a12
    v_add_f32 v22, v22, v182
    v_accvgpr_read_b32 v61, a5
    v_cvt_pk_bf16_f32 v219, v182, v183
    v_add_f32 v22, v22, v183
    v_accvgpr_read_b32 v2, a13
    s_waitcnt lgkmcnt(7)
    v_mfma_f32_32x32x16_bf16 a[96:111], v[32:35], v[196:199], a[96:111]
    ds_read_b64_tr_b16 v[46:47], v15 offset:6144
    ds_read_b128 a[224:227], v4 offset:8192
    v_exp_f32 v184, v184
    v_accvgpr_read_b32 v62, a6
    v_exp_f32 v185, v185
    v_mfma_f32_32x32x16_bf16 a[160:175], v[32:35], v[204:207], a[160:175]
    ds_read_b128 a[228:231], v5 offset:8192
    v_accvgpr_read_b32 v3, a14
    v_accvgpr_read_b32 v63, a7
    v_add_f32 v22, v22, v184
    v_cvt_pk_bf16_f32 v220, v184, v185
    v_accvgpr_read_b32 v29, a15
    v_add_f32 v22, v22, v185
    s_waitcnt lgkmcnt(8)
    v_mfma_f32_32x32x16_bf16 a[112:127], v[36:39], v[196:199], a[112:127]
    ds_read_b128 a[232:235], v6 offset:8192
    s_waitcnt lgkmcnt(7)
    v_mul_f32 v48, v48, v23
    v_exp_f32 v186, v186
    s_waitcnt lgkmcnt(6)
    v_mul_f32 v52, v52, v23
    v_exp_f32 v187, v187
    v_mfma_f32_32x32x16_bf16 a[176:191], v[36:39], v[204:207], a[176:191]
    ds_read_b128 a[236:239], v7 offset:8192
    v_mul_f32 v49, v49, v23
    v_add_f32 v22, v22, v186
    v_mul_f32 v53, v53, v23
    v_cvt_pk_bf16_f32 v221, v186, v187
    v_mul_f32 v50, v50, v23
    v_add_f32 v22, v22, v187
    s_waitcnt lgkmcnt(6)
    v_mfma_f32_32x32x16_bf16 a[128:143], v[40:43], v[196:199], a[128:143]
    ds_read_b128 a[240:243], v8 offset:8192
    v_exp_f32 v188, v188
    v_mul_f32 v54, v54, v23
    v_mul_f32 v51, v51, v23
    v_mfma_f32_32x32x16_bf16 a[192:207], v[40:43], v[204:207], a[192:207]
    ds_read_b128 a[244:247], v9 offset:8192
    v_exp_f32 v189, v189
    v_mul_f32 v55, v55, v23
    v_add_f32 v22, v22, v188
    v_fmac_f32 v48, v60, v30
    v_cvt_pk_bf16_f32 v222, v188, v189
    v_add_f32 v22, v22, v189
    s_waitcnt lgkmcnt(6)
    v_mfma_f32_32x32x16_bf16 a[144:159], v[44:47], v[196:199], a[144:159]
    ds_read_b128 a[248:251], v10 offset:8192
    v_fmac_f32 v52, v1, v25
    v_exp_f32 v190, v190
    v_fmac_f32 v49, v61, v30
    v_exp_f32 v191, v191
    v_mfma_f32_32x32x16_bf16 a[208:223], v[44:47], v[204:207], a[208:223]
    ds_read_b128 a[252:255], v11 offset:8192
    v_fmac_f32 v53, v2, v25
    v_fmac_f32 v50, v62, v30
    v_add_f32 v22, v22, v190
    v_cvt_pk_bf16_f32 v223, v190, v191
    v_fmac_f32 v54, v3, v25
    v_add_f32 v22, v22, v191
    s_waitcnt lgkmcnt(7)
    v_mfma_f32_32x32x16_bf16 v[160:175], a[224:227], v[64:67], v[224:239]
    v_add_u32 v4, 65536, v4
    v_exp_f32 v128, v128
    v_fmac_f32 v51, v63, v30
    v_fmac_f32 v55, v29, v25
    v_exp_f32 v129, v129
    s_waitcnt lgkmcnt(6)
    v_mfma_f32_32x32x16_bf16 v[160:175], a[228:231], v[68:71], v[160:175]
    v_add_u32 v5, 65536, v5
    v_exp_f32 v60, v48
    v_add_f32 v21, v21, v128
    v_cvt_pk_bf16_f32 v192, v128, v129
    v_exp_f32 v61, v49
    v_add_f32 v21, v21, v129
    s_waitcnt lgkmcnt(5)
    v_mfma_f32_32x32x16_bf16 v[160:175], a[232:235], v[72:75], v[160:175]
    v_add_u32 v6, 65536, v6
    v_exp_f32 v130, v130
    v_exp_f32 v62, v50
    v_exp_f32 v131, v131
    s_waitcnt lgkmcnt(4)
    v_mfma_f32_32x32x16_bf16 v[160:175], a[236:239], v[76:79], v[160:175]
    v_add_u32 v7, 65536, v7
    v_exp_f32 v63, v51
    v_add_f32 v21, v21, v130
    v_cvt_pk_bf16_f32 v193, v130, v131
    v_add_f32 v21, v21, v131
    v_add_f32 v60, 1.0, v60
    s_waitcnt lgkmcnt(3)
    v_mfma_f32_32x32x16_bf16 v[160:175], a[240:243], v[80:83], v[160:175]
    v_add_u32 v8, 65536, v8
    v_exp_f32 v132, v132
    v_add_f32 v61, 1.0, v61
    v_add_f32 v62, 1.0, v62
    v_exp_f32 v133, v133
    v_add_f32 v63, 1.0, v63
    s_waitcnt lgkmcnt(2)
    v_mfma_f32_32x32x16_bf16 v[160:175], a[244:247], v[84:87], v[160:175]
    v_add_u32 v9, 65536, v9
    v_add_f32 v21, v21, v132
    v_rcp_f32 v60, v60
    v_cvt_pk_bf16_f32 v194, v132, v133
    v_add_f32 v21, v21, v133
    s_waitcnt lgkmcnt(1)
    v_mfma_f32_32x32x16_bf16 v[160:175], a[248:251], v[88:91], v[160:175]
    v_add_u32 v10, 65536, v10
    v_rcp_f32 v61, v61
    v_exp_f32 v134, v134
    v_exp_f32 v135, v135
    v_rcp_f32 v62, v62
    s_waitcnt lgkmcnt(0)
    v_mfma_f32_32x32x16_bf16 v[160:175], a[252:255], v[92:95], v[160:175]
    v_add_u32 v11, 65536, v11
    v_add_f32 v21, v21, v134
    v_cvt_pk_bf16_f32 v195, v134, v135
    v_rcp_f32 v63, v63
    v_add_f32 v21, v21, v135
    v_mfma_f32_32x32x16_bf16 v[176:191], a[224:227], v[96:99], v[240:255]
    v_exp_f32 v136, v136
    v_mul_f32 v1, v60, v52
    v_mul_f32 v2, v61, v53
    v_exp_f32 v137, v137
    v_mul_f32 v3, v62, v54
    v_add_f32 v21, v21, v136
    v_mfma_f32_32x32x16_bf16 v[176:191], a[228:231], v[100:103], v[176:191]
    ds_read_b64_tr_b16 v[32:33], v12 offset:8192
    v_mul_f32 v29, v63, v55
    v_cvt_pk_bf16_f32 v196, v136, v137
    ds_read_b128 v[48:51], v27 offset:512
    ds_read_b128 v[52:55], v27 offset:576
    v_add_f32 v21, v21, v137
    v_exp_f32 v138, v138
    v_mfma_f32_32x32x16_bf16 v[176:191], a[232:235], v[104:107], v[176:191]
    ds_read_b64_tr_b16 v[34:35], v12 offset:10240
    v_cvt_pk_bf16_f32 v58, v1, v2
    v_exp_f32 v139, v139
    v_cvt_pk_bf16_f32 v59, v3, v29
    v_add_f32 v21, v21, v138
    v_mfma_f32_32x32x16_bf16 v[176:191], a[236:239], v[108:111], v[176:191]
    ds_read_b64_tr_b16 v[36:37], v13 offset:8192
    s_cmp_ge_u32 s63, 29
    s_cbranch_scc1 K1_HS1
    s_add_u32 s47, s56, 0
    buffer_store_dwordx4 v[56:59], v0, s[28:31], s47 offen offset:0 sc1
K1_HS1:
    v_cvt_pk_bf16_f32 v197, v138, v139
    v_add_f32 v21, v21, v139
    v_exp_f32 v140, v140
    v_mfma_f32_32x32x16_bf16 v[176:191], a[240:243], v[112:115], v[176:191]
    ds_read_b64_tr_b16 v[38:39], v13 offset:10240
    v_exp_f32 v141, v141
    v_accvgpr_read_b32 v60, a48
    v_accvgpr_read_b32 v1, a56
    v_add_f32 v21, v21, v140
    v_accvgpr_read_b32 v61, a49
    v_mfma_f32_32x32x16_bf16 v[176:191], a[244:247], v[116:119], v[176:191]
    ds_read_b64_tr_b16 v[40:41], v14 offset:8192
    v_cvt_pk_bf16_f32 v198, v140, v141
    v_add_f32 v21, v21, v141
    v_accvgpr_read_b32 v2, a57
    v_exp_f32 v142, v142
    v_accvgpr_read_b32 v62, a50
    v_mfma_f32_32x32x16_bf16 v[176:191], a[248:251], v[120:123], v[176:191]
    ds_read_b64_tr_b16 v[42:43], v14 offset:10240
    v_accvgpr_read_b32 v3, a58
    v_exp_f32 v143, v143
    v_accvgpr_read_b32 v63, a51
    v_add_f32 v21, v21, v142
    v_accvgpr_read_b32 v29, a59
    v_cvt_pk_bf16_f32 v199, v142, v143
    v_mfma_f32_32x32x16_bf16 v[176:191], a[252:255], v[124:127], v[176:191]
    ds_read_b64_tr_b16 v[44:45], v15 offset:8192
    s_waitcnt lgkmcnt(7)
    v_mul_f32 v48, v48, v24
    v_add_f32 v21, v21, v143
    v_exp_f32 v144, v144
    s_waitcnt lgkmcnt(6)
    v_mul_f32 v52, v52, v24
    v_mul_f32 v49, v49, v24
    s_waitcnt lgkmcnt(5)
    v_mfma_f32_32x32x16_bf16 a[96:111], v[32:35], v[208:211], a[96:111]
    ds_read_b64_tr_b16 v[46:47], v15 offset:10240
    v_exp_f32 v145, v145
    v_mul_f32 v53, v53, v24
    v_mul_f32 v50, v50, v24
    v_add_f32 v22, v22, v144
    v_cvt_pk_bf16_f32 v200, v144, v145
    v_mfma_f32_32x32x16_bf16 a[160:175], v[32:35], v[216:219], a[160:175]
    ds_read_b64_tr_b16 v[32:33], v12 offset:12288
    v_mul_f32 v54, v54, v24
    v_add_f32 v22, v22, v145
    v_mul_f32 v51, v51, v24
    v_exp_f32 v146, v146
    v_mul_f32 v55, v55, v24
    s_waitcnt lgkmcnt(5)
    v_mfma_f32_32x32x16_bf16 a[112:127], v[36:39], v[208:211], a[112:127]
    ds_read_b64_tr_b16 v[34:35], v12 offset:14336
    v_exp_f32 v147, v147
    v_fmac_f32 v48, v60, v31
    v_fmac_f32 v52, v1, v26
    v_add_f32 v22, v22, v146
    v_fmac_f32 v49, v61, v31
    v_cvt_pk_bf16_f32 v201, v146, v147
    v_mfma_f32_32x32x16_bf16 a[176:191], v[36:39], v[216:219], a[176:191]
    ds_read_b64_tr_b16 v[36:37], v13 offset:12288
    v_add_f32 v22, v22, v147
    v_fmac_f32 v53, v2, v26
    v_exp_f32 v148, v148
    v_fmac_f32 v50, v62, v31
    v_fmac_f32 v54, v3, v26
    s_waitcnt lgkmcnt(5)
    v_mfma_f32_32x32x16_bf16 a[128:143], v[40:43], v[208:211], a[128:143]
    ds_read_b64_tr_b16 v[38:39], v13 offset:14336
    v_exp_f32 v149, v149
    v_fmac_f32 v51, v63, v31
    v_add_f32 v22, v22, v148
    v_fmac_f32 v55, v29, v26
    v_cvt_pk_bf16_f32 v202, v148, v149
    v_mfma_f32_32x32x16_bf16 a[192:207], v[40:43], v[216:219], a[192:207]
    ds_read_b64_tr_b16 v[40:41], v14 offset:12288
    v_exp_f32 v60, v48
    v_add_f32 v22, v22, v149
    v_exp_f32 v150, v150
    v_exp_f32 v61, v49
    s_waitcnt lgkmcnt(5)
    v_mfma_f32_32x32x16_bf16 a[144:159], v[44:47], v[208:211], a[144:159]
    ds_read_b64_tr_b16 v[42:43], v14 offset:14336
    v_exp_f32 v151, v151
    v_exp_f32 v62, v50
    v_add_f32 v22, v22, v150
    v_cvt_pk_bf16_f32 v203, v150, v151
    v_add_f32 v22, v22, v151
    v_mfma_f32_32x32x16_bf16 a[208:223], v[44:47], v[216:219], a[208:223]
    ds_read_b64_tr_b16 v[44:45], v15 offset:12288
    s_waitcnt vmcnt(16)
    s_barrier
    v_exp_f32 v63, v51
    v_exp_f32 v152, v152
    s_waitcnt lgkmcnt(5)
    v_mfma_f32_32x32x16_bf16 a[96:111], v[32:35], v[212:215], a[96:111]
    ds_read_b64_tr_b16 v[46:47], v15 offset:14336
    ds_read_b128 a[224:227], v4 offset:0
    v_add_f32 v60, 1.0, v60
    v_exp_f32 v153, v153
    v_add_f32 v61, 1.0, v61
    v_add_f32 v22, v22, v152
    v_mfma_f32_32x32x16_bf16 a[160:175], v[32:35], v[220:223], a[160:175]
    ds_read_b128 a[228:231], v5 offset:0
    v_add_u32 v12, 32768, v12
    v_add_f32 v62, 1.0, v62
    v_cvt_pk_bf16_f32 v204, v152, v153
    v_add_f32 v63, 1.0, v63
    v_add_f32 v22, v22, v153
    v_exp_f32 v154, v154
    s_waitcnt lgkmcnt(6)
    v_mfma_f32_32x32x16_bf16 a[112:127], v[36:39], v[212:215], a[112:127]
    ds_read_b128 a[232:235], v6 offset:0
    v_add_u32 v13, 32768, v13
    v_rcp_f32 v60, v60
    v_exp_f32 v155, v155
    v_mfma_f32_32x32x16_bf16 a[176:191], v[36:39], v[220:223], a[176:191]
    ds_read_b128 a[236:239], v7 offset:0
    v_add_u32 v14, 32768, v14
    v_rcp_f32 v61, v61
    v_add_f32 v22, v22, v154
    v_cvt_pk_bf16_f32 v205, v154, v155
    v_rcp_f32 v62, v62
    v_add_f32 v22, v22, v155
    s_waitcnt lgkmcnt(6)
    v_mfma_f32_32x32x16_bf16 a[128:143], v[40:43], v[212:215], a[128:143]
    ds_read_b128 a[240:243], v8 offset:0
    v_add_u32 v15, 32768, v15
    v_exp_f32 v156, v156
    v_rcp_f32 v63, v63
    v_mfma_f32_32x32x16_bf16 a[192:207], v[40:43], v[220:223], a[192:207]
    ds_read_b128 a[244:247], v9 offset:0
    v_exp_f32 v157, v157
    v_mul_f32 v1, v60, v52
    v_add_f32 v22, v22, v156
    v_mul_f32 v2, v61, v53
    v_cvt_pk_bf16_f32 v206, v156, v157
    v_add_f32 v22, v22, v157
    s_waitcnt lgkmcnt(6)
    v_mfma_f32_32x32x16_bf16 a[144:159], v[44:47], v[212:215], a[144:159]
    ds_read_b128 a[248:251], v10 offset:0
    v_mul_f32 v3, v62, v54
    v_exp_f32 v158, v158
    v_mul_f32 v29, v63, v55
    ds_read_b128 v[48:51], v27 offset:544
    ds_read_b128 v[52:55], v27 offset:608
    v_mfma_f32_32x32x16_bf16 a[208:223], v[44:47], v[220:223], a[208:223]
    ds_read_b128 a[252:255], v11 offset:0
    v_exp_f32 v159, v159
    v_add_f32 v22, v22, v158
    v_cvt_pk_bf16_f32 v56, v1, v2
    v_cvt_pk_bf16_f32 v207, v158, v159
    v_cvt_pk_bf16_f32 v57, v3, v29
    v_add_f32 v22, v22, v159
    s_waitcnt lgkmcnt(9)
    v_mfma_f32_32x32x16_bf16 v[128:143], a[224:227], v[64:67], v[224:239]
    v_exp_f32 v160, v160
    v_accvgpr_read_b32 v60, a52
    v_accvgpr_read_b32 v1, a60
    v_exp_f32 v161, v161
    v_accvgpr_read_b32 v61, a53
    s_waitcnt lgkmcnt(8)
    v_mfma_f32_32x32x16_bf16 v[128:143], a[228:231], v[68:71], v[128:143]
    s_add_u32 m0, s42, 0
    s_add_u32 s46, s43, 65536
    buffer_load_dwordx4 v20, s[24:27], s46 offen lds
    v_add_f32 v21, v21, v160
    v_accvgpr_read_b32 v2, a61
    v_cvt_pk_bf16_f32 v208, v160, v161
    v_accvgpr_read_b32 v62, a54
    s_waitcnt lgkmcnt(7)
    v_mfma_f32_32x32x16_bf16 v[128:143], a[232:235], v[72:75], v[128:143]
    v_add_f32 v21, v21, v161
    v_exp_f32 v162, v162
    v_accvgpr_read_b32 v3, a62
    v_accvgpr_read_b32 v63, a55
    v_exp_f32 v163, v163
    s_waitcnt lgkmcnt(6)
    v_mfma_f32_32x32x16_bf16 v[128:143], a[236:239], v[76:79], v[128:143]
    buffer_load_dwordx4 v20, s[24:27], s46 offen offset:1024 lds
    v_accvgpr_read_b32 v29, a63
    v_add_f32 v21, v21, v162
    s_waitcnt lgkmcnt(2)
    v_mul_f32 v48, v48, v24
    v_cvt_pk_bf16_f32 v209, v162, v163
    v_add_f32 v21, v21, v163
    s_waitcnt lgkmcnt(1)
    v_mul_f32 v52, v52, v24
    v_mfma_f32_32x32x16_bf16 v[128:143], a[240:243], v[80:83], v[128:143]
    v_exp_f32 v164, v164
    v_mul_f32 v49, v49, v24
    v_exp_f32 v165, v165
    v_mul_f32 v53, v53, v24
    v_mul_f32 v50, v50, v24
    v_mfma_f32_32x32x16_bf16 v[128:143], a[244:247], v[84:87], v[128:143]
    buffer_load_dwordx4 v20, s[24:27], s46 offen offset:2048 lds
    v_add_f32 v21, v21, v164
    v_mul_f32 v54, v54, v24
    v_cvt_pk_bf16_f32 v210, v164, v165
    v_add_f32 v21, v21, v165
    v_mul_f32 v51, v51, v24
    v_mfma_f32_32x32x16_bf16 v[128:143], a[248:251], v[88:91], v[128:143]
    v_exp_f32 v166, v166
    v_mul_f32 v55, v55, v24
    v_exp_f32 v167, v167
    v_fmac_f32 v48, v60, v31
    v_fmac_f32 v52, v1, v26
    v_add_f32 v21, v21, v166
    s_waitcnt lgkmcnt(0)
    v_mfma_f32_32x32x16_bf16 v[128:143], a[252:255], v[92:95], v[128:143]
    buffer_load_dwordx4 v20, s[24:27], s46 offen offset:3072 lds
    v_cvt_pk_bf16_f32 v211, v166, v167
    v_fmac_f32 v49, v61, v31
    v_add_f32 v21, v21, v167
    v_fmac_f32 v53, v2, v26
    v_exp_f32 v168, v168
    v_fmac_f32 v50, v62, v31
    v_mfma_f32_32x32x16_bf16 v[144:159], a[224:227], v[96:99], v[240:255]
    v_exp_f32 v169, v169
    v_fmac_f32 v54, v3, v26
    v_add_f32 v21, v21, v168
    v_fmac_f32 v51, v63, v31
    v_cvt_pk_bf16_f32 v212, v168, v169
    v_fmac_f32 v55, v29, v26
    v_mfma_f32_32x32x16_bf16 v[144:159], a[228:231], v[100:103], v[144:159]
    ds_read_b64_tr_b16 v[32:33], v12 offset:0
    v_add_f32 v21, v21, v169
    v_exp_f32 v60, v48
    v_exp_f32 v170, v170
    v_mfma_f32_32x32x16_bf16 v[144:159], a[232:235], v[104:107], v[144:159]
    ds_read_b64_tr_b16 v[34:35], v12 offset:2048
    v_exp_f32 v171, v171
    v_exp_f32 v61, v49
    v_add_f32 v21, v21, v170
    v_cvt_pk_bf16_f32 v213, v170, v171
    v_mfma_f32_32x32x16_bf16 v[144:159], a[236:239], v[108:111], v[144:159]
    ds_read_b64_tr_b16 v[36:37], v13 offset:0
    v_exp_f32 v62, v50
    v_add_f32 v21, v21, v171
    v_exp_f32 v172, v172
    v_exp_f32 v63, v51
    v_mfma_f32_32x32x16_bf16 v[144:159], a[240:243], v[112:115], v[144:159]
    ds_read_b64_tr_b16 v[38:39], v13 offset:2048
    v_exp_f32 v173, v173
    v_add_f32 v21, v21, v172
    v_add_f32 v60, 1.0, v60
    v_cvt_pk_bf16_f32 v214, v172, v173
    v_add_f32 v21, v21, v173
    v_mfma_f32_32x32x16_bf16 v[144:159], a[244:247], v[116:119], v[144:159]
    ds_read_b64_tr_b16 v[40:41], v14 offset:0
    v_add_f32 v61, 1.0, v61
    v_exp_f32 v174, v174
    v_add_f32 v62, 1.0, v62
    v_add_f32 v63, 1.0, v63
    v_mfma_f32_32x32x16_bf16 v[144:159], a[248:251], v[120:123], v[144:159]
    ds_read_b64_tr_b16 v[42:43], v14 offset:2048
    v_exp_f32 v175, v175
    v_rcp_f32 v60, v60
    v_add_f32 v21, v21, v174
    v_cvt_pk_bf16_f32 v215, v174, v175
    v_add_f32 v21, v21, v175
    v_mfma_f32_32x32x16_bf16 v[144:159], a[252:255], v[124:127], v[144:159]
    ds_read_b64_tr_b16 v[44:45], v15 offset:0
    v_rcp_f32 v61, v61
    v_exp_f32 v176, v176
    v_exp_f32 v177, v177
    s_waitcnt lgkmcnt(5)
    v_mfma_f32_32x32x16_bf16 a[96:111], v[32:35], v[192:195], a[96:111]
    ds_read_b64_tr_b16 v[46:47], v15 offset:2048
    v_rcp_f32 v62, v62
    v_add_f32 v22, v22, v176
    v_cvt_pk_bf16_f32 v216, v176, v177
    v_rcp_f32 v63, v63
    v_mfma_f32_32x32x16_bf16 a[160:175], v[32:35], v[200:203], a[160:175]
    ds_read_b64_tr_b16 v[32:33], v12 offset:4096
    v_add_f32 v22, v22, v177
    v_exp_f32 v178, v178
    v_mul_f32 v1, v60, v52
    v_exp_f32 v179, v179
    s_waitcnt lgkmcnt(5)
    v_mfma_f32_32x32x16_bf16 a[112:127], v[36:39], v[192:195], a[112:127]
    ds_read_b64_tr_b16 v[34:35], v12 offset:6144
    v_mul_f32 v2, v61, v53
    v_mul_f32 v3, v62, v54
    v_add_f32 v22, v22, v178
    v_cvt_pk_bf16_f32 v217, v178, v179
    v_mul_f32 v29, v63, v55
    v_add_f32 v22, v22, v179
    v_mfma_f32_32x32x16_bf16 a[176:191], v[36:39], v[200:203], a[176:191]
    ds_read_b64_tr_b16 v[36:37], v13 offset:4096
    ds_read_b128 v[48:51], v27 offset:640
    ds_read_b128 v[52:55], v27 offset:704
    v_exp_f32 v180, v180
    v_exp_f32 v181, v181
    s_waitcnt lgkmcnt(7)
    v_mfma_f32_32x32x16_bf16 a[128:143], v[40:43], v[192:195], a[128:143]
    ds_read_b64_tr_b16 v[38:39], v13 offset:6144
    v_cvt_pk_bf16_f32 v58, v1, v2
    v_add_f32 v22, v22, v180
    v_cvt_pk_bf16_f32 v59, v3, v29
    v_cvt_pk_bf16_f32 v218, v180, v181
    v_mfma_f32_32x32x16_bf16 a[192:207], v[40:43], v[200:203], a[192:207]
    ds_read_b64_tr_b16 v[40:41], v14 offset:4096
    s_cmp_ge_u32 s63, 29
    s_cbranch_scc1 K1_HS3
    s_add_u32 s47, s56, 88064
    buffer_store_dwordx4 v[56:59], v0, s[28:31], s47 offen offset:0 sc1
K1_HS3:
    v_add_f32 v22, v22, v181
    v_exp_f32 v182, v182
    s_waitcnt lgkmcnt(7)
    v_mfma_f32_32x32x16_bf16 a[144:159], v[44:47], v[192:195], a[144:159]
    ds_read_b64_tr_b16 v[42:43], v14 offset:6144
    v_exp_f32 v183, v183
    v_add_f32 v22, v22, v182
    v_accvgpr_read_b32 v60, a16
    v_cvt_pk_bf16_f32 v219, v182, v183
    v_accvgpr_read_b32 v1, a24
    v_add_f32 v22, v22, v183
    v_mfma_f32_32x32x16_bf16 a[208:223], v[44:47], v[200:203], a[208:223]
    ds_read_b64_tr_b16 v[44:45], v15 offset:4096
    v_exp_f32 v184, v184
    v_accvgpr_read_b32 v61, a17
    v_accvgpr_read_b32 v2, a25
    v_exp_f32 v185, v185
    v_accvgpr_read_b32 v62, a18
    s_waitcnt lgkmcnt(7)
    v_mfma_f32_32x32x16_bf16 a[96:111], v[32:35], v[196:199], a[96:111]
    ds_read_b64_tr_b16 v[46:47], v15 offset:6144
    ds_read_b128 a[224:227], v4 offset:8192
    v_add_f32 v22, v22, v184
    v_accvgpr_read_b32 v3, a26
    v_cvt_pk_bf16_f32 v220, v184, v185
    v_add_f32 v22, v22, v185
    v_accvgpr_read_b32 v63, a19
    v_mfma_f32_32x32x16_bf16 a[160:175], v[32:35], v[204:207], a[160:175]
    ds_read_b128 a[228:231], v5 offset:8192
    v_exp_f32 v186, v186
    v_accvgpr_read_b32 v29, a27
    v_exp_f32 v187, v187
    s_waitcnt lgkmcnt(8)
    v_mul_f32 v48, v48, v23
    s_waitcnt lgkmcnt(6)
    v_mfma_f32_32x32x16_bf16 a[112:127], v[36:39], v[196:199], a[112:127]
    ds_read_b128 a[232:235], v6 offset:8192
    v_accvgpr_write_b32 a8, -1
    v_accvgpr_write_b32 a9, -1
    v_accvgpr_write_b32 a10, -1
    v_accvgpr_write_b32 a11, -1
    s_mul_i32 s62, s51, 49152
    s_add_u32 s62, s62, s53
    v_mfma_f32_32x32x16_bf16 a[176:191], v[36:39], v[204:207], a[176:191]
    ds_read_b128 a[236:239], v7 offset:8192
    v_mul_f32 v52, v52, v23
    v_add_f32 v22, v22, v186
    v_cvt_pk_bf16_f32 v221, v186, v187
    v_mul_f32 v49, v49, v23
    v_add_f32 v22, v22, v187
    v_mul_f32 v53, v53, v23
    s_waitcnt lgkmcnt(6)
    v_mfma_f32_32x32x16_bf16 a[128:143], v[40:43], v[196:199], a[128:143]
    ds_read_b128 a[240:243], v8 offset:8192
    v_exp_f32 v188, v188
    v_mul_f32 v50, v50, v23
    v_exp_f32 v189, v189
    v_mul_f32 v54, v54, v23
    v_mfma_f32_32x32x16_bf16 a[192:207], v[40:43], v[204:207], a[192:207]
    ds_read_b128 a[244:247], v9 offset:8192
    buffer_store_dwordx4 a[8:11], v0, s[28:31], s62 offen offset:0 sc1
    v_mul_f32 v51, v51, v23
    v_add_f32 v22, v22, v188
    v_cvt_pk_bf16_f32 v222, v188, v189
    v_mul_f32 v55, v55, v23
    v_add_f32 v22, v22, v189
    s_waitcnt lgkmcnt(6)
    v_mfma_f32_32x32x16_bf16 a[144:159], v[44:47], v[196:199], a[144:159]
    ds_read_b128 a[248:251], v10 offset:8192
    v_fmac_f32 v48, v60, v30
    v_exp_f32 v190, v190
    v_fmac_f32 v52, v1, v25
    v_exp_f32 v191, v191
    v_mfma_f32_32x32x16_bf16 a[208:223], v[44:47], v[204:207], a[208:223]
    ds_read_b128 a[252:255], v11 offset:8192
    v_fmac_f32 v49, v61, v30
    v_add_f32 v22, v22, v190
    v_fmac_f32 v53, v2, v25
    v_cvt_pk_bf16_f32 v223, v190, v191
    v_fmac_f32 v50, v62, v30
    v_add_f32 v22, v22, v191
    s_waitcnt lgkmcnt(7)
    v_mfma_f32_32x32x16_bf16 v[160:175], a[224:227], v[64:67], v[224:239]
    v_add_u32 v4, 4294934528, v4
    v_exp_f32 v128, v128
    v_fmac_f32 v54, v3, v25
    v_fmac_f32 v51, v63, v30
    v_exp_f32 v129, v129
    v_fmac_f32 v55, v29, v25
    s_waitcnt lgkmcnt(6)
    v_mfma_f32_32x32x16_bf16 v[160:175], a[228:231], v[68:71], v[160:175]
    v_add_u32 v5, 4294934528, v5
    v_exp_f32 v60, v48
    v_add_f32 v21, v21, v128
    v_cvt_pk_bf16_f32 v192, v128, v129
    v_add_f32 v21, v21, v129
    s_waitcnt lgkmcnt(5)
    v_mfma_f32_32x32x16_bf16 v[160:175], a[232:235], v[72:75], v[160:175]
    v_add_u32 v6, 4294934528, v6
    s_getpc_b64 s[76:77]
K1_CP1:
    s_add_u32 s76, s76, (K1_E1+(16384)-K1_CP1)&0xffffffff
    s_addc_u32 s77, s77, ((K1_E1+(16384)-K1_CP1)>>32)&0xffffffff
    global_load_dword a0, v28, s[76:77]
    v_exp_f32 v61, v49
    v_exp_f32 v130, v130
    s_waitcnt lgkmcnt(4)
    v_mfma_f32_32x32x16_bf16 v[160:175], a[236:239], v[76:79], v[160:175]
    v_add_u32 v7, 4294934528, v7
    v_exp_f32 v131, v131
    v_exp_f32 v62, v50
    v_add_f32 v21, v21, v130
    s_waitcnt lgkmcnt(3)
    v_mfma_f32_32x32x16_bf16 v[160:175], a[240:243], v[80:83], v[160:175]
    v_add_u32 v8, 4294934528, v8
    v_exp_f32 v63, v51
    v_cvt_pk_bf16_f32 v193, v130, v131
    v_add_f32 v21, v21, v131
    v_exp_f32 v132, v132
    v_add_f32 v60, 1.0, v60
    v_add_f32 v61, 1.0, v61
    s_waitcnt lgkmcnt(2)
    v_mfma_f32_32x32x16_bf16 v[160:175], a[244:247], v[84:87], v[160:175]
    v_add_u32 v9, 4294934528, v9
    v_exp_f32 v133, v133
    v_add_f32 v62, 1.0, v62
    v_add_f32 v21, v21, v132
    v_add_f32 v63, 1.0, v63
    v_cvt_pk_bf16_f32 v194, v132, v133
    s_waitcnt lgkmcnt(1)
    v_mfma_f32_32x32x16_bf16 v[160:175], a[248:251], v[88:91], v[160:175]
    v_add_u32 v10, 4294934528, v10
    v_rcp_f32 v60, v60
    v_add_f32 v21, v21, v133
    v_exp_f32 v134, v134
    v_rcp_f32 v61, v61
    s_waitcnt lgkmcnt(0)
    v_mfma_f32_32x32x16_bf16 v[160:175], a[252:255], v[92:95], v[160:175]
    v_add_u32 v11, 4294934528, v11
    v_exp_f32 v135, v135
    v_rcp_f32 v62, v62
    v_add_f32 v21, v21, v134
    v_cvt_pk_bf16_f32 v195, v134, v135
    v_add_f32 v21, v21, v135
    v_mfma_f32_32x32x16_bf16 v[176:191], a[224:227], v[96:99], v[240:255]
    v_rcp_f32 v63, v63
    v_exp_f32 v136, v136
    v_mul_f32 v1, v60, v52
    v_exp_f32 v137, v137
    v_mfma_f32_32x32x16_bf16 v[176:191], a[228:231], v[100:103], v[176:191]
    ds_read_b64_tr_b16 v[32:33], v12 offset:8192
    v_mul_f32 v2, v61, v53
    v_add_f32 v21, v21, v136
    v_mul_f32 v3, v62, v54
    v_cvt_pk_bf16_f32 v196, v136, v137
    v_mul_f32 v29, v63, v55
    v_add_f32 v21, v21, v137
    v_mfma_f32_32x32x16_bf16 v[176:191], a[232:235], v[104:107], v[176:191]
    ds_read_b64_tr_b16 v[34:35], v12 offset:10240
    ds_read_b128 v[48:51], v27 offset:672
    ds_read_b128 v[52:55], v27 offset:736
    v_exp_f32 v138, v138
    v_exp_f32 v139, v139
    v_cvt_pk_bf16_f32 v56, v1, v2
    v_mfma_f32_32x32x16_bf16 v[176:191], a[236:239], v[108:111], v[176:191]
    ds_read_b64_tr_b16 v[36:37], v13 offset:8192
    v_cvt_pk_bf16_f32 v57, v3, v29
    v_add_f32 v21, v21, v138
    v_accvgpr_read_b32 v60, a20
    v_cvt_pk_bf16_f32 v197, v138, v139
    v_add_f32 v21, v21, v139
    v_accvgpr_read_b32 v1, a28
    v_mfma_f32_32x32x16_bf16 v[176:191], a[240:243], v[112:115], v[176:191]
    ds_read_b64_tr_b16 v[38:39], v13 offset:10240
    v_exp_f32 v140, v140
    v_accvgpr_read_b32 v61, a21
    v_accvgpr_read_b32 v2, a29
    v_exp_f32 v141, v141
    v_accvgpr_read_b32 v62, a22
    v_mfma_f32_32x32x16_bf16 v[176:191], a[244:247], v[116:119], v[176:191]
    ds_read_b64_tr_b16 v[40:41], v14 offset:8192
    v_add_f32 v21, v21, v140
    v_accvgpr_read_b32 v3, a30
    v_cvt_pk_bf16_f32 v198, v140, v141
    v_accvgpr_read_b32 v63, a23
    v_add_f32 v21, v21, v141
    v_accvgpr_read_b32 v29, a31
    v_mfma_f32_32x32x16_bf16 v[176:191], a[248:251], v[120:123], v[176:191]
    ds_read_b64_tr_b16 v[42:43], v14 offset:10240
    v_exp_f32 v142, v142
    s_waitcnt lgkmcnt(5)
    v_mul_f32 v48, v48, v23
    v_exp_f32 v143, v143
    s_waitcnt lgkmcnt(4)
    v_mul_f32 v52, v52, v23
    v_mul_f32 v49, v49, v23
    v_mfma_f32_32x32x16_bf16 v[176:191], a[252:255], v[124:127], v[176:191]
    ds_read_b64_tr_b16 v[44:45], v15 offset:8192
    v_add_f32 v21, v21, v142
    v_cvt_pk_bf16_f32 v199, v142, v143
    v_mul_f32 v53, v53, v23
    v_add_f32 v21, v21, v143
    v_mul_f32 v50, v50, v23
    v_exp_f32 v144, v144
    v_mfma_f32_32x32x16_bf16 a[96:111], v[32:35], v[208:211], a[96:111]
    ds_read_b64_tr_b16 v[46:47], v15 offset:10240
    v_mul_f32 v54, v54, v23
    v_mul_f32 v51, v51, v23
    v_exp_f32 v145, v145
    v_mul_f32 v55, v55, v23
    v_add_f32 v22, v22, v144
    v_fmac_f32 v48, v60, v30
    v_mfma_f32_32x32x16_bf16 a[160:175], v[32:35], v[216:219], a[160:175]
    ds_read_b64_tr_b16 v[32:33], v12 offset:12288
    v_cvt_pk_bf16_f32 v200, v144, v145
    v_fmac_f32 v52, v1, v25
    v_add_f32 v22, v22, v145
    v_exp_f32 v146, v146
    v_fmac_f32 v49, v61, v30
    s_waitcnt lgkmcnt(5)
    v_mfma_f32_32x32x16_bf16 a[112:127], v[36:39], v[208:211], a[112:127]
    ds_read_b64_tr_b16 v[34:35], v12 offset:14336
    v_fmac_f32 v53, v2, v25
    v_exp_f32 v147, v147
    v_fmac_f32 v50, v62, v30
    v_fmac_f32 v54, v3, v25
    v_add_f32 v22, v22, v146
    v_cvt_pk_bf16_f32 v201, v146, v147
    v_mfma_f32_32x32x16_bf16 a[176:191], v[36:39], v[216:219], a[176:191]
    ds_read_b64_tr_b16 v[36:37], v13 offset:12288
    v_fmac_f32 v51, v63, v30
    v_add_f32 v22, v22, v147
    v_fmac_f32 v55, v29, v25
    v_exp_f32 v148, v148
    s_waitcnt lgkmcnt(5)
    v_mfma_f32_32x32x16_bf16 a[128:143], v[40:43], v[208:211], a[128:143]
    ds_read_b64_tr_b16 v[38:39], v13 offset:14336
    v_exp_f32 v60, v48
    v_exp_f32 v149, v149
    v_exp_f32 v61, v49
    v_add_f32 v22, v22, v148
    v_cvt_pk_bf16_f32 v202, v148, v149
    v_mfma_f32_32x32x16_bf16 a[192:207], v[40:43], v[216:219], a[192:207]
    ds_read_b64_tr_b16 v[40:41], v14 offset:12288
    v_exp_f32 v62, v50
    v_add_f32 v22, v22, v149
    v_exp_f32 v150, v150
    s_waitcnt lgkmcnt(5)
    v_mfma_f32_32x32x16_bf16 a[144:159], v[44:47], v[208:211], a[144:159]
    ds_read_b64_tr_b16 v[42:43], v14 offset:14336
    v_exp_f32 v63, v51
    v_exp_f32 v151, v151
    v_add_f32 v22, v22, v150
    v_add_f32 v60, 1.0, v60
    v_cvt_pk_bf16_f32 v203, v150, v151
    v_add_f32 v61, 1.0, v61
    v_mfma_f32_32x32x16_bf16 a[208:223], v[44:47], v[216:219], a[208:223]
    ds_read_b64_tr_b16 v[44:45], v15 offset:12288
    s_waitcnt vmcnt(18)
    s_barrier
    v_add_f32 v22, v22, v151
    v_add_f32 v62, 1.0, v62
    v_exp_f32 v152, v152
    v_add_f32 v63, 1.0, v63
    s_waitcnt lgkmcnt(5)
    v_mfma_f32_32x32x16_bf16 a[96:111], v[32:35], v[212:215], a[96:111]
    ds_read_b64_tr_b16 v[46:47], v15 offset:14336
    ds_read_b128 a[224:227], v4 offset:0
    v_exp_f32 v153, v153
    v_rcp_f32 v60, v60
    v_add_f32 v22, v22, v152
    v_mfma_f32_32x32x16_bf16 a[160:175], v[32:35], v[220:223], a[160:175]
    ds_read_b128 a[228:231], v5 offset:0
    v_add_u32 v12, 65536, v12
    v_rcp_f32 v61, v61
    v_cvt_pk_bf16_f32 v204, v152, v153
    v_add_f32 v22, v22, v153
    v_exp_f32 v154, v154
    s_waitcnt lgkmcnt(6)
    v_mfma_f32_32x32x16_bf16 a[112:127], v[36:39], v[212:215], a[112:127]
    ds_read_b128 a[232:235], v6 offset:0
    v_add_u32 v13, 65536, v13
    v_rcp_f32 v62, v62
    v_exp_f32 v155, v155
    v_mfma_f32_32x32x16_bf16 a[176:191], v[36:39], v[220:223], a[176:191]
    ds_read_b128 a[236:239], v7 offset:0
    v_add_u32 v14, 65536, v14
    v_rcp_f32 v63, v63
    v_add_f32 v22, v22, v154
    v_cvt_pk_bf16_f32 v205, v154, v155
    v_mul_f32 v1, v60, v52
    v_add_f32 v22, v22, v155
    v_mul_f32 v2, v61, v53
    s_waitcnt lgkmcnt(6)
    v_mfma_f32_32x32x16_bf16 a[128:143], v[40:43], v[212:215], a[128:143]
    ds_read_b128 a[240:243], v8 offset:0
    v_add_u32 v15, 65536, v15
    v_exp_f32 v156, v156
    v_mul_f32 v3, v62, v54
    v_exp_f32 v157, v157
    v_mfma_f32_32x32x16_bf16 a[192:207], v[40:43], v[220:223], a[192:207]
    ds_read_b128 a[244:247], v9 offset:0
    buffer_store_dwordx4 a[8:11], v0, s[28:31], s62 offen offset:1024 sc1
    v_mul_f32 v29, v63, v55
    ds_read_b128 v[48:51], v27 offset:640
    ds_read_b128 v[52:55], v27 offset:704
    v_add_f32 v22, v22, v156
    v_cvt_pk_bf16_f32 v206, v156, v157
    v_add_f32 v22, v22, v157
    s_waitcnt lgkmcnt(8)
    v_mfma_f32_32x32x16_bf16 a[144:159], v[44:47], v[212:215], a[144:159]
    ds_read_b128 a[248:251], v10 offset:0
    v_cvt_pk_bf16_f32 v58, v1, v2
    v_exp_f32 v158, v158
    v_cvt_pk_bf16_f32 v59, v3, v29
    v_mfma_f32_32x32x16_bf16 a[208:223], v[44:47], v[220:223], a[208:223]
    ds_read_b128 a[252:255], v11 offset:0
    s_cmp_ge_u32 s63, 29
    s_cbranch_scc1 K1_HS5
    s_add_u32 s47, s56, 0
    buffer_store_dwordx4 v[56:59], v0, s[28:31], s47 offen offset:1024 sc1
K1_HS5:
    v_exp_f32 v159, v159
    v_add_f32 v22, v22, v158
    v_cvt_pk_bf16_f32 v207, v158, v159
    v_add_f32 v22, v22, v159
    s_waitcnt lgkmcnt(9)
    v_mfma_f32_32x32x16_bf16 v[128:143], a[224:227], v[64:67], v[224:239]
    v_exp_f32 v160, v160
    v_accvgpr_read_b32 v60, a64
    v_accvgpr_read_b32 v1, a72
    v_exp_f32 v161, v161
    v_accvgpr_read_b32 v61, a65
    s_waitcnt lgkmcnt(8)
    v_mfma_f32_32x32x16_bf16 v[128:143], a[228:231], v[68:71], v[128:143]
    s_add_u32 m0, s42, 65536
    s_add_u32 s46, s43, 81920
    buffer_load_dwordx4 v20, s[24:27], s46 offen lds
    v_add_f32 v21, v21, v160
    v_accvgpr_read_b32 v2, a73
    v_cvt_pk_bf16_f32 v208, v160, v161
    v_add_f32 v21, v21, v161
    s_waitcnt lgkmcnt(7)
    v_mfma_f32_32x32x16_bf16 v[128:143], a[232:235], v[72:75], v[128:143]
    v_accvgpr_read_b32 v62, a66
    v_exp_f32 v162, v162
    v_accvgpr_read_b32 v3, a74
    v_exp_f32 v163, v163
    v_accvgpr_read_b32 v63, a67
    s_waitcnt lgkmcnt(6)
    v_mfma_f32_32x32x16_bf16 v[128:143], a[236:239], v[76:79], v[128:143]
    buffer_load_dwordx4 v20, s[24:27], s46 offen offset:1024 lds
    v_accvgpr_read_b32 v29, a75
    v_add_f32 v21, v21, v162
    v_cvt_pk_bf16_f32 v209, v162, v163
    s_waitcnt lgkmcnt(3)
    v_mul_f32 v48, v48, v24
    v_add_f32 v21, v21, v163
    s_waitcnt lgkmcnt(2)
    v_mul_f32 v52, v52, v24
    v_mfma_f32_32x32x16_bf16 v[128:143], a[240:243], v[80:83], v[128:143]
    v_exp_f32 v164, v164
    v_mul_f32 v49, v49, v24
    v_exp_f32 v165, v165
    v_mul_f32 v53, v53, v24
    v_add_f32 v21, v21, v164
    v_mfma_f32_32x32x16_bf16 v[128:143], a[244:247], v[84:87], v[128:143]
    buffer_load_dwordx4 v20, s[24:27], s46 offen offset:2048 lds
    v_mul_f32 v50, v50, v24
    v_cvt_pk_bf16_f32 v210, v164, v165
    v_mul_f32 v54, v54, v24
    v_add_f32 v21, v21, v165
    v_exp_f32 v166, v166
    s_waitcnt lgkmcnt(1)
    v_mfma_f32_32x32x16_bf16 v[128:143], a[248:251], v[88:91], v[128:143]
    v_mul_f32 v51, v51, v24
    v_mul_f32 v55, v55, v24
    v_exp_f32 v167, v167
    v_fmac_f32 v48, v60, v31
    v_add_f32 v21, v21, v166
    v_fmac_f32 v52, v1, v26
    s_waitcnt lgkmcnt(0)
    v_mfma_f32_32x32x16_bf16 v[128:143], a[252:255], v[92:95], v[128:143]
    buffer_load_dwordx4 v20, s[24:27], s46 offen offset:3072 lds
    v_cvt_pk_bf16_f32 v211, v166, v167
    v_add_f32 v21, v21, v167
    v_fmac_f32 v49, v61, v31
    v_exp_f32 v168, v168
    v_fmac_f32 v53, v2, v26
    v_mfma_f32_32x32x16_bf16 v[144:159], a[224:227], v[96:99], v[240:255]
    v_exp_f32 v169, v169
    v_fmac_f32 v50, v62, v31
    v_fmac_f32 v54, v3, v26
    v_add_f32 v21, v21, v168
    v_cvt_pk_bf16_f32 v212, v168, v169
    v_fmac_f32 v51, v63, v31
    v_mfma_f32_32x32x16_bf16 v[144:159], a[228:231], v[100:103], v[144:159]
    ds_read_b64_tr_b16 v[32:33], v12 offset:0
    s_add_u32 m0, s42, 16384
    s_add_u32 s46, s43, 98304
    buffer_load_dwordx4 v16, s[20:23], s46 offen lds
    v_add_f32 v21, v21, v169
    v_fmac_f32 v55, v29, v26
    v_mfma_f32_32x32x16_bf16 v[144:159], a[232:235], v[104:107], v[144:159]
    ds_read_b64_tr_b16 v[34:35], v12 offset:2048
    v_exp_f32 v170, v170
    v_exp_f32 v60, v48
    v_exp_f32 v171, v171
    v_add_f32 v21, v21, v170
    v_mfma_f32_32x32x16_bf16 v[144:159], a[236:239], v[108:111], v[144:159]
    ds_read_b64_tr_b16 v[36:37], v13 offset:0
    buffer_load_dwordx4 v17, s[20:23], s46 offen offset:1024 lds
    v_exp_f32 v61, v49
    v_cvt_pk_bf16_f32 v213, v170, v171
    v_add_f32 v21, v21, v171
    v_mfma_f32_32x32x16_bf16 v[144:159], a[240:243], v[112:115], v[144:159]
    ds_read_b64_tr_b16 v[38:39], v13 offset:2048
    v_exp_f32 v172, v172
    v_exp_f32 v62, v50
    v_exp_f32 v173, v173
    v_mfma_f32_32x32x16_bf16 v[144:159], a[244:247], v[116:119], v[144:159]
    ds_read_b64_tr_b16 v[40:41], v14 offset:0
    buffer_load_dwordx4 v18, s[20:23], s46 offen offset:2048 lds
    v_exp_f32 v63, v51
    v_add_f32 v21, v21, v172
    v_cvt_pk_bf16_f32 v214, v172, v173
    v_add_f32 v21, v21, v173
    v_add_f32 v60, 1.0, v60
    v_mfma_f32_32x32x16_bf16 v[144:159], a[248:251], v[120:123], v[144:159]
    ds_read_b64_tr_b16 v[42:43], v14 offset:2048
    v_exp_f32 v174, v174
    v_add_f32 v61, 1.0, v61
    v_exp_f32 v175, v175
    v_add_f32 v62, 1.0, v62
    v_mfma_f32_32x32x16_bf16 v[144:159], a[252:255], v[124:127], v[144:159]
    ds_read_b64_tr_b16 v[44:45], v15 offset:0
    buffer_load_dwordx4 v19, s[20:23], s46 offen offset:3072 lds
    v_add_f32 v63, 1.0, v63
    v_add_f32 v21, v21, v174
    v_cvt_pk_bf16_f32 v215, v174, v175
    v_rcp_f32 v60, v60
    s_waitcnt lgkmcnt(5)
    v_mfma_f32_32x32x16_bf16 a[96:111], v[32:35], v[192:195], a[96:111]
    ds_read_b64_tr_b16 v[46:47], v15 offset:2048
    v_add_f32 v21, v21, v175
    v_exp_f32 v176, v176
    v_rcp_f32 v61, v61
    v_mfma_f32_32x32x16_bf16 a[160:175], v[32:35], v[200:203], a[160:175]
    ds_read_b64_tr_b16 v[32:33], v12 offset:4096
    v_exp_f32 v177, v177
    v_add_f32 v22, v22, v176
    v_rcp_f32 v62, v62
    v_cvt_pk_bf16_f32 v216, v176, v177
    s_waitcnt lgkmcnt(5)
    v_mfma_f32_32x32x16_bf16 a[112:127], v[36:39], v[192:195], a[112:127]
    ds_read_b64_tr_b16 v[34:35], v12 offset:6144
    v_add_f32 v22, v22, v177
    v_exp_f32 v178, v178
    v_rcp_f32 v63, v63
    v_mfma_f32_32x32x16_bf16 a[176:191], v[36:39], v[200:203], a[176:191]
    ds_read_b64_tr_b16 v[36:37], v13 offset:4096
    v_exp_f32 v179, v179
    v_mul_f32 v1, v60, v52
    v_add_f32 v22, v22, v178
    v_cvt_pk_bf16_f32 v217, v178, v179
    v_mul_f32 v2, v61, v53
    v_add_f32 v22, v22, v179
    s_waitcnt lgkmcnt(5)
    v_mfma_f32_32x32x16_bf16 a[128:143], v[40:43], v[192:195], a[128:143]
    ds_read_b64_tr_b16 v[38:39], v13 offset:6144
    v_mul_f32 v3, v62, v54
    v_exp_f32 v180, v180
    v_mul_f32 v29, v63, v55
    v_exp_f32 v181, v181
    v_mfma_f32_32x32x16_bf16 a[192:207], v[40:43], v[200:203], a[192:207]
    ds_read_b64_tr_b16 v[40:41], v14 offset:4096
    ds_read_b128 v[48:51], v27 offset:672
    ds_read_b128 v[52:55], v27 offset:736
    v_add_f32 v22, v22, v180
    v_cvt_pk_bf16_f32 v218, v180, v181
    v_cvt_pk_bf16_f32 v56, v1, v2
    v_add_f32 v22, v22, v181
    s_waitcnt lgkmcnt(7)
    v_mfma_f32_32x32x16_bf16 a[144:159], v[44:47], v[192:195], a[144:159]
    ds_read_b64_tr_b16 v[42:43], v14 offset:6144
    v_exp_f32 v182, v182
    v_cvt_pk_bf16_f32 v57, v3, v29
    v_accvgpr_read_b32 v60, a68
    v_exp_f32 v183, v183
    v_mfma_f32_32x32x16_bf16 a[208:223], v[44:47], v[200:203], a[208:223]
    ds_read_b64_tr_b16 v[44:45], v15 offset:4096
    v_accvgpr_read_b32 v1, a76
    v_add_f32 v22, v22, v182
    v_accvgpr_read_b32 v61, a69
    v_cvt_pk_bf16_f32 v219, v182, v183
    v_add_f32 v22, v22, v183
    v_accvgpr_read_b32 v2, a77
    s_waitcnt lgkmcnt(7)
    v_mfma_f32_32x32x16_bf16 a[96:111], v[32:35], v[196:199], a[96:111]
    ds_read_b64_tr_b16 v[46:47], v15 offset:6144
    ds_read_b128 a[224:227], v4 offset:8192
    v_exp_f32 v184, v184
    v_accvgpr_read_b32 v62, a70
    v_exp_f32 v185, v185
    v_mfma_f32_32x32x16_bf16 a[160:175], v[32:35], v[204:207], a[160:175]
    ds_read_b128 a[228:231], v5 offset:8192
    v_accvgpr_read_b32 v3, a78
    v_accvgpr_read_b32 v63, a71
    v_add_f32 v22, v22, v184
    v_cvt_pk_bf16_f32 v220, v184, v185
    v_accvgpr_read_b32 v29, a79
    v_add_f32 v22, v22, v185
    s_waitcnt lgkmcnt(8)
    v_mfma_f32_32x32x16_bf16 a[112:127], v[36:39], v[196:199], a[112:127]
    ds_read_b128 a[232:235], v6 offset:8192
    s_waitcnt lgkmcnt(7)
    v_mul_f32 v48, v48, v24
    v_exp_f32 v186, v186
    s_waitcnt lgkmcnt(6)
    v_mul_f32 v52, v52, v24
    v_exp_f32 v187, v187
    v_mfma_f32_32x32x16_bf16 a[176:191], v[36:39], v[204:207], a[176:191]
    ds_read_b128 a[236:239], v7 offset:8192
    v_mul_f32 v49, v49, v24
    v_add_f32 v22, v22, v186
    v_mul_f32 v53, v53, v24
    v_cvt_pk_bf16_f32 v221, v186, v187
    v_mul_f32 v50, v50, v24
    v_add_f32 v22, v22, v187
    s_waitcnt lgkmcnt(6)
    v_mfma_f32_32x32x16_bf16 a[128:143], v[40:43], v[196:199], a[128:143]
    ds_read_b128 a[240:243], v8 offset:8192
    v_exp_f32 v188, v188
    v_mul_f32 v54, v54, v24
    v_mul_f32 v51, v51, v24
    v_exp_f32 v189, v189
    v_mfma_f32_32x32x16_bf16 a[192:207], v[40:43], v[204:207], a[192:207]
    ds_read_b128 a[244:247], v9 offset:8192
    buffer_store_dwordx4 a[8:11], v0, s[28:31], s62 offen offset:2048 sc1
    v_mul_f32 v55, v55, v24
    v_add_f32 v22, v22, v188
    v_fmac_f32 v48, v60, v31
    v_cvt_pk_bf16_f32 v222, v188, v189
    v_add_f32 v22, v22, v189
    s_waitcnt lgkmcnt(6)
    v_mfma_f32_32x32x16_bf16 a[144:159], v[44:47], v[196:199], a[144:159]
    ds_read_b128 a[248:251], v10 offset:8192
    v_fmac_f32 v52, v1, v26
    v_exp_f32 v190, v190
    v_fmac_f32 v49, v61, v31
    v_exp_f32 v191, v191
    v_mfma_f32_32x32x16_bf16 a[208:223], v[44:47], v[204:207], a[208:223]
    ds_read_b128 a[252:255], v11 offset:8192
    v_fmac_f32 v53, v2, v26
    v_fmac_f32 v50, v62, v31
    v_add_f32 v22, v22, v190
    v_cvt_pk_bf16_f32 v223, v190, v191
    v_fmac_f32 v54, v3, v26
    v_add_f32 v22, v22, v191
    s_waitcnt lgkmcnt(7)
    v_mfma_f32_32x32x16_bf16 v[160:175], a[224:227], v[64:67], v[224:239]
    v_add_u32 v4, 65536, v4
    v_exp_f32 v128, v128
    v_fmac_f32 v51, v63, v31
    v_fmac_f32 v55, v29, v26
    v_exp_f32 v129, v129
    s_waitcnt lgkmcnt(6)
    v_mfma_f32_32x32x16_bf16 v[160:175], a[228:231], v[68:71], v[160:175]
    v_add_u32 v5, 65536, v5
    v_exp_f32 v60, v48
    v_add_f32 v21, v21, v128
    v_cvt_pk_bf16_f32 v192, v128, v129
    v_exp_f32 v61, v49
    v_add_f32 v21, v21, v129
    s_waitcnt lgkmcnt(5)
    v_mfma_f32_32x32x16_bf16 v[160:175], a[232:235], v[72:75], v[160:175]
    v_add_u32 v6, 65536, v6
    v_exp_f32 v130, v130
    v_exp_f32 v62, v50
    v_exp_f32 v131, v131
    s_waitcnt lgkmcnt(4)
    v_mfma_f32_32x32x16_bf16 v[160:175], a[236:239], v[76:79], v[160:175]
    v_add_u32 v7, 65536, v7
    v_exp_f32 v63, v51
    v_add_f32 v21, v21, v130
    v_cvt_pk_bf16_f32 v193, v130, v131
    v_add_f32 v21, v21, v131
    v_add_f32 v60, 1.0, v60
    s_waitcnt lgkmcnt(3)
    v_mfma_f32_32x32x16_bf16 v[160:175], a[240:243], v[80:83], v[160:175]
    v_add_u32 v8, 65536, v8
    v_exp_f32 v132, v132
    v_add_f32 v61, 1.0, v61
    v_add_f32 v62, 1.0, v62
    v_exp_f32 v133, v133
    v_add_f32 v63, 1.0, v63
    s_waitcnt lgkmcnt(2)
    v_mfma_f32_32x32x16_bf16 v[160:175], a[244:247], v[84:87], v[160:175]
    v_add_u32 v9, 65536, v9
    v_add_f32 v21, v21, v132
    v_rcp_f32 v60, v60
    v_cvt_pk_bf16_f32 v194, v132, v133
    v_add_f32 v21, v21, v133
    s_waitcnt lgkmcnt(1)
    v_mfma_f32_32x32x16_bf16 v[160:175], a[248:251], v[88:91], v[160:175]
    v_add_u32 v10, 65536, v10
    v_rcp_f32 v61, v61
    v_exp_f32 v134, v134
    v_exp_f32 v135, v135
    v_rcp_f32 v62, v62
    s_waitcnt lgkmcnt(0)
    v_mfma_f32_32x32x16_bf16 v[160:175], a[252:255], v[92:95], v[160:175]
    v_add_u32 v11, 65536, v11
    v_add_f32 v21, v21, v134
    v_cvt_pk_bf16_f32 v195, v134, v135
    v_rcp_f32 v63, v63
    v_add_f32 v21, v21, v135
    v_mfma_f32_32x32x16_bf16 v[176:191], a[224:227], v[96:99], v[240:255]
    v_exp_f32 v136, v136
    v_mul_f32 v1, v60, v52
    v_mul_f32 v2, v61, v53
    v_exp_f32 v137, v137
    v_mul_f32 v3, v62, v54
    v_add_f32 v21, v21, v136
    v_mul_f32 v29, v63, v55
    v_mfma_f32_32x32x16_bf16 v[176:191], a[228:231], v[100:103], v[176:191]
    ds_read_b64_tr_b16 v[32:33], v12 offset:8192
    v_cvt_pk_bf16_f32 v196, v136, v137
    ds_read_b128 v[48:51], v27 offset:768
    ds_read_b128 v[52:55], v27 offset:832
    v_add_f32 v21, v21, v137
    v_exp_f32 v138, v138
    v_mfma_f32_32x32x16_bf16 v[176:191], a[232:235], v[104:107], v[176:191]
    ds_read_b64_tr_b16 v[34:35], v12 offset:10240
    v_cvt_pk_bf16_f32 v58, v1, v2
    v_exp_f32 v139, v139
    v_cvt_pk_bf16_f32 v59, v3, v29
    v_add_f32 v21, v21, v138
    v_mfma_f32_32x32x16_bf16 v[176:191], a[236:239], v[108:111], v[176:191]
    ds_read_b64_tr_b16 v[36:37], v13 offset:8192
    s_cmp_ge_u32 s63, 29
    s_cbranch_scc1 K1_HS7
    s_add_u32 s47, s56, 88064
    buffer_store_dwordx4 v[56:59], v0, s[28:31], s47 offen offset:1024 sc1
K1_HS7:
    v_cvt_pk_bf16_f32 v197, v138, v139
    v_add_f32 v21, v21, v139
    v_exp_f32 v140, v140
    v_mfma_f32_32x32x16_bf16 v[176:191], a[240:243], v[112:115], v[176:191]
    ds_read_b64_tr_b16 v[38:39], v13 offset:10240
    v_exp_f32 v141, v141
    v_accvgpr_read_b32 v60, a32
    v_accvgpr_read_b32 v1, a40
    v_add_f32 v21, v21, v140
    v_accvgpr_read_b32 v61, a33
    v_mfma_f32_32x32x16_bf16 v[176:191], a[244:247], v[116:119], v[176:191]
    ds_read_b64_tr_b16 v[40:41], v14 offset:8192
    v_cvt_pk_bf16_f32 v198, v140, v141
    v_add_f32 v21, v21, v141
    v_accvgpr_read_b32 v2, a41
    v_exp_f32 v142, v142
    v_accvgpr_read_b32 v62, a34
    v_accvgpr_read_b32 v3, a42
    v_mfma_f32_32x32x16_bf16 v[176:191], a[248:251], v[120:123], v[176:191]
    ds_read_b64_tr_b16 v[42:43], v14 offset:10240
    v_exp_f32 v143, v143
    v_accvgpr_read_b32 v63, a35
    v_add_f32 v21, v21, v142
    v_accvgpr_read_b32 v29, a43
    v_cvt_pk_bf16_f32 v199, v142, v143
    v_mfma_f32_32x32x16_bf16 v[176:191], a[252:255], v[124:127], v[176:191]
    ds_read_b64_tr_b16 v[44:45], v15 offset:8192
    s_waitcnt lgkmcnt(7)
    v_mul_f32 v48, v48, v23
    v_add_f32 v21, v21, v143
    v_exp_f32 v144, v144
    s_waitcnt lgkmcnt(6)
    v_mul_f32 v52, v52, v23
    v_mul_f32 v49, v49, v23
    s_waitcnt lgkmcnt(5)
    v_mfma_f32_32x32x16_bf16 a[96:111], v[32:35], v[208:211], a[96:111]
    ds_read_b64_tr_b16 v[46:47], v15 offset:10240
    v_exp_f32 v145, v145
    v_mul_f32 v53, v53, v23
    v_mul_f32 v50, v50, v23
    v_add_f32 v22, v22, v144
    v_cvt_pk_bf16_f32 v200, v144, v145
    v_mul_f32 v54, v54, v23
    v_mfma_f32_32x32x16_bf16 a[160:175], v[32:35], v[216:219], a[160:175]
    ds_read_b64_tr_b16 v[32:33], v12 offset:12288
    v_add_f32 v22, v22, v145
    v_mul_f32 v51, v51, v23
    v_exp_f32 v146, v146
    v_mul_f32 v55, v55, v23
    s_waitcnt lgkmcnt(5)
    v_mfma_f32_32x32x16_bf16 a[112:127], v[36:39], v[208:211], a[112:127]
    ds_read_b64_tr_b16 v[34:35], v12 offset:14336
    v_exp_f32 v147, v147
    v_fmac_f32 v48, v60, v30
    v_fmac_f32 v52, v1, v25
    v_add_f32 v22, v22, v146
    v_fmac_f32 v49, v61, v30
    v_cvt_pk_bf16_f32 v201, v146, v147
    v_add_f32 v22, v22, v147
    v_mfma_f32_32x32x16_bf16 a[176:191], v[36:39], v[216:219], a[176:191]
    ds_read_b64_tr_b16 v[36:37], v13 offset:12288
    v_fmac_f32 v53, v2, v25
    v_exp_f32 v148, v148
    v_fmac_f32 v50, v62, v30
    v_fmac_f32 v54, v3, v25
    s_waitcnt lgkmcnt(5)
    v_mfma_f32_32x32x16_bf16 a[128:143], v[40:43], v[208:211], a[128:143]
    ds_read_b64_tr_b16 v[38:39], v13 offset:14336
    v_exp_f32 v149, v149
    v_fmac_f32 v51, v63, v30
    v_add_f32 v22, v22, v148
    v_fmac_f32 v55, v29, v25
    v_cvt_pk_bf16_f32 v202, v148, v149
    v_exp_f32 v60, v48
    v_mfma_f32_32x32x16_bf16 a[192:207], v[40:43], v[216:219], a[192:207]
    ds_read_b64_tr_b16 v[40:41], v14 offset:12288
    v_add_f32 v22, v22, v149
    v_exp_f32 v150, v150
    v_exp_f32 v61, v49
    s_waitcnt lgkmcnt(5)
    v_mfma_f32_32x32x16_bf16 a[144:159], v[44:47], v[208:211], a[144:159]
    ds_read_b64_tr_b16 v[42:43], v14 offset:14336
    v_exp_f32 v151, v151
    v_exp_f32 v62, v50
    v_add_f32 v22, v22, v150
    v_cvt_pk_bf16_f32 v203, v150, v151
    v_add_f32 v22, v22, v151
    v_mfma_f32_32x32x16_bf16 a[208:223], v[44:47], v[216:219], a[208:223]
    ds_read_b64_tr_b16 v[44:45], v15 offset:12288
    s_waitcnt vmcnt(20)
    s_barrier
    v_exp_f32 v63, v51
    v_exp_f32 v152, v152
    v_add_f32 v60, 1.0, v60
    s_waitcnt lgkmcnt(5)
    v_mfma_f32_32x32x16_bf16 a[96:111], v[32:35], v[212:215], a[96:111]
    ds_read_b64_tr_b16 v[46:47], v15 offset:14336
    ds_read_b128 a[224:227], v4 offset:0
    v_exp_f32 v153, v153
    v_add_f32 v61, 1.0, v61
    v_add_f32 v22, v22, v152
    v_add_f32 v62, 1.0, v62
    v_mfma_f32_32x32x16_bf16 a[160:175], v[32:35], v[220:223], a[160:175]
    ds_read_b128 a[228:231], v5 offset:0
    v_add_u32 v12, 4294934528, v12
    v_cvt_pk_bf16_f32 v204, v152, v153
    v_add_f32 v63, 1.0, v63
    v_add_f32 v22, v22, v153
    v_exp_f32 v154, v154
    s_waitcnt lgkmcnt(6)
    v_mfma_f32_32x32x16_bf16 a[112:127], v[36:39], v[212:215], a[112:127]
    ds_read_b128 a[232:235], v6 offset:0
    v_add_u32 v13, 4294934528, v13
    v_rcp_f32 v60, v60
    v_exp_f32 v155, v155
    v_rcp_f32 v61, v61
    v_mfma_f32_32x32x16_bf16 a[176:191], v[36:39], v[220:223], a[176:191]
    ds_read_b128 a[236:239], v7 offset:0
    v_add_u32 v14, 4294934528, v14
    v_add_f32 v22, v22, v154
    v_cvt_pk_bf16_f32 v205, v154, v155
    v_rcp_f32 v62, v62
    v_add_f32 v22, v22, v155
    s_waitcnt lgkmcnt(6)
    v_mfma_f32_32x32x16_bf16 a[128:143], v[40:43], v[212:215], a[128:143]
    ds_read_b128 a[240:243], v8 offset:0
    v_add_u32 v15, 4294934528, v15
    v_exp_f32 v156, v156
    v_rcp_f32 v63, v63
    v_exp_f32 v157, v157
    v_mfma_f32_32x32x16_bf16 a[192:207], v[40:43], v[220:223], a[192:207]
    ds_read_b128 a[244:247], v9 offset:0
    buffer_store_dwordx4 a[8:11], v0, s[28:31], s62 offen offset:3072 sc1
    v_mul_f32 v1, v60, v52
    v_add_f32 v22, v22, v156
    v_mul_f32 v2, v61, v53
    v_cvt_pk_bf16_f32 v206, v156, v157
    v_add_f32 v22, v22, v157
    s_waitcnt lgkmcnt(6)
    v_mfma_f32_32x32x16_bf16 a[144:159], v[44:47], v[212:215], a[144:159]
    ds_read_b128 a[248:251], v10 offset:0
    v_mul_f32 v3, v62, v54
    v_exp_f32 v158, v158
    v_mul_f32 v29, v63, v55
    ds_read_b128 v[48:51], v27 offset:800
    ds_read_b128 v[52:55], v27 offset:864
    v_mfma_f32_32x32x16_bf16 a[208:223], v[44:47], v[220:223], a[208:223]
    ds_read_b128 a[252:255], v11 offset:0
    v_exp_f32 v159, v159
    v_add_f32 v22, v22, v158
    v_cvt_pk_bf16_f32 v56, v1, v2
    v_cvt_pk_bf16_f32 v207, v158, v159
    v_cvt_pk_bf16_f32 v57, v3, v29
    v_add_f32 v22, v22, v159
    s_waitcnt lgkmcnt(9)
    v_mfma_f32_32x32x16_bf16 v[128:143], a[224:227], v[64:67], v[224:239]
    v_exp_f32 v160, v160
    v_accvgpr_read_b32 v60, a36
    v_accvgpr_read_b32 v1, a44
    v_exp_f32 v161, v161
    v_accvgpr_read_b32 v61, a37
    s_waitcnt lgkmcnt(8)
    v_mfma_f32_32x32x16_bf16 v[128:143], a[228:231], v[68:71], v[128:143]
    s_add_u32 m0, s42, 49152
    s_add_u32 s46, s43, 114688
    buffer_load_dwordx4 v16, s[20:23], s46 offen lds
    v_add_f32 v21, v21, v160
    v_accvgpr_read_b32 v2, a45
    v_cvt_pk_bf16_f32 v208, v160, v161
    v_accvgpr_read_b32 v62, a38
    s_waitcnt lgkmcnt(7)
    v_mfma_f32_32x32x16_bf16 v[128:143], a[232:235], v[72:75], v[128:143]
    v_add_f32 v21, v21, v161
    v_exp_f32 v162, v162
    v_accvgpr_read_b32 v3, a46
    v_accvgpr_read_b32 v63, a39
    v_exp_f32 v163, v163
    s_waitcnt lgkmcnt(6)
    v_mfma_f32_32x32x16_bf16 v[128:143], a[236:239], v[76:79], v[128:143]
    buffer_load_dwordx4 v17, s[20:23], s46 offen offset:1024 lds
    v_accvgpr_read_b32 v29, a47
    v_add_f32 v21, v21, v162
    s_waitcnt lgkmcnt(2)
    v_mul_f32 v48, v48, v23
    v_cvt_pk_bf16_f32 v209, v162, v163
    v_add_f32 v21, v21, v163
    s_waitcnt lgkmcnt(1)
    v_mul_f32 v52, v52, v23
    v_mfma_f32_32x32x16_bf16 v[128:143], a[240:243], v[80:83], v[128:143]
    v_exp_f32 v164, v164
    v_mul_f32 v49, v49, v23
    v_exp_f32 v165, v165
    v_mul_f32 v53, v53, v23
    v_mfma_f32_32x32x16_bf16 v[128:143], a[244:247], v[84:87], v[128:143]
    buffer_load_dwordx4 v18, s[20:23], s46 offen offset:2048 lds
    v_mul_f32 v50, v50, v23
    v_add_f32 v21, v21, v164
    v_mul_f32 v54, v54, v23
    v_cvt_pk_bf16_f32 v210, v164, v165
    v_add_f32 v21, v21, v165
    v_mul_f32 v51, v51, v23
    v_mfma_f32_32x32x16_bf16 v[128:143], a[248:251], v[88:91], v[128:143]
    v_exp_f32 v166, v166
    v_mul_f32 v55, v55, v23
    v_exp_f32 v167, v167
    v_fmac_f32 v48, v60, v30
    v_fmac_f32 v52, v1, v25
    s_waitcnt lgkmcnt(0)
    v_mfma_f32_32x32x16_bf16 v[128:143], a[252:255], v[92:95], v[128:143]
    buffer_load_dwordx4 v19, s[20:23], s46 offen offset:3072 lds
    v_add_f32 v21, v21, v166
    v_cvt_pk_bf16_f32 v211, v166, v167
    v_fmac_f32 v49, v61, v30
    v_add_f32 v21, v21, v167
    v_fmac_f32 v53, v2, v25
    v_mfma_f32_32x32x16_bf16 v[144:159], a[224:227], v[96:99], v[240:255]
    v_exp_f32 v168, v168
    v_fmac_f32 v50, v62, v30
    v_exp_f32 v169, v169
    v_fmac_f32 v54, v3, v25
    v_add_f32 v21, v21, v168
    v_fmac_f32 v51, v63, v30
    v_mfma_f32_32x32x16_bf16 v[144:159], a[228:231], v[100:103], v[144:159]
    ds_read_b64_tr_b16 v[32:33], v12 offset:0
    v_cvt_pk_bf16_f32 v212, v168, v169
    v_fmac_f32 v55, v29, v25
    v_add_f32 v21, v21, v169
    v_exp_f32 v60, v48
    v_mfma_f32_32x32x16_bf16 v[144:159], a[232:235], v[104:107], v[144:159]
    ds_read_b64_tr_b16 v[34:35], v12 offset:2048
    v_exp_f32 v170, v170
    v_exp_f32 v171, v171
    v_exp_f32 v61, v49
    v_add_f32 v21, v21, v170
    v_mfma_f32_32x32x16_bf16 v[144:159], a[236:239], v[108:111], v[144:159]
    ds_read_b64_tr_b16 v[36:37], v13 offset:0
    v_cvt_pk_bf16_f32 v213, v170, v171
    v_exp_f32 v62, v50
    v_add_f32 v21, v21, v171
    v_exp_f32 v172, v172
    v_mfma_f32_32x32x16_bf16 v[144:159], a[240:243], v[112:115], v[144:159]
    ds_read_b64_tr_b16 v[38:39], v13 offset:2048
    v_exp_f32 v63, v51
    v_exp_f32 v173, v173
    v_add_f32 v21, v21, v172
    v_mfma_f32_32x32x16_bf16 v[144:159], a[244:247], v[116:119], v[144:159]
    ds_read_b64_tr_b16 v[40:41], v14 offset:0
    v_add_f32 v60, 1.0, v60
    v_cvt_pk_bf16_f32 v214, v172, v173
    v_add_f32 v21, v21, v173
    v_add_f32 v61, 1.0, v61
    v_exp_f32 v174, v174
    v_mfma_f32_32x32x16_bf16 v[144:159], a[248:251], v[120:123], v[144:159]
    ds_read_b64_tr_b16 v[42:43], v14 offset:2048
    v_add_f32 v62, 1.0, v62
    v_add_f32 v63, 1.0, v63
    v_exp_f32 v175, v175
    v_rcp_f32 v60, v60
    v_mfma_f32_32x32x16_bf16 v[144:159], a[252:255], v[124:127], v[144:159]
    ds_read_b64_tr_b16 v[44:45], v15 offset:0
    v_add_f32 v21, v21, v174
    v_cvt_pk_bf16_f32 v215, v174, v175
    v_add_f32 v21, v21, v175
    v_rcp_f32 v61, v61
    s_waitcnt lgkmcnt(5)
    v_mfma_f32_32x32x16_bf16 a[96:111], v[32:35], v[192:195], a[96:111]
    ds_read_b64_tr_b16 v[46:47], v15 offset:2048
    v_exp_f32 v176, v176
    v_exp_f32 v177, v177
    v_rcp_f32 v62, v62
    v_add_f32 v22, v22, v176
    v_mfma_f32_32x32x16_bf16 a[160:175], v[32:35], v[200:203], a[160:175]
    ds_read_b64_tr_b16 v[32:33], v12 offset:4096
    v_cvt_pk_bf16_f32 v216, v176, v177
    v_rcp_f32 v63, v63
    v_add_f32 v22, v22, v177
    v_exp_f32 v178, v178
    s_waitcnt lgkmcnt(5)
    v_mfma_f32_32x32x16_bf16 a[112:127], v[36:39], v[192:195], a[112:127]
    ds_read_b64_tr_b16 v[34:35], v12 offset:6144
    v_mul_f32 v1, v60, v52
    v_exp_f32 v179, v179
    v_mul_f32 v2, v61, v53
    v_mul_f32 v3, v62, v54
    v_add_f32 v22, v22, v178
    v_mfma_f32_32x32x16_bf16 a[176:191], v[36:39], v[200:203], a[176:191]
    ds_read_b64_tr_b16 v[36:37], v13 offset:4096
    v_cvt_pk_bf16_f32 v217, v178, v179
    v_mul_f32 v29, v63, v55
    v_add_f32 v22, v22, v179
    ds_read_b128 v[48:51], v27 offset:768
    ds_read_b128 v[52:55], v27 offset:832
    s_waitcnt lgkmcnt(7)
    v_mfma_f32_32x32x16_bf16 a[128:143], v[40:43], v[192:195], a[128:143]
    ds_read_b64_tr_b16 v[38:39], v13 offset:6144
    v_exp_f32 v180, v180
    v_exp_f32 v181, v181
    v_cvt_pk_bf16_f32 v58, v1, v2
    v_add_f32 v22, v22, v180
    v_mfma_f32_32x32x16_bf16 a[192:207], v[40:43], v[200:203], a[192:207]
    ds_read_b64_tr_b16 v[40:41], v14 offset:4096
    v_cvt_pk_bf16_f32 v59, v3, v29
    v_cvt_pk_bf16_f32 v218, v180, v181
    s_cmp_ge_u32 s63, 28
    s_cbranch_scc1 K1_HS9
    s_add_u32 s47, s56, 0
    buffer_store_dwordx4 v[56:59], v0, s[28:31], s47 offen offset:2048 sc1
K1_HS9:
    s_waitcnt lgkmcnt(7)
    v_mfma_f32_32x32x16_bf16 a[144:159], v[44:47], v[192:195], a[144:159]
    ds_read_b64_tr_b16 v[42:43], v14 offset:6144
    v_add_f32 v22, v22, v181
    v_exp_f32 v182, v182
    v_exp_f32 v183, v183
    v_add_f32 v22, v22, v182
    v_mfma_f32_32x32x16_bf16 a[208:223], v[44:47], v[200:203], a[208:223]
    ds_read_b64_tr_b16 v[44:45], v15 offset:4096
    v_accvgpr_read_b32 v60, a80
    v_cvt_pk_bf16_f32 v219, v182, v183
    v_accvgpr_read_b32 v1, a88
    v_add_f32 v22, v22, v183
    v_exp_f32 v184, v184
    s_waitcnt lgkmcnt(7)
    v_mfma_f32_32x32x16_bf16 a[96:111], v[32:35], v[196:199], a[96:111]
    ds_read_b64_tr_b16 v[46:47], v15 offset:6144
    ds_read_b128 a[224:227], v4 offset:8192
    v_accvgpr_read_b32 v61, a81
    v_accvgpr_read_b32 v2, a89
    v_exp_f32 v185, v185
    v_accvgpr_read_b32 v62, a82
    v_mfma_f32_32x32x16_bf16 a[160:175], v[32:35], v[204:207], a[160:175]
    ds_read_b128 a[228:231], v5 offset:8192
    v_add_f32 v22, v22, v184
    v_accvgpr_read_b32 v3, a90
    v_cvt_pk_bf16_f32 v220, v184, v185
    v_add_f32 v22, v22, v185
    v_accvgpr_read_b32 v63, a83
    s_waitcnt lgkmcnt(6)
    v_mfma_f32_32x32x16_bf16 a[112:127], v[36:39], v[196:199], a[112:127]
    ds_read_b128 a[232:235], v6 offset:8192
    v_exp_f32 v186, v186
    v_accvgpr_read_b32 v29, a91
    v_exp_f32 v187, v187
    v_mul_f32 v48, v48, v24
    v_mul_f32 v52, v52, v24
    v_mfma_f32_32x32x16_bf16 a[176:191], v[36:39], v[204:207], a[176:191]
    ds_read_b128 a[236:239], v7 offset:8192
    v_add_f32 v22, v22, v186
    v_cvt_pk_bf16_f32 v221, v186, v187
    v_mul_f32 v49, v49, v24
    v_add_f32 v22, v22, v187
    v_mul_f32 v53, v53, v24
    s_waitcnt lgkmcnt(6)
    v_mfma_f32_32x32x16_bf16 a[128:143], v[40:43], v[196:199], a[128:143]
    ds_read_b128 a[240:243], v8 offset:8192
    v_exp_f32 v188, v188
    v_mul_f32 v50, v50, v24
    v_exp_f32 v189, v189
    v_mul_f32 v54, v54, v24
    v_mfma_f32_32x32x16_bf16 a[192:207], v[40:43], v[204:207], a[192:207]
    ds_read_b128 a[244:247], v9 offset:8192
    s_add_u32 s62, s62, 4096
    buffer_store_dwordx4 a[8:11], v0, s[28:31], s62 offen offset:0 sc1
    v_mul_f32 v51, v51, v24
    v_add_f32 v22, v22, v188
    v_cvt_pk_bf16_f32 v222, v188, v189
    v_mul_f32 v55, v55, v24
    v_add_f32 v22, v22, v189
    s_waitcnt lgkmcnt(6)
    v_mfma_f32_32x32x16_bf16 a[144:159], v[44:47], v[196:199], a[144:159]
    ds_read_b128 a[248:251], v10 offset:8192
    v_fmac_f32 v48, v60, v31
    v_exp_f32 v190, v190
    v_fmac_f32 v52, v1, v26
    v_exp_f32 v191, v191
    v_mfma_f32_32x32x16_bf16 a[208:223], v[44:47], v[204:207], a[208:223]
    ds_read_b128 a[252:255], v11 offset:8192
    v_fmac_f32 v49, v61, v31
    v_add_f32 v22, v22, v190
    v_fmac_f32 v53, v2, v26
    v_cvt_pk_bf16_f32 v223, v190, v191
    v_fmac_f32 v50, v62, v31
    v_add_f32 v22, v22, v191
    s_waitcnt lgkmcnt(7)
    v_mfma_f32_32x32x16_bf16 v[160:175], a[224:227], v[64:67], v[224:239]
    v_add_u32 v4, 32768, v4
    v_exp_f32 v128, v128
    v_fmac_f32 v54, v3, v26
    v_fmac_f32 v51, v63, v31
    v_exp_f32 v129, v129
    v_fmac_f32 v55, v29, v26
    s_waitcnt lgkmcnt(6)
    v_mfma_f32_32x32x16_bf16 v[160:175], a[228:231], v[68:71], v[160:175]
    v_add_u32 v5, 32768, v5
    v_exp_f32 v60, v48
    v_add_f32 v21, v21, v128
    v_cvt_pk_bf16_f32 v192, v128, v129
    v_add_f32 v21, v21, v129
    s_waitcnt lgkmcnt(5)
    v_mfma_f32_32x32x16_bf16 v[160:175], a[232:235], v[72:75], v[160:175]
    v_add_u32 v6, 32768, v6
    s_getpc_b64 s[76:77]
K1_CP2:
    s_add_u32 s76, s76, (K1_E1+(24576)-K1_CP2)&0xffffffff
    s_addc_u32 s77, s77, ((K1_E1+(24576)-K1_CP2)>>32)&0xffffffff
    global_load_dword a0, v28, s[76:77]
    v_exp_f32 v61, v49
    v_exp_f32 v130, v130
    s_waitcnt lgkmcnt(4)
    v_mfma_f32_32x32x16_bf16 v[160:175], a[236:239], v[76:79], v[160:175]
    v_add_u32 v7, 32768, v7
    v_exp_f32 v131, v131
    v_exp_f32 v62, v50
    v_add_f32 v21, v21, v130
    s_waitcnt lgkmcnt(3)
    v_mfma_f32_32x32x16_bf16 v[160:175], a[240:243], v[80:83], v[160:175]
    v_add_u32 v8, 32768, v8
    v_exp_f32 v63, v51
    v_cvt_pk_bf16_f32 v193, v130, v131
    v_add_f32 v21, v21, v131
    v_exp_f32 v132, v132
    v_add_f32 v60, 1.0, v60
    v_add_f32 v61, 1.0, v61
    s_waitcnt lgkmcnt(2)
    v_mfma_f32_32x32x16_bf16 v[160:175], a[244:247], v[84:87], v[160:175]
    v_add_u32 v9, 32768, v9
    v_exp_f32 v133, v133
    v_add_f32 v62, 1.0, v62
    v_add_f32 v21, v21, v132
    v_add_f32 v63, 1.0, v63
    v_cvt_pk_bf16_f32 v194, v132, v133
    s_waitcnt lgkmcnt(1)
    v_mfma_f32_32x32x16_bf16 v[160:175], a[248:251], v[88:91], v[160:175]
    v_add_u32 v10, 32768, v10
    v_rcp_f32 v60, v60
    v_add_f32 v21, v21, v133
    v_exp_f32 v134, v134
    v_rcp_f32 v61, v61
    s_waitcnt lgkmcnt(0)
    v_mfma_f32_32x32x16_bf16 v[160:175], a[252:255], v[92:95], v[160:175]
    v_add_u32 v11, 32768, v11
    v_exp_f32 v135, v135
    v_add_f32 v21, v21, v134
    v_rcp_f32 v62, v62
    v_cvt_pk_bf16_f32 v195, v134, v135
    v_mfma_f32_32x32x16_bf16 v[176:191], a[224:227], v[96:99], v[240:255]
    v_add_f32 v21, v21, v135
    v_rcp_f32 v63, v63
    v_exp_f32 v136, v136
    v_exp_f32 v137, v137
    v_mul_f32 v1, v60, v52
    v_mfma_f32_32x32x16_bf16 v[176:191], a[228:231], v[100:103], v[176:191]
    ds_read_b64_tr_b16 v[32:33], v12 offset:8192
    v_mul_f32 v2, v61, v53
    v_add_f32 v21, v21, v136
    v_mul_f32 v3, v62, v54
    v_cvt_pk_bf16_f32 v196, v136, v137
    v_add_f32 v21, v21, v137
    v_mul_f32 v29, v63, v55
    v_mfma_f32_32x32x16_bf16 v[176:191], a[232:235], v[104:107], v[176:191]
    ds_read_b64_tr_b16 v[34:35], v12 offset:10240
    v_exp_f32 v138, v138
    ds_read_b128 v[48:51], v27 offset:800
    ds_read_b128 v[52:55], v27 offset:864
    v_exp_f32 v139, v139
    v_cvt_pk_bf16_f32 v56, v1, v2
    v_mfma_f32_32x32x16_bf16 v[176:191], a[236:239], v[108:111], v[176:191]
    ds_read_b64_tr_b16 v[36:37], v13 offset:8192
    v_add_f32 v21, v21, v138
    v_cvt_pk_bf16_f32 v57, v3, v29
    v_cvt_pk_bf16_f32 v197, v138, v139
    v_accvgpr_read_b32 v60, a84
    v_add_f32 v21, v21, v139
    v_mfma_f32_32x32x16_bf16 v[176:191], a[240:243], v[112:115], v[176:191]
    ds_read_b64_tr_b16 v[38:39], v13 offset:10240
    v_exp_f32 v140, v140
    v_accvgpr_read_b32 v1, a92
    v_accvgpr_read_b32 v61, a85
    v_exp_f32 v141, v141
    v_accvgpr_read_b32 v2, a93
    v_add_f32 v21, v21, v140
    v_mfma_f32_32x32x16_bf16 v[176:191], a[244:247], v[116:119], v[176:191]
    ds_read_b64_tr_b16 v[40:41], v14 offset:8192
    v_accvgpr_read_b32 v62, a86
    v_cvt_pk_bf16_f32 v198, v140, v141
    v_accvgpr_read_b32 v3, a94
    v_add_f32 v21, v21, v141
    v_accvgpr_read_b32 v63, a87
    v_mfma_f32_32x32x16_bf16 v[176:191], a[248:251], v[120:123], v[176:191]
    ds_read_b64_tr_b16 v[42:43], v14 offset:10240
    v_exp_f32 v142, v142
    v_accvgpr_read_b32 v29, a95
    v_exp_f32 v143, v143
    s_waitcnt lgkmcnt(5)
    v_mul_f32 v48, v48, v24
    s_waitcnt lgkmcnt(4)
    v_mul_f32 v52, v52, v24
    v_add_f32 v21, v21, v142
    v_mfma_f32_32x32x16_bf16 v[176:191], a[252:255], v[124:127], v[176:191]
    ds_read_b64_tr_b16 v[44:45], v15 offset:8192
    v_cvt_pk_bf16_f32 v199, v142, v143
    v_mul_f32 v49, v49, v24
    v_add_f32 v21, v21, v143
    v_mul_f32 v53, v53, v24
    v_exp_f32 v144, v144
    v_mfma_f32_32x32x16_bf16 a[96:111], v[32:35], v[208:211], a[96:111]
    ds_read_b64_tr_b16 v[46:47], v15 offset:10240
    v_mul_f32 v50, v50, v24
    v_mul_f32 v54, v54, v24
    v_exp_f32 v145, v145
    v_mul_f32 v51, v51, v24
    v_add_f32 v22, v22, v144
    v_mul_f32 v55, v55, v24
    v_mfma_f32_32x32x16_bf16 a[160:175], v[32:35], v[216:219], a[160:175]
    ds_read_b64_tr_b16 v[32:33], v12 offset:12288
    v_cvt_pk_bf16_f32 v200, v144, v145
    v_fmac_f32 v48, v60, v31
    v_add_f32 v22, v22, v145
    v_exp_f32 v146, v146
    v_fmac_f32 v52, v1, v26
    s_waitcnt lgkmcnt(5)
    v_mfma_f32_32x32x16_bf16 a[112:127], v[36:39], v[208:211], a[112:127]
    ds_read_b64_tr_b16 v[34:35], v12 offset:14336
    v_fmac_f32 v49, v61, v31
    v_exp_f32 v147, v147
    v_fmac_f32 v53, v2, v26
    v_add_f32 v22, v22, v146
    v_fmac_f32 v50, v62, v31
    v_cvt_pk_bf16_f32 v201, v146, v147
    v_mfma_f32_32x32x16_bf16 a[176:191], v[36:39], v[216:219], a[176:191]
    ds_read_b64_tr_b16 v[36:37], v13 offset:12288
    v_fmac_f32 v54, v3, v26
    v_add_f32 v22, v22, v147
    v_fmac_f32 v51, v63, v31
    v_exp_f32 v148, v148
    v_fmac_f32 v55, v29, v26
    s_waitcnt lgkmcnt(5)
    v_mfma_f32_32x32x16_bf16 a[128:143], v[40:43], v[208:211], a[128:143]
    ds_read_b64_tr_b16 v[38:39], v13 offset:14336
    v_exp_f32 v149, v149
    v_exp_f32 v60, v48
    v_add_f32 v22, v22, v148
    v_cvt_pk_bf16_f32 v202, v148, v149
    v_mfma_f32_32x32x16_bf16 a[192:207], v[40:43], v[216:219], a[192:207]
    ds_read_b64_tr_b16 v[40:41], v14 offset:12288
    v_exp_f32 v61, v49
    v_add_f32 v22, v22, v149
    v_exp_f32 v150, v150
    v_exp_f32 v62, v50
    s_waitcnt lgkmcnt(5)
    v_mfma_f32_32x32x16_bf16 a[144:159], v[44:47], v[208:211], a[144:159]
    ds_read_b64_tr_b16 v[42:43], v14 offset:14336
    v_exp_f32 v151, v151
    v_exp_f32 v63, v51
    v_add_f32 v22, v22, v150
    v_cvt_pk_bf16_f32 v203, v150, v151
    v_add_f32 v22, v22, v151
    v_mfma_f32_32x32x16_bf16 a[208:223], v[44:47], v[216:219], a[208:223]
    ds_read_b64_tr_b16 v[44:45], v15 offset:12288
    s_waitcnt vmcnt(19)
    s_barrier
    v_add_f32 v60, 1.0, v60
    v_exp_f32 v152, v152
    v_add_f32 v61, 1.0, v61
    s_waitcnt lgkmcnt(5)
    v_mfma_f32_32x32x16_bf16 a[96:111], v[32:35], v[212:215], a[96:111]
    ds_read_b64_tr_b16 v[46:47], v15 offset:14336
    ds_read_b128 a[224:227], v4 offset:0
    v_add_f32 v62, 1.0, v62
    v_exp_f32 v153, v153
    v_add_f32 v63, 1.0, v63
    v_add_f32 v22, v22, v152
    v_mfma_f32_32x32x16_bf16 a[160:175], v[32:35], v[220:223], a[160:175]
    ds_read_b128 a[228:231], v5 offset:0
    v_add_u32 v12, 4294885376, v12
    v_rcp_f32 v60, v60
    v_cvt_pk_bf16_f32 v204, v152, v153
    v_add_f32 v22, v22, v153
    v_rcp_f32 v61, v61
    s_waitcnt lgkmcnt(6)
    v_mfma_f32_32x32x16_bf16 a[112:127], v[36:39], v[212:215], a[112:127]
    ds_read_b128 a[232:235], v6 offset:0
    v_add_u32 v13, 4294885376, v13
    v_exp_f32 v154, v154
    v_exp_f32 v155, v155
    v_rcp_f32 v62, v62
    v_mfma_f32_32x32x16_bf16 a[176:191], v[36:39], v[220:223], a[176:191]
    ds_read_b128 a[236:239], v7 offset:0
    v_add_u32 v14, 4294885376, v14
    v_add_f32 v22, v22, v154
    v_cvt_pk_bf16_f32 v205, v154, v155
    v_rcp_f32 v63, v63
    v_add_f32 v22, v22, v155
    s_waitcnt lgkmcnt(6)
    v_mfma_f32_32x32x16_bf16 a[128:143], v[40:43], v[212:215], a[128:143]
    ds_read_b128 a[240:243], v8 offset:0
    v_add_u32 v15, 4294885376, v15
    v_exp_f32 v156, v156
    v_mul_f32 v1, v60, v52
    v_exp_f32 v157, v157
    v_mul_f32 v2, v61, v53
    v_mfma_f32_32x32x16_bf16 a[192:207], v[40:43], v[220:223], a[192:207]
    ds_read_b128 a[244:247], v9 offset:0
    buffer_store_dwordx4 a[8:11], v0, s[28:31], s62 offen offset:1024 sc1
    v_mul_f32 v3, v62, v54
    v_add_f32 v22, v22, v156
    v_mul_f32 v29, v63, v55
    v_cvt_pk_bf16_f32 v206, v156, v157
    v_add_f32 v22, v22, v157
    s_waitcnt lgkmcnt(6)
    v_mfma_f32_32x32x16_bf16 a[144:159], v[44:47], v[212:215], a[144:159]
    ds_read_b128 a[248:251], v10 offset:0
    v_cvt_pk_bf16_f32 v58, v1, v2
    v_exp_f32 v158, v158
    v_cvt_pk_bf16_f32 v59, v3, v29
    v_mfma_f32_32x32x16_bf16 a[208:223], v[44:47], v[220:223], a[208:223]
    ds_read_b128 a[252:255], v11 offset:0
    s_cmp_ge_u32 s63, 28
    s_cbranch_scc1 K1_HS11
    s_add_u32 s47, s56, 88064
    buffer_store_dwordx4 v[56:59], v0, s[28:31], s47 offen offset:2048 sc1
K1_HS11:
    v_exp_f32 v159, v159
    v_add_f32 v22, v22, v158
    v_cvt_pk_bf16_f32 v207, v158, v159
    v_add_f32 v22, v22, v159
    s_waitcnt lgkmcnt(7)
    v_mfma_f32_32x32x16_bf16 v[128:143], a[224:227], v[64:67], v[224:239]
    v_exp_f32 v160, v160
    v_exp_f32 v161, v161
    v_add_f32 v21, v21, v160
    s_waitcnt lgkmcnt(6)
    v_mfma_f32_32x32x16_bf16 v[128:143], a[228:231], v[68:71], v[128:143]
    s_add_u32 m0, s42, 98304
    s_add_u32 s46, s43, 98304
    buffer_load_dwordx4 v20, s[24:27], s46 offen lds
    v_cvt_pk_bf16_f32 v208, v160, v161
    s_waitcnt lgkmcnt(5)
    v_mfma_f32_32x32x16_bf16 v[128:143], a[232:235], v[72:75], v[128:143]
    v_add_f32 v21, v21, v161
    v_exp_f32 v162, v162
    v_exp_f32 v163, v163
    s_waitcnt lgkmcnt(4)
    v_mfma_f32_32x32x16_bf16 v[128:143], a[236:239], v[76:79], v[128:143]
    buffer_load_dwordx4 v20, s[24:27], s46 offen offset:1024 lds
    v_add_f32 v21, v21, v162
    v_cvt_pk_bf16_f32 v209, v162, v163
    v_add_f32 v21, v21, v163
    s_waitcnt lgkmcnt(3)
    v_mfma_f32_32x32x16_bf16 v[128:143], a[240:243], v[80:83], v[128:143]
    v_exp_f32 v164, v164
    v_exp_f32 v165, v165
    v_add_f32 v21, v21, v164
    s_waitcnt lgkmcnt(2)
    v_mfma_f32_32x32x16_bf16 v[128:143], a[244:247], v[84:87], v[128:143]
    buffer_load_dwordx4 v20, s[24:27], s46 offen offset:2048 lds
    v_cvt_pk_bf16_f32 v210, v164, v165
    v_add_f32 v21, v21, v165
    v_exp_f32 v166, v166
    s_waitcnt lgkmcnt(1)
    v_mfma_f32_32x32x16_bf16 v[128:143], a[248:251], v[88:91], v[128:143]
    v_exp_f32 v167, v167
    v_add_f32 v21, v21, v166
    v_cvt_pk_bf16_f32 v211, v166, v167
    s_waitcnt lgkmcnt(0)
    v_mfma_f32_32x32x16_bf16 v[128:143], a[252:255], v[92:95], v[128:143]
    buffer_load_dwordx4 v20, s[24:27], s46 offen offset:3072 lds
    v_add_f32 v21, v21, v167
    v_exp_f32 v168, v168
    v_mfma_f32_32x32x16_bf16 v[144:159], a[224:227], v[96:99], v[240:255]
    v_exp_f32 v169, v169
    v_add_f32 v21, v21, v168
    v_cvt_pk_bf16_f32 v212, v168, v169
    v_add_f32 v21, v21, v169
    v_mfma_f32_32x32x16_bf16 v[144:159], a[228:231], v[100:103], v[144:159]
    ds_read_b64_tr_b16 v[32:33], v12 offset:0
    s_add_u32 m0, s42, 114688
    s_add_u32 s46, s43, 114688
    buffer_load_dwordx4 v20, s[24:27], s46 offen lds
    v_mfma_f32_32x32x16_bf16 v[144:159], a[232:235], v[104:107], v[144:159]
    ds_read_b64_tr_b16 v[34:35], v12 offset:2048
    v_exp_f32 v170, v170
    v_exp_f32 v171, v171
    v_add_f32 v21, v21, v170
    v_mfma_f32_32x32x16_bf16 v[144:159], a[236:239], v[108:111], v[144:159]
    ds_read_b64_tr_b16 v[36:37], v13 offset:0
    buffer_load_dwordx4 v20, s[24:27], s46 offen offset:1024 lds
    v_cvt_pk_bf16_f32 v213, v170, v171
    v_add_f32 v21, v21, v171
    v_mfma_f32_32x32x16_bf16 v[144:159], a[240:243], v[112:115], v[144:159]
    ds_read_b64_tr_b16 v[38:39], v13 offset:2048
    v_exp_f32 v172, v172
    v_exp_f32 v173, v173
    v_mfma_f32_32x32x16_bf16 v[144:159], a[244:247], v[116:119], v[144:159]
    ds_read_b64_tr_b16 v[40:41], v14 offset:0
    buffer_load_dwordx4 v20, s[24:27], s46 offen offset:2048 lds
    v_add_f32 v21, v21, v172
    v_cvt_pk_bf16_f32 v214, v172, v173
    v_add_f32 v21, v21, v173
    v_mfma_f32_32x32x16_bf16 v[144:159], a[248:251], v[120:123], v[144:159]
    ds_read_b64_tr_b16 v[42:43], v14 offset:2048
    v_exp_f32 v174, v174
    v_mfma_f32_32x32x16_bf16 v[144:159], a[252:255], v[124:127], v[144:159]
    ds_read_b64_tr_b16 v[44:45], v15 offset:0
    buffer_load_dwordx4 v20, s[24:27], s46 offen offset:3072 lds
    v_exp_f32 v175, v175
    v_add_f32 v21, v21, v174
    v_cvt_pk_bf16_f32 v215, v174, v175
    s_waitcnt lgkmcnt(5)
    v_mfma_f32_32x32x16_bf16 a[96:111], v[32:35], v[192:195], a[96:111]
    ds_read_b64_tr_b16 v[46:47], v15 offset:2048
    v_add_f32 v21, v21, v175
    v_exp_f32 v176, v176
    v_mfma_f32_32x32x16_bf16 a[160:175], v[32:35], v[200:203], a[160:175]
    ds_read_b64_tr_b16 v[32:33], v12 offset:4096
    v_exp_f32 v177, v177
    v_add_f32 v22, v22, v176
    v_cvt_pk_bf16_f32 v216, v176, v177
    s_waitcnt lgkmcnt(5)
    v_mfma_f32_32x32x16_bf16 a[112:127], v[36:39], v[192:195], a[112:127]
    ds_read_b64_tr_b16 v[34:35], v12 offset:6144
    v_add_f32 v22, v22, v177
    v_exp_f32 v178, v178
    v_mfma_f32_32x32x16_bf16 a[176:191], v[36:39], v[200:203], a[176:191]
    ds_read_b64_tr_b16 v[36:37], v13 offset:4096
    v_exp_f32 v179, v179
    v_add_f32 v22, v22, v178
    v_cvt_pk_bf16_f32 v217, v178, v179
    v_add_f32 v22, v22, v179
    s_waitcnt lgkmcnt(5)
    v_mfma_f32_32x32x16_bf16 a[128:143], v[40:43], v[192:195], a[128:143]
    ds_read_b64_tr_b16 v[38:39], v13 offset:6144
    v_exp_f32 v180, v180
    v_mfma_f32_32x32x16_bf16 a[192:207], v[40:43], v[200:203], a[192:207]
    ds_read_b64_tr_b16 v[40:41], v14 offset:4096
    v_exp_f32 v181, v181
    v_add_f32 v22, v22, v180
    v_cvt_pk_bf16_f32 v218, v180, v181
    v_add_f32 v22, v22, v181
    s_waitcnt lgkmcnt(5)
    v_mfma_f32_32x32x16_bf16 a[144:159], v[44:47], v[192:195], a[144:159]
    ds_read_b64_tr_b16 v[42:43], v14 offset:6144
    v_exp_f32 v182, v182
    v_mfma_f32_32x32x16_bf16 a[208:223], v[44:47], v[200:203], a[208:223]
    ds_read_b64_tr_b16 v[44:45], v15 offset:4096
    v_exp_f32 v183, v183
    v_add_f32 v22, v22, v182
    v_cvt_pk_bf16_f32 v219, v182, v183
    v_add_f32 v22, v22, v183
    s_waitcnt lgkmcnt(5)
    v_mfma_f32_32x32x16_bf16 a[96:111], v[32:35], v[196:199], a[96:111]
    ds_read_b64_tr_b16 v[46:47], v15 offset:6144
    ds_read_b128 a[224:227], v4 offset:8192
    v_exp_f32 v184, v184
    v_mfma_f32_32x32x16_bf16 a[160:175], v[32:35], v[204:207], a[160:175]
    ds_read_b128 a[228:231], v5 offset:8192
    v_exp_f32 v185, v185
    v_add_f32 v22, v22, v184
    v_cvt_pk_bf16_f32 v220, v184, v185
    s_waitcnt lgkmcnt(6)
    v_mfma_f32_32x32x16_bf16 a[112:127], v[36:39], v[196:199], a[112:127]
    ds_read_b128 a[232:235], v6 offset:8192
    v_add_f32 v22, v22, v185
    v_exp_f32 v186, v186
    v_mfma_f32_32x32x16_bf16 a[176:191], v[36:39], v[204:207], a[176:191]
    ds_read_b128 a[236:239], v7 offset:8192
    v_exp_f32 v187, v187
    v_add_f32 v22, v22, v186
    v_cvt_pk_bf16_f32 v221, v186, v187
    v_add_f32 v22, v22, v187
    s_waitcnt lgkmcnt(6)
    v_mfma_f32_32x32x16_bf16 a[128:143], v[40:43], v[196:199], a[128:143]
    ds_read_b128 a[240:243], v8 offset:8192
    v_exp_f32 v188, v188
    v_mfma_f32_32x32x16_bf16 a[192:207], v[40:43], v[204:207], a[192:207]
    ds_read_b128 a[244:247], v9 offset:8192
    v_exp_f32 v189, v189
    v_add_f32 v22, v22, v188
    v_cvt_pk_bf16_f32 v222, v188, v189
    v_add_f32 v22, v22, v189
    s_waitcnt lgkmcnt(6)
    v_mfma_f32_32x32x16_bf16 a[144:159], v[44:47], v[196:199], a[144:159]
    ds_read_b128 a[248:251], v10 offset:8192
    v_exp_f32 v190, v190
    v_mfma_f32_32x32x16_bf16 a[208:223], v[44:47], v[204:207], a[208:223]
    ds_read_b128 a[252:255], v11 offset:8192
    v_exp_f32 v191, v191
    v_add_f32 v22, v22, v190
    v_cvt_pk_bf16_f32 v223, v190, v191
    v_add_f32 v22, v22, v191
    s_waitcnt lgkmcnt(7)
    v_mfma_f32_32x32x16_bf16 v[160:175], a[224:227], v[64:67], v[224:239]
    v_add_u32 v4, 4294852608, v4
    v_exp_f32 v128, v128
    v_exp_f32 v129, v129
    s_waitcnt lgkmcnt(6)
    v_mfma_f32_32x32x16_bf16 v[160:175], a[228:231], v[68:71], v[160:175]
    v_add_u32 v5, 4294852608, v5
    v_add_f32 v21, v21, v128
    v_cvt_pk_bf16_f32 v192, v128, v129
    v_add_f32 v21, v21, v129
    s_waitcnt lgkmcnt(5)
    v_mfma_f32_32x32x16_bf16 v[160:175], a[232:235], v[72:75], v[160:175]
    v_add_u32 v6, 4294852608, v6
    v_exp_f32 v130, v130
    v_exp_f32 v131, v131
    s_waitcnt lgkmcnt(4)
    v_mfma_f32_32x32x16_bf16 v[160:175], a[236:239], v[76:79], v[160:175]
    v_add_u32 v7, 4294852608, v7
    v_add_f32 v21, v21, v130
    v_cvt_pk_bf16_f32 v193, v130, v131
    v_add_f32 v21, v21, v131
    s_waitcnt lgkmcnt(3)
    v_mfma_f32_32x32x16_bf16 v[160:175], a[240:243], v[80:83], v[160:175]
    v_add_u32 v8, 4294852608, v8
    v_exp_f32 v132, v132
    v_exp_f32 v133, v133
    s_waitcnt lgkmcnt(2)
    v_mfma_f32_32x32x16_bf16 v[160:175], a[244:247], v[84:87], v[160:175]
    v_add_u32 v9, 4294852608, v9
    v_add_f32 v21, v21, v132
    v_cvt_pk_bf16_f32 v194, v132, v133
    v_add_f32 v21, v21, v133
    s_waitcnt lgkmcnt(1)
    v_mfma_f32_32x32x16_bf16 v[160:175], a[248:251], v[88:91], v[160:175]
    v_add_u32 v10, 4294852608, v10
    v_exp_f32 v134, v134
    v_exp_f32 v135, v135
    v_add_f32 v21, v21, v134
    s_waitcnt lgkmcnt(0)
    v_mfma_f32_32x32x16_bf16 v[160:175], a[252:255], v[92:95], v[160:175]
    v_add_u32 v11, 4294852608, v11
    v_cvt_pk_bf16_f32 v195, v134, v135
    v_add_f32 v21, v21, v135
    v_exp_f32 v136, v136
    v_mfma_f32_32x32x16_bf16 v[176:191], a[224:227], v[96:99], v[240:255]
    v_exp_f32 v137, v137
    v_add_f32 v21, v21, v136
    v_cvt_pk_bf16_f32 v196, v136, v137
    v_mfma_f32_32x32x16_bf16 v[176:191], a[228:231], v[100:103], v[176:191]
    ds_read_b64_tr_b16 v[32:33], v12 offset:8192
    v_add_f32 v21, v21, v137
    v_exp_f32 v138, v138
    v_mfma_f32_32x32x16_bf16 v[176:191], a[232:235], v[104:107], v[176:191]
    ds_read_b64_tr_b16 v[34:35], v12 offset:10240
    v_exp_f32 v139, v139
    v_add_f32 v21, v21, v138
    v_cvt_pk_bf16_f32 v197, v138, v139
    v_add_f32 v21, v21, v139
    v_mfma_f32_32x32x16_bf16 v[176:191], a[236:239], v[108:111], v[176:191]
    ds_read_b64_tr_b16 v[36:37], v13 offset:8192
    v_exp_f32 v140, v140
    v_mfma_f32_32x32x16_bf16 v[176:191], a[240:243], v[112:115], v[176:191]
    ds_read_b64_tr_b16 v[38:39], v13 offset:10240
    v_exp_f32 v141, v141
    v_add_f32 v21, v21, v140
    v_cvt_pk_bf16_f32 v198, v140, v141
    v_add_f32 v21, v21, v141
    v_mfma_f32_32x32x16_bf16 v[176:191], a[244:247], v[116:119], v[176:191]
    ds_read_b64_tr_b16 v[40:41], v14 offset:8192
    v_exp_f32 v142, v142
    v_exp_f32 v143, v143
    v_mfma_f32_32x32x16_bf16 v[176:191], a[248:251], v[120:123], v[176:191]
    ds_read_b64_tr_b16 v[42:43], v14 offset:10240
    v_add_f32 v21, v21, v142
    v_cvt_pk_bf16_f32 v199, v142, v143
    v_add_f32 v21, v21, v143
    v_mfma_f32_32x32x16_bf16 v[176:191], a[252:255], v[124:127], v[176:191]
    ds_read_b64_tr_b16 v[44:45], v15 offset:8192
    v_exp_f32 v144, v144
    v_exp_f32 v145, v145
    s_waitcnt lgkmcnt(5)
    v_mfma_f32_32x32x16_bf16 a[96:111], v[32:35], v[208:211], a[96:111]
    ds_read_b64_tr_b16 v[46:47], v15 offset:10240
    v_add_f32 v22, v22, v144
    v_cvt_pk_bf16_f32 v200, v144, v145
    v_add_f32 v22, v22, v145
    v_mfma_f32_32x32x16_bf16 a[160:175], v[32:35], v[216:219], a[160:175]
    ds_read_b64_tr_b16 v[32:33], v12 offset:12288
    v_exp_f32 v146, v146
    v_exp_f32 v147, v147
    s_waitcnt lgkmcnt(5)
    v_mfma_f32_32x32x16_bf16 a[112:127], v[36:39], v[208:211], a[112:127]
    ds_read_b64_tr_b16 v[34:35], v12 offset:14336
    v_add_f32 v22, v22, v146
    v_cvt_pk_bf16_f32 v201, v146, v147
    v_add_f32 v22, v22, v147
    v_mfma_f32_32x32x16_bf16 a[176:191], v[36:39], v[216:219], a[176:191]
    ds_read_b64_tr_b16 v[36:37], v13 offset:12288
    v_exp_f32 v148, v148
    v_exp_f32 v149, v149
    v_add_f32 v22, v22, v148
    s_waitcnt lgkmcnt(5)
    v_mfma_f32_32x32x16_bf16 a[128:143], v[40:43], v[208:211], a[128:143]
    ds_read_b64_tr_b16 v[38:39], v13 offset:14336
    v_cvt_pk_bf16_f32 v202, v148, v149
    v_add_f32 v22, v22, v149
    v_mfma_f32_32x32x16_bf16 a[192:207], v[40:43], v[216:219], a[192:207]
    ds_read_b64_tr_b16 v[40:41], v14 offset:12288
    v_exp_f32 v150, v150
    v_exp_f32 v151, v151
    v_add_f32 v22, v22, v150
    s_waitcnt lgkmcnt(5)
    v_mfma_f32_32x32x16_bf16 a[144:159], v[44:47], v[208:211], a[144:159]
    ds_read_b64_tr_b16 v[42:43], v14 offset:14336
    v_cvt_pk_bf16_f32 v203, v150, v151
    v_add_f32 v22, v22, v151
    v_exp_f32 v152, v152
    v_mfma_f32_32x32x16_bf16 a[208:223], v[44:47], v[216:219], a[208:223]
    ds_read_b64_tr_b16 v[44:45], v15 offset:12288
    s_waitcnt vmcnt(8)
    s_barrier
    s_cmp_eq_u32 s32, 0
    s_cbranch_scc0 K1_SIGB
    s_lshl_b32 s47, s33, 2
    v_mov_b32 v60, s47
    v_mov_b32 v61, 1
    s_mov_b64 exec, 1
    buffer_store_dword v61, v60, s[28:31], s55 offen offset:128 sc1
    s_mov_b64 exec, -1
K1_SIGB:
    v_exp_f32 v153, v153
    s_waitcnt lgkmcnt(5)
    v_mfma_f32_32x32x16_bf16 a[96:111], v[32:35], v[212:215], a[96:111]
    ds_read_b64_tr_b16 v[46:47], v15 offset:14336
    ds_read_b128 a[224:227], v4 offset:0
    v_add_f32 v22, v22, v152
    v_cvt_pk_bf16_f32 v204, v152, v153
    v_mfma_f32_32x32x16_bf16 a[160:175], v[32:35], v[220:223], a[160:175]
    ds_read_b128 a[228:231], v5 offset:0
    v_add_u32 v12, 65536, v12
    v_add_f32 v22, v22, v153
    v_exp_f32 v154, v154
    s_waitcnt lgkmcnt(6)
    v_mfma_f32_32x32x16_bf16 a[112:127], v[36:39], v[212:215], a[112:127]
    ds_read_b128 a[232:235], v6 offset:0
    v_add_u32 v13, 65536, v13
    v_exp_f32 v155, v155
    v_add_f32 v22, v22, v154
    v_mfma_f32_32x32x16_bf16 a[176:191], v[36:39], v[220:223], a[176:191]
    ds_read_b128 a[236:239], v7 offset:0
    v_add_u32 v14, 65536, v14
    v_cvt_pk_bf16_f32 v205, v154, v155
    v_add_f32 v22, v22, v155
    s_waitcnt lgkmcnt(6)
    v_mfma_f32_32x32x16_bf16 a[128:143], v[40:43], v[212:215], a[128:143]
    ds_read_b128 a[240:243], v8 offset:0
    v_add_u32 v15, 65536, v15
    v_exp_f32 v156, v156
    v_mfma_f32_32x32x16_bf16 a[192:207], v[40:43], v[220:223], a[192:207]
    ds_read_b128 a[244:247], v9 offset:0
    v_exp_f32 v157, v157
    v_add_f32 v22, v22, v156
    v_cvt_pk_bf16_f32 v206, v156, v157
    v_add_f32 v22, v22, v157
    s_waitcnt lgkmcnt(6)
    v_mfma_f32_32x32x16_bf16 a[144:159], v[44:47], v[212:215], a[144:159]
    ds_read_b128 a[248:251], v10 offset:0
    v_exp_f32 v158, v158
    v_mfma_f32_32x32x16_bf16 a[208:223], v[44:47], v[220:223], a[208:223]
    ds_read_b128 a[252:255], v11 offset:0
    v_exp_f32 v159, v159
    v_add_f32 v22, v22, v158
    v_cvt_pk_bf16_f32 v207, v158, v159
    v_add_f32 v22, v22, v159
    s_waitcnt lgkmcnt(7)
    v_mfma_f32_32x32x16_bf16 v[128:143], a[224:227], v[64:67], v[224:239]
    s_mul_i32 s48, s51, 24576
    s_sub_u32 s47, 88064, s48
    s_min_u32 s18, s47, 24576
    s_mul_i32 s47, s59, 88064
    s_add_u32 s47, s47, s48
    s_add_u32 s47, s47, 17825792
    s_add_u32 s16, s28, s47
    s_addc_u32 s17, s29, 0
    s_mov_b32 s19, 0x00020000
    s_mov_b32 s8, s68
    s_mov_b32 s9, s69
    s_lshl_b32 s48, s48, 4
    s_lshl_b32 s47, s18, 4
    s_add_u32 s10, s47, s48
    s_mov_b32 s11, 0x00020000
    s_lshl_b32 s47, s32, 14
    s_lshl_b32 s49, s52, 8
    s_add_u32 s47, s47, s49
    s_add_u32 s37, s48, s47
    s_lshl_b32 s48, s51, 20
    s_add_u32 s39, s48, s47
    s_mov_b32 s12, s66
    s_mov_b32 s13, s67
    s_add_u32 s14, s48, 1048576
    s_mov_b32 s15, 0x00020000
    s_mul_i32 s47, s59, 266496
    s_lshl_b32 s48, s51, 16
    s_add_u32 s47, s47, s48
    s_add_u32 s4, s28, s47
    s_addc_u32 s5, s29, 0
    s_mov_b32 s6, 65536
    s_mov_b32 s7, 0x00020000
    s_waitcnt lgkmcnt(6)
    v_mfma_f32_32x32x16_bf16 v[128:143], a[228:231], v[68:71], v[128:143]
    v_exp_f32 v160, v160
    v_exp_f32 v161, v161
    v_add_f32 v21, v21, v160
    v_cvt_pk_bf16_f32 v208, v160, v161
    s_waitcnt lgkmcnt(5)
    v_mfma_f32_32x32x16_bf16 v[128:143], a[232:235], v[72:75], v[128:143]
    v_add_f32 v21, v21, v161
    v_exp_f32 v162, v162
    v_exp_f32 v163, v163
    s_waitcnt lgkmcnt(4)
    v_mfma_f32_32x32x16_bf16 v[128:143], a[236:239], v[76:79], v[128:143]
    v_add_f32 v21, v21, v162
    v_cvt_pk_bf16_f32 v209, v162, v163
    v_add_f32 v21, v21, v163
    v_exp_f32 v164, v164
    s_waitcnt lgkmcnt(3)
    v_mfma_f32_32x32x16_bf16 v[128:143], a[240:243], v[80:83], v[128:143]
    s_lshr_b32 s47, s2, 3
    s_lshl_b32 s47, s47, 2
    s_add_u32 s47, s47, s32
    s_lshl_b32 s47, s47, 13
    v_lshlrev_b32 v60, 3, v0
    v_add_u32 v60, s47, v60
    s_lshl_b32 s48, s51, 20
    buffer_load_dword v61, v60, s[12:15], s48 offen
    s_mul_i32 s48, s51, 393216
    buffer_load_dword v62, v60, s[8:11], s48 offen
    s_waitcnt lgkmcnt(2)
    v_mfma_f32_32x32x16_bf16 v[128:143], a[244:247], v[84:87], v[128:143]
    s_waitcnt lgkmcnt(1)
    v_mfma_f32_32x32x16_bf16 v[128:143], a[248:251], v[88:91], v[128:143]
    v_exp_f32 v165, v165
    v_add_f32 v21, v21, v164
    v_cvt_pk_bf16_f32 v210, v164, v165
    v_add_f32 v21, v21, v165
    s_waitcnt lgkmcnt(0)
    v_mfma_f32_32x32x16_bf16 v[128:143], a[252:255], v[92:95], v[128:143]
    v_exp_f32 v166, v166
    v_exp_f32 v167, v167
    v_add_f32 v21, v21, v166
    v_cvt_pk_bf16_f32 v211, v166, v167
    v_mfma_f32_32x32x16_bf16 v[144:159], a[224:227], v[96:99], v[240:255]
    v_lshrrev_b32 v2, 8, v0
    v_bfe_u32 v3, v0, 4, 4
    v_lshlrev_b32 v29, 2, v2
    v_xor_b32 v29, v29, v3
    v_lshlrev_b32 v29, 4, v29
    v_lshl_add_u32 v48, v2, 10, v29
    v_add_u32 v49, 3072, v48
    v_add_u32 v50, 6144, v48
    v_add_u32 v51, 9216, v48
    v_mfma_f32_32x32x16_bf16 v[144:159], a[228:231], v[100:103], v[144:159]
    ds_read_b64_tr_b16 v[32:33], v12 offset:0
    v_add_f32 v21, v21, v167
    v_mfma_f32_32x32x16_bf16 v[144:159], a[232:235], v[104:107], v[144:159]
    ds_read_b64_tr_b16 v[34:35], v12 offset:2048
    v_exp_f32 v168, v168
    v_exp_f32 v169, v169
    v_mfma_f32_32x32x16_bf16 v[144:159], a[236:239], v[108:111], v[144:159]
    ds_read_b64_tr_b16 v[36:37], v13 offset:0
    v_add_f32 v21, v21, v168
    v_cvt_pk_bf16_f32 v212, v168, v169
    v_add_f32 v21, v21, v169
    v_mfma_f32_32x32x16_bf16 v[144:159], a[240:243], v[112:115], v[144:159]
    ds_read_b64_tr_b16 v[38:39], v13 offset:2048
    v_exp_f32 v170, v170
    v_exp_f32 v171, v171
    v_add_f32 v21, v21, v170
    v_mfma_f32_32x32x16_bf16 v[144:159], a[244:247], v[116:119], v[144:159]
    ds_read_b64_tr_b16 v[40:41], v14 offset:0
    v_cvt_pk_bf16_f32 v213, v170, v171
    v_add_f32 v21, v21, v171
    v_exp_f32 v172, v172
    v_mfma_f32_32x32x16_bf16 v[144:159], a[248:251], v[120:123], v[144:159]
    ds_read_b64_tr_b16 v[42:43], v14 offset:2048
    v_exp_f32 v173, v173
    v_add_f32 v21, v21, v172
    v_cvt_pk_bf16_f32 v214, v172, v173
    v_mfma_f32_32x32x16_bf16 v[144:159], a[252:255], v[124:127], v[144:159]
    ds_read_b64_tr_b16 v[44:45], v15 offset:0
    v_add_f32 v21, v21, v173
    v_exp_f32 v174, v174
    v_exp_f32 v175, v175
    s_waitcnt lgkmcnt(5)
    v_mfma_f32_32x32x16_bf16 a[96:111], v[32:35], v[192:195], a[96:111]
    ds_read_b64_tr_b16 v[46:47], v15 offset:2048
    v_add_f32 v21, v21, v174
    v_cvt_pk_bf16_f32 v215, v174, v175
    v_add_f32 v21, v21, v175
    v_mfma_f32_32x32x16_bf16 a[160:175], v[32:35], v[200:203], a[160:175]
    ds_read_b64_tr_b16 v[32:33], v12 offset:4096
    v_exp_f32 v176, v176
    v_exp_f32 v177, v177
    v_add_f32 v22, v22, v176
    s_waitcnt lgkmcnt(5)
    v_mfma_f32_32x32x16_bf16 a[112:127], v[36:39], v[192:195], a[112:127]
    ds_read_b64_tr_b16 v[34:35], v12 offset:6144
    v_cvt_pk_bf16_f32 v216, v176, v177
    v_add_f32 v22, v22, v177
    v_exp_f32 v178, v178
    v_mfma_f32_32x32x16_bf16 a[176:191], v[36:39], v[200:203], a[176:191]
    ds_read_b64_tr_b16 v[36:37], v13 offset:4096
    v_exp_f32 v179, v179
    v_add_f32 v22, v22, v178
    v_cvt_pk_bf16_f32 v217, v178, v179
    s_waitcnt lgkmcnt(5)
    v_mfma_f32_32x32x16_bf16 a[128:143], v[40:43], v[192:195], a[128:143]
    ds_read_b64_tr_b16 v[38:39], v13 offset:6144
    v_add_f32 v22, v22, v179
    v_exp_f32 v180, v180
    v_mfma_f32_32x32x16_bf16 a[192:207], v[40:43], v[200:203], a[192:207]
    ds_read_b64_tr_b16 v[40:41], v14 offset:4096
    v_exp_f32 v181, v181
    v_add_f32 v22, v22, v180
    v_cvt_pk_bf16_f32 v218, v180, v181
    v_add_f32 v22, v22, v181
    s_waitcnt lgkmcnt(5)
    v_mfma_f32_32x32x16_bf16 a[144:159], v[44:47], v[192:195], a[144:159]
    ds_read_b64_tr_b16 v[42:43], v14 offset:6144
    v_exp_f32 v182, v182
    v_exp_f32 v183, v183
    v_add_f32 v22, v22, v182
    v_mfma_f32_32x32x16_bf16 a[208:223], v[44:47], v[200:203], a[208:223]
    ds_read_b64_tr_b16 v[44:45], v15 offset:4096
    v_cvt_pk_bf16_f32 v219, v182, v183
    v_add_f32 v22, v22, v183
    v_exp_f32 v184, v184
    s_waitcnt lgkmcnt(5)
    v_mfma_f32_32x32x16_bf16 a[96:111], v[32:35], v[196:199], a[96:111]
    ds_read_b64_tr_b16 v[46:47], v15 offset:6144
    ds_read_b128 a[224:227], v4 offset:8192
    v_exp_f32 v185, v185
    v_add_f32 v22, v22, v184
    v_mfma_f32_32x32x16_bf16 a[160:175], v[32:35], v[204:207], a[160:175]
    ds_read_b128 a[228:231], v5 offset:8192
    v_cvt_pk_bf16_f32 v220, v184, v185
    v_add_f32 v22, v22, v185
    v_exp_f32 v186, v186
    s_waitcnt lgkmcnt(6)
    v_mfma_f32_32x32x16_bf16 a[112:127], v[36:39], v[196:199], a[112:127]
    ds_read_b128 a[232:235], v6 offset:8192
    s_add_u32 m0, s42, 131072
    s_add_u32 s40, s37, 0
    buffer_load_dwordx4 v48, s[8:11], s40 offen lds
    v_mfma_f32_32x32x16_bf16 a[176:191], v[36:39], v[204:207], a[176:191]
    ds_read_b128 a[236:239], v7 offset:8192
    buffer_load_dwordx4 v49, s[8:11], s40 offen offset:1024 lds
    v_exp_f32 v187, v187
    v_add_f32 v22, v22, v186
    v_cvt_pk_bf16_f32 v221, v186, v187
    s_waitcnt lgkmcnt(6)
    v_mfma_f32_32x32x16_bf16 a[128:143], v[40:43], v[196:199], a[128:143]
    ds_read_b128 a[240:243], v8 offset:8192
    buffer_load_dwordx4 v50, s[8:11], s40 offen offset:2048 lds
    v_add_f32 v22, v22, v187
    v_exp_f32 v188, v188
    v_mfma_f32_32x32x16_bf16 a[192:207], v[40:43], v[204:207], a[192:207]
    ds_read_b128 a[244:247], v9 offset:8192
    buffer_load_dwordx4 v51, s[8:11], s40 offen offset:3072 lds
    v_exp_f32 v189, v189
    v_add_f32 v22, v22, v188
    v_cvt_pk_bf16_f32 v222, v188, v189
    s_waitcnt lgkmcnt(6)
    v_mfma_f32_32x32x16_bf16 a[144:159], v[44:47], v[196:199], a[144:159]
    ds_read_b128 a[248:251], v10 offset:8192
    v_add_f32 v22, v22, v189
    v_exp_f32 v190, v190
    v_mfma_f32_32x32x16_bf16 a[208:223], v[44:47], v[204:207], a[208:223]
    ds_read_b128 a[252:255], v11 offset:8192
    v_exp_f32 v191, v191
    v_add_f32 v22, v22, v190
    v_cvt_pk_bf16_f32 v223, v190, v191
    v_add_f32 v22, v22, v191
    s_waitcnt lgkmcnt(7)
    v_mfma_f32_32x32x16_bf16 v[160:175], a[224:227], v[64:67], v[224:239]
    v_add_u32 v4, 32768, v4
    v_exp_f32 v128, v128
    v_exp_f32 v129, v129
    s_waitcnt lgkmcnt(6)
    v_mfma_f32_32x32x16_bf16 v[160:175], a[228:231], v[68:71], v[160:175]
    v_add_u32 v5, 32768, v5
    v_add_f32 v21, v21, v128
    v_cvt_pk_bf16_f32 v192, v128, v129
    v_add_f32 v21, v21, v129
    s_waitcnt lgkmcnt(5)
    v_mfma_f32_32x32x16_bf16 v[160:175], a[232:235], v[72:75], v[160:175]
    v_add_u32 v6, 32768, v6
    v_exp_f32 v130, v130
    v_exp_f32 v131, v131
    v_add_f32 v21, v21, v130
    s_waitcnt lgkmcnt(4)
    v_mfma_f32_32x32x16_bf16 v[160:175], a[236:239], v[76:79], v[160:175]
    v_add_u32 v7, 32768, v7
    v_cvt_pk_bf16_f32 v193, v130, v131
    v_add_f32 v21, v21, v131
    v_exp_f32 v132, v132
    s_waitcnt lgkmcnt(3)
    v_mfma_f32_32x32x16_bf16 v[160:175], a[240:243], v[80:83], v[160:175]
    v_add_u32 v8, 32768, v8
    v_lshrrev_b32 v63, 2, v0
    buffer_load_dword v63, v63, s[28:31], s55 offen sc1
    s_waitcnt lgkmcnt(2)
    v_mfma_f32_32x32x16_bf16 v[160:175], a[244:247], v[84:87], v[160:175]
    v_add_u32 v9, 32768, v9
    v_exp_f32 v133, v133
    v_add_f32 v21, v21, v132
    v_cvt_pk_bf16_f32 v194, v132, v133
    v_add_f32 v21, v21, v133
    s_waitcnt lgkmcnt(1)
    v_mfma_f32_32x32x16_bf16 v[160:175], a[248:251], v[88:91], v[160:175]
    v_add_u32 v10, 32768, v10
    v_exp_f32 v134, v134
    v_exp_f32 v135, v135
    s_waitcnt lgkmcnt(0)
    v_mfma_f32_32x32x16_bf16 v[160:175], a[252:255], v[92:95], v[160:175]
    v_add_u32 v11, 32768, v11
    v_add_f32 v21, v21, v134
    v_cvt_pk_bf16_f32 v195, v134, v135
    v_add_f32 v21, v21, v135
    v_mfma_f32_32x32x16_bf16 v[176:191], a[224:227], v[96:99], v[240:255]
    s_getpc_b64 s[76:77]
K1_CP3:
    s_add_u32 s76, s76, (K1_CODE_END+(-8192)-K1_CP3)&0xffffffff
    s_addc_u32 s77, s77, ((K1_CODE_END+(-8192)-K1_CP3)>>32)&0xffffffff
    global_load_dword a0, v28, s[76:77]
    v_exp_f32 v136, v136
    v_mfma_f32_32x32x16_bf16 v[176:191], a[228:231], v[100:103], v[176:191]
    ds_read_b64_tr_b16 v[32:33], v12 offset:8192
    v_exp_f32 v137, v137
    v_add_f32 v21, v21, v136
    v_cvt_pk_bf16_f32 v196, v136, v137
    v_mfma_f32_32x32x16_bf16 v[176:191], a[232:235], v[104:107], v[176:191]
    ds_read_b64_tr_b16 v[34:35], v12 offset:10240
    v_add_f32 v21, v21, v137
    v_exp_f32 v138, v138
    v_mfma_f32_32x32x16_bf16 v[176:191], a[236:239], v[108:111], v[176:191]
    ds_read_b64_tr_b16 v[36:37], v13 offset:8192
    v_exp_f32 v139, v139
    v_add_f32 v21, v21, v138
    v_cvt_pk_bf16_f32 v197, v138, v139
    v_add_f32 v21, v21, v139
    v_mfma_f32_32x32x16_bf16 v[176:191], a[240:243], v[112:115], v[176:191]
    ds_read_b64_tr_b16 v[38:39], v13 offset:10240
    v_exp_f32 v140, v140
    v_mfma_f32_32x32x16_bf16 v[176:191], a[244:247], v[116:119], v[176:191]
    ds_read_b64_tr_b16 v[40:41], v14 offset:8192
    v_exp_f32 v141, v141
    v_add_f32 v21, v21, v140
    v_cvt_pk_bf16_f32 v198, v140, v141
    v_add_f32 v21, v21, v141
    v_mfma_f32_32x32x16_bf16 v[176:191], a[248:251], v[120:123], v[176:191]
    ds_read_b64_tr_b16 v[42:43], v14 offset:10240
    v_exp_f32 v142, v142
    v_exp_f32 v143, v143
    v_mfma_f32_32x32x16_bf16 v[176:191], a[252:255], v[124:127], v[176:191]
    ds_read_b64_tr_b16 v[44:45], v15 offset:8192
    v_add_f32 v21, v21, v142
    v_cvt_pk_bf16_f32 v199, v142, v143
    v_add_f32 v21, v21, v143
    s_waitcnt lgkmcnt(5)
    v_mfma_f32_32x32x16_bf16 a[96:111], v[32:35], v[208:211], a[96:111]
    ds_read_b64_tr_b16 v[46:47], v15 offset:10240
    v_exp_f32 v144, v144
    v_exp_f32 v145, v145
    v_add_f32 v22, v22, v144
    v_mfma_f32_32x32x16_bf16 a[160:175], v[32:35], v[216:219], a[160:175]
    ds_read_b64_tr_b16 v[32:33], v12 offset:12288
    v_cvt_pk_bf16_f32 v200, v144, v145
    v_add_f32 v22, v22, v145
    v_exp_f32 v146, v146
    s_waitcnt lgkmcnt(5)
    v_mfma_f32_32x32x16_bf16 a[112:127], v[36:39], v[208:211], a[112:127]
    ds_read_b64_tr_b16 v[34:35], v12 offset:14336
    v_exp_f32 v147, v147
    v_add_f32 v22, v22, v146
    v_cvt_pk_bf16_f32 v201, v146, v147
    v_mfma_f32_32x32x16_bf16 a[176:191], v[36:39], v[216:219], a[176:191]
    ds_read_b64_tr_b16 v[36:37], v13 offset:12288
    v_add_f32 v22, v22, v147
    v_exp_f32 v148, v148
    s_waitcnt lgkmcnt(5)
    v_mfma_f32_32x32x16_bf16 a[128:143], v[40:43], v[208:211], a[128:143]
    ds_read_b64_tr_b16 v[38:39], v13 offset:14336
    v_exp_f32 v149, v149
    v_add_f32 v22, v22, v148
    v_cvt_pk_bf16_f32 v202, v148, v149
    v_mfma_f32_32x32x16_bf16 a[192:207], v[40:43], v[216:219], a[192:207]
    ds_read_b64_tr_b16 v[40:41], v14 offset:12288
    v_add_f32 v22, v22, v149
    v_exp_f32 v150, v150
    s_waitcnt lgkmcnt(5)
    v_mfma_f32_32x32x16_bf16 a[144:159], v[44:47], v[208:211], a[144:159]
    ds_read_b64_tr_b16 v[42:43], v14 offset:14336
    v_exp_f32 v151, v151
    v_add_f32 v22, v22, v150
    v_cvt_pk_bf16_f32 v203, v150, v151
    v_add_f32 v22, v22, v151
    v_mfma_f32_32x32x16_bf16 a[208:223], v[44:47], v[216:219], a[208:223]
    ds_read_b64_tr_b16 v[44:45], v15 offset:12288
    s_waitcnt vmcnt(12)
    s_barrier
    v_exp_f32 v152, v152
    s_waitcnt lgkmcnt(5)
    v_mfma_f32_32x32x16_bf16 a[96:111], v[32:35], v[212:215], a[96:111]
    ds_read_b64_tr_b16 v[46:47], v15 offset:14336
    ds_read_b128 a[224:227], v4 offset:0
    v_exp_f32 v153, v153
    v_add_f32 v22, v22, v152
    v_mfma_f32_32x32x16_bf16 a[160:175], v[32:35], v[220:223], a[160:175]
    ds_read_b128 a[228:231], v5 offset:0
    v_add_u32 v12, 32768, v12
    v_cvt_pk_bf16_f32 v204, v152, v153
    v_add_f32 v22, v22, v153
    s_waitcnt lgkmcnt(6)
    v_mfma_f32_32x32x16_bf16 a[112:127], v[36:39], v[212:215], a[112:127]
    ds_read_b128 a[232:235], v6 offset:0
    v_add_u32 v13, 32768, v13
    v_exp_f32 v154, v154
    v_exp_f32 v155, v155
    v_mfma_f32_32x32x16_bf16 a[176:191], v[36:39], v[220:223], a[176:191]
    ds_read_b128 a[236:239], v7 offset:0
    v_add_u32 v14, 32768, v14
    v_add_f32 v22, v22, v154
    v_cvt_pk_bf16_f32 v205, v154, v155
    v_add_f32 v22, v22, v155
    s_waitcnt lgkmcnt(6)
    v_mfma_f32_32x32x16_bf16 a[128:143], v[40:43], v[212:215], a[128:143]
    ds_read_b128 a[240:243], v8 offset:0
    v_add_u32 v15, 32768, v15
    v_exp_f32 v156, v156
    v_mfma_f32_32x32x16_bf16 a[192:207], v[40:43], v[220:223], a[192:207]
    ds_read_b128 a[244:247], v9 offset:0
    v_exp_f32 v157, v157
    v_add_f32 v22, v22, v156
    v_cvt_pk_bf16_f32 v206, v156, v157
    s_waitcnt lgkmcnt(6)
    v_mfma_f32_32x32x16_bf16 a[144:159], v[44:47], v[212:215], a[144:159]
    ds_read_b128 a[248:251], v10 offset:0
    v_add_f32 v22, v22, v157
    v_exp_f32 v158, v158
    v_mfma_f32_32x32x16_bf16 a[208:223], v[44:47], v[220:223], a[208:223]
    ds_read_b128 a[252:255], v11 offset:0
    v_exp_f32 v159, v159
    v_add_f32 v22, v22, v158
    v_cvt_pk_bf16_f32 v207, v158, v159
    v_add_f32 v22, v22, v159
    s_mov_b32 s49, 1400897536
    s_mul_i32 s36, s58, 266496
    s_lshl_b32 s47, s33, 13
    s_add_u32 s36, s36, s47
    s_waitcnt lgkmcnt(7)
    v_mfma_f32_32x32x16_bf16 v[128:143], a[224:227], v[64:67], v[224:239]
    ds_read_b64_tr_b16 v[32:33], v12 offset:0
    ds_read_b64_tr_b16 v[34:35], v12 offset:2048
    ds_read_b64_tr_b16 v[36:37], v13 offset:0
    ds_read_b64_tr_b16 v[38:39], v13 offset:2048
    v_exp_f32 v160, v160
    s_waitcnt lgkmcnt(10)
    v_mfma_f32_32x32x16_bf16 v[128:143], a[228:231], v[68:71], v[128:143]
    ds_read_b64_tr_b16 v[40:41], v14 offset:0
    ds_read_b64_tr_b16 v[42:43], v14 offset:2048
    ds_read_b128 a[224:227], v4 offset:8192
    v_exp_f32 v161, v161
    v_add_f32 v21, v21, v160
    v_cvt_pk_bf16_f32 v208, v160, v161
    s_waitcnt lgkmcnt(12)
    v_mfma_f32_32x32x16_bf16 v[128:143], a[232:235], v[72:75], v[128:143]
    ds_read_b64_tr_b16 v[44:45], v15 offset:0
    ds_read_b64_tr_b16 v[46:47], v15 offset:2048
    ds_read_b128 a[228:231], v5 offset:8192
    v_add_f32 v21, v21, v161
    v_exp_f32 v162, v162
    s_waitcnt lgkmcnt(14)
    v_mfma_f32_32x32x16_bf16 v[128:143], a[236:239], v[76:79], v[128:143]
    ds_read_b64_tr_b16 v[144:145], v12 offset:4096
    ds_read_b64_tr_b16 v[146:147], v12 offset:6144
    ds_read_b128 a[232:235], v6 offset:8192
    v_exp_f32 v163, v163
    v_add_f32 v21, v21, v162
    v_cvt_pk_bf16_f32 v209, v162, v163
    s_waitcnt lgkmcnt(15)
    v_mfma_f32_32x32x16_bf16 v[128:143], a[240:243], v[80:83], v[128:143]
    ds_read_b64_tr_b16 v[148:149], v13 offset:4096
    ds_read_b64_tr_b16 v[150:151], v13 offset:6144
    ds_read_b128 a[236:239], v7 offset:8192
    v_add_f32 v21, v21, v163
    v_exp_f32 v164, v164
    v_mfma_f32_32x32x16_bf16 v[128:143], a[244:247], v[84:87], v[128:143]
    ds_read_b64_tr_b16 v[152:153], v14 offset:4096
    ds_read_b64_tr_b16 v[154:155], v14 offset:6144
    ds_read_b128 a[240:243], v8 offset:8192
    v_exp_f32 v165, v165
    v_add_f32 v21, v21, v164
    v_cvt_pk_bf16_f32 v210, v164, v165
    s_waitcnt lgkmcnt(15)
    v_mfma_f32_32x32x16_bf16 v[128:143], a[248:251], v[88:91], v[128:143]
    ds_read_b64_tr_b16 v[156:157], v15 offset:4096
    ds_read_b64_tr_b16 v[158:159], v15 offset:6144
    ds_read_b128 a[244:247], v9 offset:8192
    v_add_f32 v21, v21, v165
    v_exp_f32 v166, v166
    v_mfma_f32_32x32x16_bf16 v[128:143], a[252:255], v[92:95], v[128:143]
    ds_read_b128 a[248:251], v10 offset:8192
    v_exp_f32 v167, v167
    v_add_f32 v21, v21, v166
    v_cvt_pk_bf16_f32 v211, v166, v167
    v_add_f32 v21, v21, v167
    v_mfma_f32_32x32x16_bf16 a[96:111], v[32:35], v[192:195], a[96:111]
    ds_read_b128 a[252:255], v11 offset:8192
    v_exp_f32 v168, v168
    v_exp_f32 v169, v169
    v_add_f32 v21, v21, v168
    v_cvt_pk_bf16_f32 v212, v168, v169
    v_mfma_f32_32x32x16_bf16 a[112:127], v[36:39], v[192:195], a[112:127]
    s_waitcnt vmcnt(1)
K1_PB:
    v_cmp_ne_u32 vcc, 0, v63
    s_nop 1
    s_cmp_eq_u32 vcc_hi, -1
    s_cbranch_scc0 K1_PB_SPIN
    v_add_f32 v21, v21, v169
    s_waitcnt lgkmcnt(15)
    v_mfma_f32_32x32x16_bf16 a[128:143], v[40:43], v[192:195], a[128:143]
    s_add_u32 m0, s42, 147456
    s_mov_b32 s41, 0
    buffer_load_dwordx4 v0, s[16:19], s41 offen sc1 lds
    v_exp_f32 v170, v170
    v_exp_f32 v171, v171
    v_mfma_f32_32x32x16_bf16 a[144:159], v[44:47], v[192:195], a[144:159]
    v_add_f32 v21, v21, v170
    v_cvt_pk_bf16_f32 v213, v170, v171
    v_add_f32 v21, v21, v171
    v_exp_f32 v172, v172
    v_exp_f32 v173, v173
    s_waitcnt lgkmcnt(12)
    v_mfma_f32_32x32x16_bf16 a[96:111], v[144:147], v[196:199], a[96:111]
    buffer_load_dwordx4 v0, s[16:19], s41 offen offset:1024 sc1 lds
    v_add_f32 v21, v21, v172
    v_cvt_pk_bf16_f32 v214, v172, v173
    v_add_f32 v21, v21, v173
    v_exp_f32 v174, v174
    s_waitcnt lgkmcnt(9)
    v_mfma_f32_32x32x16_bf16 a[112:127], v[148:151], v[196:199], a[112:127]
    v_exp_f32 v175, v175
    v_add_f32 v21, v21, v174
    v_cvt_pk_bf16_f32 v215, v174, v175
    v_add_f32 v21, v21, v175
    s_waitcnt lgkmcnt(6)
    v_mfma_f32_32x32x16_bf16 a[128:143], v[152:155], v[196:199], a[128:143]
    buffer_load_dwordx4 v0, s[16:19], s41 offen offset:2048 sc1 lds
    s_waitcnt lgkmcnt(3)
    v_mfma_f32_32x32x16_bf16 a[144:159], v[156:159], v[196:199], a[144:159]
    ds_read_b64_tr_b16 v[32:33], v12 offset:8192
    ds_read_b64_tr_b16 v[34:35], v12 offset:10240
    v_mfma_f32_32x32x16_bf16 v[160:175], a[224:227], v[64:67], v[224:239]
    ds_read_b64_tr_b16 v[36:37], v13 offset:8192
    ds_read_b64_tr_b16 v[38:39], v13 offset:10240
    buffer_load_dwordx4 v0, s[16:19], s41 offen offset:3072 sc1 lds
    v_exp_f32 v128, v128
    v_exp_f32 v129, v129
    v_mfma_f32_32x32x16_bf16 v[160:175], a[228:231], v[68:71], v[160:175]
    ds_read_b64_tr_b16 v[40:41], v14 offset:8192
    ds_read_b64_tr_b16 v[42:43], v14 offset:10240
    v_add_f32 v21, v21, v128
    v_cvt_pk_bf16_f32 v192, v128, v129
    v_add_f32 v21, v21, v129
    v_exp_f32 v130, v130
    v_mfma_f32_32x32x16_bf16 v[160:175], a[232:235], v[72:75], v[160:175]
    ds_read_b64_tr_b16 v[44:45], v15 offset:8192
    ds_read_b64_tr_b16 v[46:47], v15 offset:10240
    s_add_u32 m0, s42, 0
    s_add_u32 s40, s37, 65536
    buffer_load_dwordx4 v48, s[8:11], s40 offen lds
    v_exp_f32 v131, v131
    v_mfma_f32_32x32x16_bf16 v[160:175], a[236:239], v[76:79], v[160:175]
    ds_read_b64_tr_b16 v[144:145], v12 offset:12288
    ds_read_b64_tr_b16 v[146:147], v12 offset:14336
    v_add_f32 v21, v21, v130
    v_cvt_pk_bf16_f32 v193, v130, v131
    v_add_f32 v21, v21, v131
    v_exp_f32 v132, v132
    v_mfma_f32_32x32x16_bf16 v[160:175], a[240:243], v[80:83], v[160:175]
    s_waitcnt vmcnt(13)
    s_barrier
    ds_read_b64_tr_b16 v[148:149], v13 offset:12288
    ds_read_b64_tr_b16 v[150:151], v13 offset:14336
    buffer_load_dwordx4 v49, s[8:11], s40 offen offset:1024 lds
    v_exp_f32 v133, v133
    s_waitcnt lgkmcnt(14)
    v_mfma_f32_32x32x16_bf16 v[160:175], a[244:247], v[84:87], v[160:175]
    ds_read_b64_tr_b16 v[152:153], v14 offset:12288
    ds_read_b64_tr_b16 v[154:155], v14 offset:14336
    v_add_f32 v21, v21, v132
    v_cvt_pk_bf16_f32 v194, v132, v133
    v_add_f32 v21, v21, v133
    v_exp_f32 v134, v134
    s_waitcnt lgkmcnt(15)
    v_mfma_f32_32x32x16_bf16 v[160:175], a[248:251], v[88:91], v[160:175]
    ds_read_b64_tr_b16 v[156:157], v15 offset:12288
    ds_read_b64_tr_b16 v[158:159], v15 offset:14336
    buffer_load_dwordx4 v50, s[8:11], s40 offen offset:2048 lds
    v_exp_f32 v135, v135
    v_add_f32 v21, v21, v134
    v_cvt_pk_bf16_f32 v195, v134, v135
    s_waitcnt lgkmcnt(15)
    v_mfma_f32_32x32x16_bf16 v[160:175], a[252:255], v[92:95], v[160:175]
    v_add_f32 v21, v21, v135
    v_exp_f32 v136, v136
    v_exp_f32 v137, v137
    v_add_f32 v21, v21, v136
    v_cvt_pk_bf16_f32 v196, v136, v137
    s_waitcnt lgkmcnt(14)
    v_mfma_f32_32x32x16_bf16 a[96:111], v[32:35], v[208:211], a[96:111]
    ds_read_b64_tr_b16 v[32:33], v12 offset:16384
    ds_read_b64_tr_b16 v[34:35], v12 offset:18432
    buffer_load_dwordx4 v51, s[8:11], s40 offen offset:3072 lds
    v_add_f32 v21, v21, v137
    v_exp_f32 v138, v138
    s_waitcnt lgkmcnt(14)
    v_mfma_f32_32x32x16_bf16 a[112:127], v[36:39], v[208:211], a[112:127]
    ds_read_b64_tr_b16 v[36:37], v13 offset:16384
    ds_read_b64_tr_b16 v[38:39], v13 offset:18432
    v_exp_f32 v139, v139
    v_add_f32 v21, v21, v138
    v_cvt_pk_bf16_f32 v197, v138, v139
    v_add_f32 v21, v21, v139
    s_waitcnt lgkmcnt(14)
    v_mfma_f32_32x32x16_bf16 a[128:143], v[40:43], v[208:211], a[128:143]
    ds_read_b64_tr_b16 v[40:41], v14 offset:16384
    ds_read_b64_tr_b16 v[42:43], v14 offset:18432
    s_add_u32 m0, s42, 16384
    s_mov_b32 s41, 4096
    buffer_load_dwordx4 v0, s[16:19], s41 offen sc1 lds
    v_exp_f32 v140, v140
    s_waitcnt lgkmcnt(14)
    v_mfma_f32_32x32x16_bf16 a[144:159], v[44:47], v[208:211], a[144:159]
    ds_read_b64_tr_b16 v[44:45], v15 offset:16384
    ds_read_b64_tr_b16 v[46:47], v15 offset:18432
    v_exp_f32 v141, v141
    v_add_f32 v21, v21, v140
    v_cvt_pk_bf16_f32 v198, v140, v141
    v_add_f32 v21, v21, v141
    v_exp_f32 v142, v142
    v_exp_f32 v143, v143
    v_add_f32 v21, v21, v142
    v_cvt_pk_bf16_f32 v199, v142, v143
    v_add_f32 v21, v21, v143
    s_waitcnt lgkmcnt(14)
    v_mfma_f32_32x32x16_bf16 a[96:111], v[144:147], v[212:215], a[96:111]
    ds_read_b64_tr_b16 v[144:145], v12 offset:20480
    ds_read_b64_tr_b16 v[146:147], v12 offset:22528
    buffer_load_dwordx4 v0, s[16:19], s41 offen offset:1024 sc1 lds
    v_exp_f32 v160, v160
    v_exp_f32 v161, v161
    s_waitcnt lgkmcnt(14)
    v_mfma_f32_32x32x16_bf16 a[112:127], v[148:151], v[212:215], a[112:127]
    ds_read_b64_tr_b16 v[148:149], v13 offset:20480
    ds_read_b64_tr_b16 v[150:151], v13 offset:22528
    v_add_f32 v21, v21, v160
    v_cvt_pk_bf16_f32 v208, v160, v161
    v_add_f32 v21, v21, v161
    v_exp_f32 v162, v162
    s_waitcnt lgkmcnt(14)
    v_mfma_f32_32x32x16_bf16 a[128:143], v[152:155], v[212:215], a[128:143]
    ds_read_b64_tr_b16 v[152:153], v14 offset:20480
    ds_read_b64_tr_b16 v[154:155], v14 offset:22528
    buffer_load_dwordx4 v0, s[16:19], s41 offen offset:2048 sc1 lds
    v_exp_f32 v163, v163
    v_add_f32 v21, v21, v162
    v_cvt_pk_bf16_f32 v209, v162, v163
    s_waitcnt lgkmcnt(14)
    v_mfma_f32_32x32x16_bf16 a[144:159], v[156:159], v[212:215], a[144:159]
    ds_read_b64_tr_b16 v[156:157], v15 offset:20480
    ds_read_b64_tr_b16 v[158:159], v15 offset:22528
    v_add_f32 v21, v21, v163
    v_exp_f32 v164, v164
    v_exp_f32 v165, v165
    s_waitcnt lgkmcnt(14)
    v_mfma_f32_32x32x16_bf16 a[96:111], v[32:35], v[192:195], a[96:111]
    ds_read_b64_tr_b16 v[32:33], v12 offset:24576
    ds_read_b64_tr_b16 v[34:35], v12 offset:26624
    buffer_load_dwordx4 v0, s[16:19], s41 offen offset:3072 sc1 lds
    v_add_f32 v21, v21, v164
    v_cvt_pk_bf16_f32 v210, v164, v165
    v_add_f32 v21, v21, v165
    s_waitcnt lgkmcnt(14)
    v_mfma_f32_32x32x16_bf16 a[112:127], v[36:39], v[192:195], a[112:127]
    ds_read_b64_tr_b16 v[36:37], v13 offset:24576
    ds_read_b64_tr_b16 v[38:39], v13 offset:26624
    v_exp_f32 v166, v166
    v_exp_f32 v167, v167
    v_add_f32 v21, v21, v166
    s_waitcnt lgkmcnt(14)
    v_mfma_f32_32x32x16_bf16 a[128:143], v[40:43], v[192:195], a[128:143]
    ds_read_b64_tr_b16 v[40:41], v14 offset:24576
    ds_read_b64_tr_b16 v[42:43], v14 offset:26624
    s_add_u32 m0, s42, 32768
    s_add_u32 s40, s37, 131072
    buffer_load_dwordx4 v48, s[8:11], s40 offen lds
    v_cvt_pk_bf16_f32 v211, v166, v167
    v_add_f32 v21, v21, v167
    s_waitcnt lgkmcnt(14)
    v_mfma_f32_32x32x16_bf16 a[144:159], v[44:47], v[192:195], a[144:159]
    ds_read_b64_tr_b16 v[44:45], v15 offset:24576
    ds_read_b64_tr_b16 v[46:47], v15 offset:26624
    v_exp_f32 v168, v168
    v_exp_f32 v169, v169
    v_add_f32 v21, v21, v168
    s_waitcnt lgkmcnt(14)
    v_mfma_f32_32x32x16_bf16 a[96:111], v[144:147], v[196:199], a[96:111]
    ds_read_b64_tr_b16 v[144:145], v12 offset:28672
    ds_read_b64_tr_b16 v[146:147], v12 offset:30720
    ds_read_b128 a[224:227], v4 offset:0
    buffer_load_dwordx4 v49, s[8:11], s40 offen offset:1024 lds
    v_cvt_pk_bf16_f32 v212, v168, v169
    v_add_f32 v21, v21, v169
    s_waitcnt lgkmcnt(15)
    v_mfma_f32_32x32x16_bf16 a[112:127], v[148:151], v[196:199], a[112:127]
    ds_read_b64_tr_b16 v[148:149], v13 offset:28672
    ds_read_b64_tr_b16 v[150:151], v13 offset:30720
    ds_read_b128 a[228:231], v5 offset:0
    v_exp_f32 v170, v170
    v_exp_f32 v171, v171
    s_waitcnt lgkmcnt(15)
    v_mfma_f32_32x32x16_bf16 a[128:143], v[152:155], v[196:199], a[128:143]
    ds_read_b64_tr_b16 v[152:153], v14 offset:28672
    ds_read_b64_tr_b16 v[154:155], v14 offset:30720
    ds_read_b128 a[232:235], v6 offset:0
    buffer_load_dwordx4 v50, s[8:11], s40 offen offset:2048 lds
    v_add_f32 v21, v21, v170
    v_cvt_pk_bf16_f32 v213, v170, v171
    v_add_f32 v21, v21, v171
    v_exp_f32 v172, v172
    v_exp_f32 v173, v173
    v_add_f32 v21, v21, v172
    v_cvt_pk_bf16_f32 v214, v172, v173
    v_add_f32 v21, v21, v173
    v_exp_f32 v174, v174
    v_exp_f32 v175, v175
    v_add_f32 v21, v21, v174
    v_cvt_pk_bf16_f32 v215, v174, v175
    v_add_f32 v21, v21, v175
    s_waitcnt lgkmcnt(15)
    v_mfma_f32_32x32x16_bf16 a[144:159], v[156:159], v[196:199], a[144:159]
    ds_read_b64_tr_b16 v[156:157], v15 offset:28672
    ds_read_b64_tr_b16 v[158:159], v15 offset:30720
    ds_read_b128 a[236:239], v7 offset:0
    v_mov_b32 v1, v21
    s_nop 1
    v_permlane32_swap_b32 v1, v21
    v_mfma_f32_32x32x16_bf16 a[96:111], v[32:35], v[208:211], a[96:111]
    ds_read_b128 a[240:243], v8 offset:0
    buffer_load_dwordx4 v51, s[8:11], s40 offen offset:3072 lds
    v_add_f32 v21, v21, v1
    v_cmp_nlt_f32 s[60:61], v21, s49
    v_rcp_f32 v21, v21
    s_waitcnt lgkmcnt(15)
    v_mfma_f32_32x32x16_bf16 a[112:127], v[36:39], v[208:211], a[112:127]
    ds_read_b128 a[244:247], v9 offset:0
    s_add_u32 m0, s42, 65536
    s_add_u32 s40, s37, 196608
    buffer_load_dwordx4 v48, s[8:11], s40 offen lds
    v_mfma_f32_32x32x16_bf16 a[128:143], v[40:43], v[208:211], a[128:143]
    ds_read_b128 a[248:251], v10 offset:0
    buffer_load_dwordx4 v49, s[8:11], s40 offen offset:1024 lds
    s_waitcnt lgkmcnt(15)
    v_mfma_f32_32x32x16_bf16 a[144:159], v[44:47], v[208:211], a[144:159]
    ds_read_b128 a[252:255], v11 offset:0
    buffer_load_dwordx4 v50, s[8:11], s40 offen offset:2048 lds
    s_waitcnt lgkmcnt(14)
    v_mfma_f32_32x32x16_bf16 a[96:111], v[144:147], v[212:215], a[96:111]
    buffer_load_dwordx4 v51, s[8:11], s40 offen offset:3072 lds
    s_waitcnt lgkmcnt(11)
    v_mfma_f32_32x32x16_bf16 a[112:127], v[148:151], v[212:215], a[112:127]
    s_waitcnt lgkmcnt(8)
    v_mfma_f32_32x32x16_bf16 a[128:143], v[152:155], v[212:215], a[128:143]
    s_waitcnt lgkmcnt(5)
    v_mfma_f32_32x32x16_bf16 a[144:159], v[156:159], v[212:215], a[144:159]
    ds_read_b64_tr_b16 v[32:33], v12 offset:0
    ds_read_b64_tr_b16 v[34:35], v12 offset:2048
    v_mfma_f32_32x32x16_bf16 v[144:159], a[224:227], v[96:99], v[240:255]
    ds_read_b64_tr_b16 v[36:37], v13 offset:0
    ds_read_b64_tr_b16 v[38:39], v13 offset:2048
    v_exp_f32 v176, v176
    v_mfma_f32_32x32x16_bf16 v[144:159], a[228:231], v[100:103], v[144:159]
    ds_read_b64_tr_b16 v[40:41], v14 offset:0
    ds_read_b64_tr_b16 v[42:43], v14 offset:2048
    ds_read_b128 a[224:227], v4 offset:8192
    v_mfma_f32_32x32x16_bf16 v[144:159], a[232:235], v[104:107], v[144:159]
    ds_read_b64_tr_b16 v[44:45], v15 offset:0
    ds_read_b64_tr_b16 v[46:47], v15 offset:2048
    ds_read_b128 a[228:231], v5 offset:8192
    s_waitcnt lgkmcnt(14)
    v_mfma_f32_32x32x16_bf16 v[144:159], a[236:239], v[108:111], v[144:159]
    ds_read_b64_tr_b16 v[128:129], v12 offset:4096
    ds_read_b64_tr_b16 v[130:131], v12 offset:6144
    ds_read_b128 a[232:235], v6 offset:8192
    s_waitcnt lgkmcnt(15)
    v_mfma_f32_32x32x16_bf16 v[144:159], a[240:243], v[112:115], v[144:159]
    ds_read_b64_tr_b16 v[132:133], v13 offset:4096
    ds_read_b64_tr_b16 v[134:135], v13 offset:6144
    ds_read_b128 a[236:239], v7 offset:8192
    v_accvgpr_read_b32 v224, a96
    v_accvgpr_read_b32 v225, a97
    v_exp_f32 v177, v177
    v_mfma_f32_32x32x16_bf16 v[144:159], a[244:247], v[116:119], v[144:159]
    ds_read_b64_tr_b16 v[136:137], v14 offset:4096
    ds_read_b64_tr_b16 v[138:139], v14 offset:6144
    ds_read_b128 a[240:243], v8 offset:8192
    v_accvgpr_read_b32 v226, a98
    v_accvgpr_read_b32 v227, a99
    v_add_f32 v22, v22, v176
    v_accvgpr_read_b32 v228, a100
    s_waitcnt lgkmcnt(15)
    v_mfma_f32_32x32x16_bf16 v[144:159], a[248:251], v[120:123], v[144:159]
    ds_read_b64_tr_b16 v[140:141], v15 offset:4096
    ds_read_b64_tr_b16 v[142:143], v15 offset:6144
    ds_read_b128 a[244:247], v9 offset:8192
    v_cvt_pk_bf16_f32 v216, v176, v177
    v_accvgpr_read_b32 v229, a101
    v_add_f32 v22, v22, v177
    v_accvgpr_read_b32 v230, a102
    v_mfma_f32_32x32x16_bf16 v[144:159], a[252:255], v[124:127], v[144:159]
    ds_read_b128 a[248:251], v10 offset:8192
    v_exp_f32 v178, v178
    v_accvgpr_read_b32 v231, a103
    v_mul_f32 v224, v224, v21
    v_exp_f32 v179, v179
    v_mfma_f32_32x32x16_bf16 a[160:175], v[32:35], v[200:203], a[160:175]
    ds_read_b128 a[252:255], v11 offset:8192
    v_mul_f32 v225, v225, v21
    v_mul_f32 v226, v226, v21
    v_add_f32 v22, v22, v178
    v_mul_f32 v227, v227, v21
    v_cvt_pk_bf16_f32 v217, v178, v179
    v_mul_f32 v228, v228, v21
    v_mfma_f32_32x32x16_bf16 a[176:191], v[36:39], v[200:203], a[176:191]
    v_add_f32 v22, v22, v179
    v_mul_f32 v229, v229, v21
    v_exp_f32 v180, v180
    v_mul_f32 v230, v230, v21
    v_mul_f32 v231, v231, v21
    s_waitcnt lgkmcnt(15)
    v_mfma_f32_32x32x16_bf16 a[192:207], v[40:43], v[200:203], a[192:207]
    v_exp_f32 v181, v181
    v_cvt_pk_bf16_f32 v192, v224, v225
    v_cvt_pk_bf16_f32 v193, v226, v227
    v_add_f32 v22, v22, v180
    v_cvt_pk_bf16_f32 v194, v228, v229
    v_cvt_pk_bf16_f32 v218, v180, v181
    v_mfma_f32_32x32x16_bf16 a[208:223], v[44:47], v[200:203], a[208:223]
    v_cvt_pk_bf16_f32 v195, v230, v231
    v_add_f32 v22, v22, v181
    s_add_u32 s50, s36, 0
    buffer_store_dwordx4 v[192:195], v0, s[28:31], s50 offen offset:0 sc1
    v_exp_f32 v182, v182
    v_accvgpr_read_b32 v232, a104
    v_accvgpr_read_b32 v233, a105
    s_waitcnt lgkmcnt(12)
    v_mfma_f32_32x32x16_bf16 a[160:175], v[128:131], v[204:207], a[160:175]
    v_exp_f32 v183, v183
    v_accvgpr_read_b32 v234, a106
    v_accvgpr_read_b32 v235, a107
    v_add_f32 v22, v22, v182
    v_accvgpr_read_b32 v236, a108
    v_cvt_pk_bf16_f32 v219, v182, v183
    s_waitcnt lgkmcnt(9)
    v_mfma_f32_32x32x16_bf16 a[176:191], v[132:135], v[204:207], a[176:191]
    v_accvgpr_read_b32 v237, a109
    v_add_f32 v22, v22, v183
    v_accvgpr_read_b32 v238, a110
    v_exp_f32 v184, v184
    v_accvgpr_read_b32 v239, a111
    v_mul_f32 v232, v232, v21
    s_waitcnt lgkmcnt(6)
    v_mfma_f32_32x32x16_bf16 a[192:207], v[136:139], v[204:207], a[192:207]
    v_exp_f32 v185, v185
    v_mul_f32 v233, v233, v21
    v_mul_f32 v234, v234, v21
    v_add_f32 v22, v22, v184
    v_mul_f32 v235, v235, v21
    v_cvt_pk_bf16_f32 v220, v184, v185
    v_mul_f32 v236, v236, v21
    v_add_f32 v22, v22, v185
    v_mul_f32 v237, v237, v21
    v_exp_f32 v186, v186
    v_mul_f32 v238, v238, v21
    v_mul_f32 v239, v239, v21
    v_exp_f32 v187, v187
    v_cvt_pk_bf16_f32 v196, v232, v233
    v_cvt_pk_bf16_f32 v197, v234, v235
    v_add_f32 v22, v22, v186
    v_cvt_pk_bf16_f32 v198, v236, v237
    v_cvt_pk_bf16_f32 v221, v186, v187
    v_cvt_pk_bf16_f32 v199, v238, v239
    v_add_f32 v22, v22, v187
    buffer_store_dwordx4 v[196:199], v0, s[28:31], s50 offen offset:1024 sc1
    v_exp_f32 v188, v188
    v_accvgpr_read_b32 v224, a112
    v_accvgpr_read_b32 v225, a113
    v_exp_f32 v189, v189
    v_accvgpr_read_b32 v226, a114
    v_accvgpr_read_b32 v227, a115
    v_add_f32 v22, v22, v188
    v_accvgpr_read_b32 v228, a116
    v_cvt_pk_bf16_f32 v222, v188, v189
    v_accvgpr_read_b32 v229, a117
    v_add_f32 v22, v22, v189
    v_accvgpr_read_b32 v230, a118
    v_exp_f32 v190, v190
    v_accvgpr_read_b32 v231, a119
    v_mul_f32 v224, v224, v21
    v_exp_f32 v191, v191
    v_mul_f32 v225, v225, v21
    v_mul_f32 v226, v226, v21
    v_add_f32 v22, v22, v190
    v_mul_f32 v227, v227, v21
    v_cvt_pk_bf16_f32 v223, v190, v191
    v_mul_f32 v228, v228, v21
    v_add_f32 v22, v22, v191
    v_mul_f32 v229, v229, v21
    s_waitcnt lgkmcnt(3)
    v_mfma_f32_32x32x16_bf16 a[208:223], v[140:143], v[204:207], a[208:223]
    ds_read_b64_tr_b16 v[32:33], v12 offset:8192
    ds_read_b64_tr_b16 v[34:35], v12 offset:10240
    v_mfma_f32_32x32x16_bf16 v[176:191], a[224:227], v[96:99], v[240:255]
    ds_read_b64_tr_b16 v[36:37], v13 offset:8192
    ds_read_b64_tr_b16 v[38:39], v13 offset:10240
    v_exp_f32 v144, v144
    v_mul_f32 v230, v230, v21
    v_mul_f32 v231, v231, v21
    v_mfma_f32_32x32x16_bf16 v[176:191], a[228:231], v[100:103], v[176:191]
    ds_read_b64_tr_b16 v[40:41], v14 offset:8192
    ds_read_b64_tr_b16 v[42:43], v14 offset:10240
    v_exp_f32 v145, v145
    v_cvt_pk_bf16_f32 v208, v224, v225
    v_cvt_pk_bf16_f32 v209, v226, v227
    v_add_f32 v22, v22, v144
    v_mfma_f32_32x32x16_bf16 v[176:191], a[232:235], v[104:107], v[176:191]
    ds_read_b64_tr_b16 v[44:45], v15 offset:8192
    ds_read_b64_tr_b16 v[46:47], v15 offset:10240
    v_cvt_pk_bf16_f32 v210, v228, v229
    v_cvt_pk_bf16_f32 v200, v144, v145
    v_cvt_pk_bf16_f32 v211, v230, v231
    v_add_f32 v22, v22, v145
    buffer_store_dwordx4 v[208:211], v0, s[28:31], s50 offen offset:2048 sc1
    v_mfma_f32_32x32x16_bf16 v[176:191], a[236:239], v[108:111], v[176:191]
    ds_read_b64_tr_b16 v[128:129], v12 offset:12288
    ds_read_b64_tr_b16 v[130:131], v12 offset:14336
    v_exp_f32 v146, v146
    v_accvgpr_read_b32 v232, a120
    v_accvgpr_read_b32 v233, a121
    v_mfma_f32_32x32x16_bf16 v[176:191], a[240:243], v[112:115], v[176:191]
    ds_read_b64_tr_b16 v[132:133], v13 offset:12288
    ds_read_b64_tr_b16 v[134:135], v13 offset:14336
    v_exp_f32 v147, v147
    v_accvgpr_read_b32 v234, a122
    v_accvgpr_read_b32 v235, a123
    v_add_f32 v22, v22, v146
    s_waitcnt lgkmcnt(14)
    v_mfma_f32_32x32x16_bf16 v[176:191], a[244:247], v[116:119], v[176:191]
    ds_read_b64_tr_b16 v[136:137], v14 offset:12288
    ds_read_b64_tr_b16 v[138:139], v14 offset:14336
    v_accvgpr_read_b32 v236, a124
    v_cvt_pk_bf16_f32 v201, v146, v147
    v_accvgpr_read_b32 v237, a125
    v_add_f32 v22, v22, v147
    v_accvgpr_read_b32 v238, a126
    s_waitcnt lgkmcnt(15)
    v_mfma_f32_32x32x16_bf16 v[176:191], a[248:251], v[120:123], v[176:191]
    ds_read_b64_tr_b16 v[140:141], v15 offset:12288
    ds_read_b64_tr_b16 v[142:143], v15 offset:14336
    v_exp_f32 v148, v148
    v_accvgpr_read_b32 v239, a127
    v_mul_f32 v232, v232, v21
    s_waitcnt lgkmcnt(15)
    v_mfma_f32_32x32x16_bf16 v[176:191], a[252:255], v[124:127], v[176:191]
    v_exp_f32 v149, v149
    v_mul_f32 v233, v233, v21
    v_mul_f32 v234, v234, v21
    v_add_f32 v22, v22, v148
    v_mul_f32 v235, v235, v21
    v_cvt_pk_bf16_f32 v202, v148, v149
    s_waitcnt lgkmcnt(14)
    v_mfma_f32_32x32x16_bf16 a[160:175], v[32:35], v[216:219], a[160:175]
    ds_read_b64_tr_b16 v[32:33], v12 offset:16384
    ds_read_b64_tr_b16 v[34:35], v12 offset:18432
    v_mul_f32 v236, v236, v21
    v_add_f32 v22, v22, v149
    v_mul_f32 v237, v237, v21
    v_exp_f32 v150, v150
    s_waitcnt lgkmcnt(14)
    v_mfma_f32_32x32x16_bf16 a[176:191], v[36:39], v[216:219], a[176:191]
    ds_read_b64_tr_b16 v[36:37], v13 offset:16384
    ds_read_b64_tr_b16 v[38:39], v13 offset:18432
    v_mul_f32 v238, v238, v21
    v_mul_f32 v239, v239, v21
    v_exp_f32 v151, v151
    v_cvt_pk_bf16_f32 v192, v232, v233
    s_waitcnt lgkmcnt(14)
    v_mfma_f32_32x32x16_bf16 a[192:207], v[40:43], v[216:219], a[192:207]
    ds_read_b64_tr_b16 v[40:41], v14 offset:16384
    ds_read_b64_tr_b16 v[42:43], v14 offset:18432
    v_cvt_pk_bf16_f32 v193, v234, v235
    v_add_f32 v22, v22, v150
    v_cvt_pk_bf16_f32 v194, v236, v237
    v_cvt_pk_bf16_f32 v203, v150, v151
    v_cvt_pk_bf16_f32 v195, v238, v239
    s_waitcnt lgkmcnt(14)
    v_mfma_f32_32x32x16_bf16 a[208:223], v[44:47], v[216:219], a[208:223]
    ds_read_b64_tr_b16 v[44:45], v15 offset:16384
    ds_read_b64_tr_b16 v[46:47], v15 offset:18432
    v_add_f32 v22, v22, v151
    buffer_store_dwordx4 v[192:195], v0, s[28:31], s50 offen offset:3072 sc1
    v_exp_f32 v152, v152
    v_accvgpr_read_b32 v224, a128
    v_accvgpr_read_b32 v225, a129
    v_exp_f32 v153, v153
    v_accvgpr_read_b32 v226, a130
    v_accvgpr_read_b32 v227, a131
    v_add_f32 v22, v22, v152
    v_accvgpr_read_b32 v228, a132
    v_cvt_pk_bf16_f32 v204, v152, v153
    v_accvgpr_read_b32 v229, a133
    v_add_f32 v22, v22, v153
    v_accvgpr_read_b32 v230, a134
    v_exp_f32 v154, v154
    v_accvgpr_read_b32 v231, a135
    v_mul_f32 v224, v224, v21
    v_exp_f32 v155, v155
    v_mul_f32 v225, v225, v21
    v_mul_f32 v226, v226, v21
    v_add_f32 v22, v22, v154
    v_mul_f32 v227, v227, v21
    v_cvt_pk_bf16_f32 v205, v154, v155
    v_mul_f32 v228, v228, v21
    v_add_f32 v22, v22, v155
    v_mul_f32 v229, v229, v21
    v_exp_f32 v156, v156
    v_mul_f32 v230, v230, v21
    v_mul_f32 v231, v231, v21
    v_exp_f32 v157, v157
    v_cvt_pk_bf16_f32 v196, v224, v225
    v_cvt_pk_bf16_f32 v197, v226, v227
    v_add_f32 v22, v22, v156
    v_cvt_pk_bf16_f32 v198, v228, v229
    v_cvt_pk_bf16_f32 v206, v156, v157
    v_cvt_pk_bf16_f32 v199, v230, v231
    v_add_f32 v22, v22, v157
    s_add_u32 s50, s36, 4096
    buffer_store_dwordx4 v[196:199], v0, s[28:31], s50 offen offset:0 sc1
    v_exp_f32 v158, v158
    v_accvgpr_read_b32 v232, a136
    v_accvgpr_read_b32 v233, a137
    v_exp_f32 v159, v159
    v_accvgpr_read_b32 v234, a138
    v_accvgpr_read_b32 v235, a139
    v_add_f32 v22, v22, v158
    v_accvgpr_read_b32 v236, a140
    v_cvt_pk_bf16_f32 v207, v158, v159
    v_accvgpr_read_b32 v237, a141
    v_add_f32 v22, v22, v159
    v_accvgpr_read_b32 v238, a142
    s_waitcnt lgkmcnt(14)
    v_mfma_f32_32x32x16_bf16 a[160:175], v[128:131], v[220:223], a[160:175]
    ds_read_b64_tr_b16 v[128:129], v12 offset:20480
    ds_read_b64_tr_b16 v[130:131], v12 offset:22528
    v_exp_f32 v176, v176
    v_accvgpr_read_b32 v239, a143
    v_mul_f32 v232, v232, v21
    s_waitcnt lgkmcnt(14)
    v_mfma_f32_32x32x16_bf16 a[176:191], v[132:135], v[220:223], a[176:191]
    ds_read_b64_tr_b16 v[132:133], v13 offset:20480
    ds_read_b64_tr_b16 v[134:135], v13 offset:22528
    v_exp_f32 v177, v177
    v_mul_f32 v233, v233, v21
    v_add_f32 v22, v22, v176
    v_cvt_pk_bf16_f32 v216, v176, v177
    s_waitcnt lgkmcnt(14)
    v_mfma_f32_32x32x16_bf16 a[192:207], v[136:139], v[220:223], a[192:207]
    ds_read_b64_tr_b16 v[136:137], v14 offset:20480
    ds_read_b64_tr_b16 v[138:139], v14 offset:22528
    v_mul_f32 v234, v234, v21
    v_add_f32 v22, v22, v177
    v_exp_f32 v178, v178
    v_mul_f32 v235, v235, v21
    s_waitcnt lgkmcnt(14)
    v_mfma_f32_32x32x16_bf16 a[208:223], v[140:143], v[220:223], a[208:223]
    ds_read_b64_tr_b16 v[140:141], v15 offset:20480
    ds_read_b64_tr_b16 v[142:143], v15 offset:22528
    v_exp_f32 v179, v179
    v_mul_f32 v236, v236, v21
    v_add_f32 v22, v22, v178
    v_mul_f32 v237, v237, v21
    s_waitcnt lgkmcnt(14)
    v_mfma_f32_32x32x16_bf16 a[160:175], v[32:35], v[200:203], a[160:175]
    ds_read_b64_tr_b16 v[32:33], v12 offset:24576
    ds_read_b64_tr_b16 v[34:35], v12 offset:26624
    v_cvt_pk_bf16_f32 v217, v178, v179
    v_add_f32 v22, v22, v179
    v_mul_f32 v238, v238, v21
    v_exp_f32 v180, v180
    s_waitcnt lgkmcnt(14)
    v_mfma_f32_32x32x16_bf16 a[176:191], v[36:39], v[200:203], a[176:191]
    ds_read_b64_tr_b16 v[36:37], v13 offset:24576
    ds_read_b64_tr_b16 v[38:39], v13 offset:26624
    v_mul_f32 v239, v239, v21
    v_exp_f32 v181, v181
    v_cvt_pk_bf16_f32 v208, v232, v233
    v_add_f32 v22, v22, v180
    s_waitcnt lgkmcnt(14)
    v_mfma_f32_32x32x16_bf16 a[192:207], v[40:43], v[200:203], a[192:207]
    ds_read_b64_tr_b16 v[40:41], v14 offset:24576
    ds_read_b64_tr_b16 v[42:43], v14 offset:26624
    v_cvt_pk_bf16_f32 v209, v234, v235
    v_cvt_pk_bf16_f32 v218, v180, v181
    v_add_f32 v22, v22, v181
    v_cvt_pk_bf16_f32 v210, v236, v237
    s_waitcnt lgkmcnt(14)
    v_mfma_f32_32x32x16_bf16 a[208:223], v[44:47], v[200:203], a[208:223]
    ds_read_b64_tr_b16 v[44:45], v15 offset:24576
    ds_read_b64_tr_b16 v[46:47], v15 offset:26624
    v_exp_f32 v182, v182
    v_cvt_pk_bf16_f32 v211, v238, v239
    v_exp_f32 v183, v183
    s_waitcnt lgkmcnt(14)
    v_mfma_f32_32x32x16_bf16 a[160:175], v[128:131], v[204:207], a[160:175]
    ds_read_b64_tr_b16 v[128:129], v12 offset:28672
    ds_read_b64_tr_b16 v[130:131], v12 offset:30720
    buffer_store_dwordx4 v[208:211], v0, s[28:31], s50 offen offset:1024 sc1
    v_add_f32 v22, v22, v182
    v_cvt_pk_bf16_f32 v219, v182, v183
    v_accvgpr_read_b32 v224, a144
    v_add_f32 v22, v22, v183
    s_waitcnt lgkmcnt(14)
    v_mfma_f32_32x32x16_bf16 a[176:191], v[132:135], v[204:207], a[176:191]
    ds_read_b64_tr_b16 v[132:133], v13 offset:28672
    ds_read_b64_tr_b16 v[134:135], v13 offset:30720
    v_exp_f32 v184, v184
    v_accvgpr_read_b32 v225, a145
    v_accvgpr_read_b32 v226, a146
    s_waitcnt lgkmcnt(14)
    v_mfma_f32_32x32x16_bf16 a[192:207], v[136:139], v[204:207], a[192:207]
    ds_read_b64_tr_b16 v[136:137], v14 offset:28672
    ds_read_b64_tr_b16 v[138:139], v14 offset:30720
    v_exp_f32 v185, v185
    v_accvgpr_read_b32 v227, a147
    v_add_f32 v22, v22, v184
    v_cvt_pk_bf16_f32 v220, v184, v185
    v_accvgpr_read_b32 v228, a148
    v_add_f32 v22, v22, v185
    v_exp_f32 v186, v186
    v_accvgpr_read_b32 v229, a149
    v_exp_f32 v187, v187
    v_accvgpr_read_b32 v230, a150
    v_add_f32 v22, v22, v186
    v_accvgpr_read_b32 v231, a151
    v_cvt_pk_bf16_f32 v221, v186, v187
    v_add_f32 v22, v22, v187
    v_mul_f32 v224, v224, v21
    v_exp_f32 v188, v188
    v_mul_f32 v225, v225, v21
    v_exp_f32 v189, v189
    v_mul_f32 v226, v226, v21
    v_add_f32 v22, v22, v188
    v_mul_f32 v227, v227, v21
    v_cvt_pk_bf16_f32 v222, v188, v189
    v_add_f32 v22, v22, v189
    v_mul_f32 v228, v228, v21
    v_exp_f32 v190, v190
    v_mul_f32 v229, v229, v21
    v_exp_f32 v191, v191
    v_mul_f32 v230, v230, v21
    v_add_f32 v22, v22, v190
    v_cvt_pk_bf16_f32 v223, v190, v191
    v_mul_f32 v231, v231, v21
    v_add_f32 v22, v22, v191
    s_waitcnt lgkmcnt(14)
    v_mfma_f32_32x32x16_bf16 a[208:223], v[140:143], v[204:207], a[208:223]
    ds_read_b64_tr_b16 v[140:141], v15 offset:28672
    ds_read_b64_tr_b16 v[142:143], v15 offset:30720
    v_mov_b32 v2, v22
    s_nop 1
    v_permlane32_swap_b32 v2, v22
    v_add_f32 v22, v22, v2
    s_waitcnt lgkmcnt(14)
    v_mfma_f32_32x32x16_bf16 a[160:175], v[32:35], v[216:219], a[160:175]
    v_cmp_nlt_f32 vcc, v22, s49
    v_rcp_f32 v22, v22
    v_cvt_pk_bf16_f32 v192, v224, v225
    v_cvt_pk_bf16_f32 v193, v226, v227
    v_cvt_pk_bf16_f32 v194, v228, v229
    v_cvt_pk_bf16_f32 v195, v230, v231
    s_waitcnt lgkmcnt(12)
    v_mfma_f32_32x32x16_bf16 a[176:191], v[36:39], v[216:219], a[176:191]
    buffer_store_dwordx4 v[192:195], v0, s[28:31], s50 offen offset:2048 sc1
    v_accvgpr_read_b32 v232, a152
    v_accvgpr_read_b32 v233, a153
    v_accvgpr_read_b32 v234, a154
    v_accvgpr_read_b32 v235, a155
    v_accvgpr_read_b32 v236, a156
    v_accvgpr_read_b32 v237, a157
    s_waitcnt lgkmcnt(10)
    v_mfma_f32_32x32x16_bf16 a[192:207], v[40:43], v[216:219], a[192:207]
    v_accvgpr_read_b32 v238, a158
    v_accvgpr_read_b32 v239, a159
    v_mul_f32 v232, v232, v21
    v_mul_f32 v233, v233, v21
    v_mul_f32 v234, v234, v21
    v_mul_f32 v235, v235, v21
    v_mul_f32 v236, v236, v21
    s_waitcnt lgkmcnt(8)
    v_mfma_f32_32x32x16_bf16 a[208:223], v[44:47], v[216:219], a[208:223]
    v_mul_f32 v237, v237, v21
    v_mul_f32 v238, v238, v21
    v_mul_f32 v239, v239, v21
    v_cvt_pk_bf16_f32 v196, v232, v233
    v_cvt_pk_bf16_f32 v197, v234, v235
    v_cvt_pk_bf16_f32 v198, v236, v237
    v_cvt_pk_bf16_f32 v199, v238, v239
    s_waitcnt lgkmcnt(6)
    v_mfma_f32_32x32x16_bf16 a[160:175], v[128:131], v[220:223], a[160:175]
    buffer_store_dwordx4 v[196:199], v0, s[28:31], s50 offen offset:3072 sc1
    s_waitcnt lgkmcnt(4)
    v_mfma_f32_32x32x16_bf16 a[176:191], v[132:135], v[220:223], a[176:191]
    s_waitcnt lgkmcnt(2)
    v_mfma_f32_32x32x16_bf16 a[192:207], v[136:139], v[220:223], a[192:207]
    s_waitcnt lgkmcnt(0)
    v_mfma_f32_32x32x16_bf16 a[208:223], v[140:143], v[220:223], a[208:223]
    s_lshl_b32 s47, s32, 2
    s_add_u32 s47, s47, 81920
    v_lshlrev_b32 v3, 8, v0
    v_add_u32 v3, s47, v3
    s_or_b64 vcc, vcc, s[60:61]
    s_cmp_lg_u64 vcc, 0
    s_cselect_b32 s46, 1, 0
    s_andn2_b32 s46, s46, s57
    v_mov_b32 v2, s46
    s_mov_b64 exec, 15
    ds_write_b32 v3, v2
    s_mov_b64 exec, -1
    s_add_u32 s47, s42, 81920
    v_mov_b32 v3, s47
    v_mov_b32 v244, v48
    v_mov_b32 v245, v49
    v_mov_b32 v246, v50
    v_mov_b32 v247, v51
    v_bfe_u32 v1, v0, 6, 2
    v_lshrrev_b32 v29, 9, v0
    v_lshl_add_u32 v252, v29, 2, v1
    v_lshlrev_b32 v252, 8, v252
    v_bfe_u32 v29, v0, 4, 1
    v_lshl_add_u32 v252, v29, 5, v252
    v_bfe_u32 v29, v0, 8, 1
    v_lshl_add_u32 v252, v29, 4, v252
    v_bfe_u32 v29, v0, 5, 1
    v_lshl_add_u32 v252, v29, 3, v252
    v_xor_b32 v248, 0, v1
    v_lshl_add_u32 v248, v248, 6, v252
    v_add_u32 v248, 131072, v248
    v_xor_b32 v249, 1, v1
    v_lshl_add_u32 v249, v249, 6, v252
    v_add_u32 v249, 131072, v249
    v_xor_b32 v250, 2, v1
    v_lshl_add_u32 v250, v250, 6, v252
    v_add_u32 v250, 131072, v250
    v_xor_b32 v251, 3, v1
    v_lshl_add_u32 v251, v251, 6, v252
    v_add_u32 v251, 131072, v251
    s_add_u32 s47, s42, 147456
    v_add_u32 v252, s47, v0
    s_waitcnt vmcnt(24)
    s_waitcnt lgkmcnt(0)
    s_barrier
    ds_read_b128 v[240:243], v3
    ds_read_b128 v[192:195], v252 offset:0
    ds_read_b64_tr_b16 v[32:33], v248 offset:0
    ds_read_b64_tr_b16 v[34:35], v248 offset:2048
    ds_read_b64_tr_b16 v[36:37], v249 offset:0
    ds_read_b64_tr_b16 v[38:39], v249 offset:2048
    ds_read_b128 v[196:199], v252 offset:1024
    ds_read_b64_tr_b16 v[40:41], v250 offset:0
    ds_read_b64_tr_b16 v[42:43], v250 offset:2048
    ds_read_b64_tr_b16 v[44:45], v251 offset:0
    ds_read_b64_tr_b16 v[46:47], v251 offset:2048
    ds_read_b64_tr_b16 v[48:49], v248 offset:4096
    ds_read_b64_tr_b16 v[50:51], v248 offset:6144
    ds_read_b64_tr_b16 v[52:53], v249 offset:4096
    ds_read_b64_tr_b16 v[54:55], v249 offset:6144
    s_waitcnt lgkmcnt(14)
    v_or3_b32 v2, v240, v241, v242
    v_or_b32 v2, v2, v243
    s_nop 0
    v_readfirstlane_b32 s47, v2
    s_nop 0
    s_cmp_lg_u32 s47, 0
    s_cbranch_scc1 K1_REDO
    s_add_u32 m0, s42, 49152
    s_mov_b32 s41, 8192
    buffer_load_dwordx4 v0, s[16:19], s41 offen sc1 lds
    buffer_load_dwordx4 v0, s[16:19], s41 offen offset:1024 sc1 lds
    buffer_load_dwordx4 v0, s[16:19], s41 offen offset:2048 sc1 lds
    buffer_load_dwordx4 v0, s[16:19], s41 offen offset:3072 sc1 lds
    s_waitcnt lgkmcnt(11)
    v_mfma_f32_32x32x16_bf16 v[64:79], v[32:35], v[192:195], 0
    ds_read_b128 v[200:203], v252 offset:2048
    ds_read_b64_tr_b16 v[56:57], v250 offset:4096
    ds_read_b64_tr_b16 v[58:59], v250 offset:6144
    v_accvgpr_read_b32 v208, a160
    v_accvgpr_read_b32 v209, a161
    v_accvgpr_read_b32 v210, a162
    v_accvgpr_read_b32 v211, a163
    v_accvgpr_read_b32 v212, a164
    v_accvgpr_read_b32 v213, a165
    v_accvgpr_read_b32 v214, a166
    v_accvgpr_read_b32 v215, a167
    v_mul_f32 v208, v208, v22
    v_mul_f32 v209, v209, v22
    v_mul_f32 v210, v210, v22
    s_waitcnt lgkmcnt(12)
    v_mfma_f32_32x32x16_bf16 v[80:95], v[36:39], v[192:195], 0
    ds_read_b64_tr_b16 v[60:61], v251 offset:4096
    ds_read_b64_tr_b16 v[62:63], v251 offset:6144
    v_mul_f32 v211, v211, v22
    v_mul_f32 v212, v212, v22
    v_mul_f32 v213, v213, v22
    v_mul_f32 v214, v214, v22
    v_mul_f32 v215, v215, v22
    v_cvt_pk_bf16_f32 v224, v208, v209
    v_cvt_pk_bf16_f32 v225, v210, v211
    v_cvt_pk_bf16_f32 v226, v212, v213
    v_cvt_pk_bf16_f32 v227, v214, v215
    s_add_u32 s50, s36, 266496
    buffer_store_dwordx4 v[224:227], v0, s[28:31], s50 offen offset:0 sc1
    v_accvgpr_read_b32 v216, a168
    v_accvgpr_read_b32 v217, a169
    s_waitcnt lgkmcnt(11)
    v_mfma_f32_32x32x16_bf16 v[96:111], v[40:43], v[192:195], 0
    ds_read_b64_tr_b16 v[32:33], v248 offset:8192
    ds_read_b64_tr_b16 v[34:35], v248 offset:10240
    v_accvgpr_read_b32 v218, a170
    v_accvgpr_read_b32 v219, a171
    v_accvgpr_read_b32 v220, a172
    v_accvgpr_read_b32 v221, a173
    v_accvgpr_read_b32 v222, a174
    v_accvgpr_read_b32 v223, a175
    v_mul_f32 v216, v216, v22
    v_mul_f32 v217, v217, v22
    v_mul_f32 v218, v218, v22
    v_mul_f32 v219, v219, v22
    v_mul_f32 v220, v220, v22
    v_mul_f32 v221, v221, v22
    s_waitcnt lgkmcnt(11)
    v_mfma_f32_32x32x16_bf16 v[112:127], v[44:47], v[192:195], 0
    ds_read_b64_tr_b16 v[36:37], v249 offset:8192
    ds_read_b64_tr_b16 v[38:39], v249 offset:10240
    s_add_u32 m0, s42, 81920
    s_mov_b32 s41, 12288
    buffer_load_dwordx4 v0, s[16:19], s41 offen sc1 lds
    v_mul_f32 v222, v222, v22
    v_mul_f32 v223, v223, v22
    v_cvt_pk_bf16_f32 v228, v216, v217
    v_cvt_pk_bf16_f32 v229, v218, v219
    v_cvt_pk_bf16_f32 v230, v220, v221
    v_cvt_pk_bf16_f32 v231, v222, v223
    buffer_store_dwordx4 v[228:231], v0, s[28:31], s50 offen offset:1024 sc1
    v_accvgpr_read_b32 v208, a176
    v_accvgpr_read_b32 v209, a177
    s_waitcnt lgkmcnt(11)
    v_mfma_f32_32x32x16_bf16 v[64:79], v[48:51], v[196:199], v[64:79]
    ds_read_b128 v[204:207], v252 offset:3072
    ds_read_b64_tr_b16 v[40:41], v250 offset:8192
    ds_read_b64_tr_b16 v[42:43], v250 offset:10240
    v_accvgpr_read_b32 v210, a178
    v_accvgpr_read_b32 v211, a179
    v_accvgpr_read_b32 v212, a180
    v_accvgpr_read_b32 v213, a181
    v_accvgpr_read_b32 v214, a182
    v_accvgpr_read_b32 v215, a183
    v_mul_f32 v208, v208, v22
    v_mul_f32 v209, v209, v22
    v_mul_f32 v210, v210, v22
    v_mul_f32 v211, v211, v22
    v_mul_f32 v212, v212, v22
    s_waitcnt lgkmcnt(12)
    v_mfma_f32_32x32x16_bf16 v[80:95], v[52:55], v[196:199], v[80:95]
    ds_read_b64_tr_b16 v[44:45], v251 offset:8192
    ds_read_b64_tr_b16 v[46:47], v251 offset:10240
    buffer_load_dwordx4 v0, s[16:19], s41 offen offset:1024 sc1 lds
    v_mul_f32 v213, v213, v22
    v_mul_f32 v214, v214, v22
    v_mul_f32 v215, v215, v22
    v_cvt_pk_bf16_f32 v232, v208, v209
    v_cvt_pk_bf16_f32 v233, v210, v211
    v_cvt_pk_bf16_f32 v234, v212, v213
    v_cvt_pk_bf16_f32 v235, v214, v215
    buffer_store_dwordx4 v[232:235], v0, s[28:31], s50 offen offset:2048 sc1
    v_accvgpr_read_b32 v216, a184
    v_accvgpr_read_b32 v217, a185
    v_accvgpr_read_b32 v218, a186
    s_waitcnt lgkmcnt(11)
    v_mfma_f32_32x32x16_bf16 v[96:111], v[56:59], v[196:199], v[96:111]
    ds_read_b64_tr_b16 v[48:49], v248 offset:12288
    ds_read_b64_tr_b16 v[50:51], v248 offset:14336
    v_accvgpr_read_b32 v219, a187
    v_accvgpr_read_b32 v220, a188
    v_accvgpr_read_b32 v221, a189
    v_accvgpr_read_b32 v222, a190
    v_accvgpr_read_b32 v223, a191
    v_mul_f32 v216, v216, v22
    v_mul_f32 v217, v217, v22
    v_mul_f32 v218, v218, v22
    v_mul_f32 v219, v219, v22
    v_mul_f32 v220, v220, v22
    v_mul_f32 v221, v221, v22
    v_mul_f32 v222, v222, v22
    s_waitcnt lgkmcnt(11)
    v_mfma_f32_32x32x16_bf16 v[112:127], v[60:63], v[196:199], v[112:127]
    ds_read_b64_tr_b16 v[52:53], v249 offset:12288
    ds_read_b64_tr_b16 v[54:55], v249 offset:14336
    buffer_load_dwordx4 v0, s[16:19], s41 offen offset:2048 sc1 lds
    v_mul_f32 v223, v223, v22
    v_cvt_pk_bf16_f32 v224, v216, v217
    v_cvt_pk_bf16_f32 v225, v218, v219
    v_cvt_pk_bf16_f32 v226, v220, v221
    v_cvt_pk_bf16_f32 v227, v222, v223
    buffer_store_dwordx4 v[224:227], v0, s[28:31], s50 offen offset:3072 sc1
    v_accvgpr_read_b32 v208, a192
    v_accvgpr_read_b32 v209, a193
    v_accvgpr_read_b32 v210, a194
    v_accvgpr_read_b32 v211, a195
    v_accvgpr_read_b32 v212, a196
    s_waitcnt lgkmcnt(11)
    v_mfma_f32_32x32x16_bf16 v[64:79], v[32:35], v[200:203], v[64:79]
    ds_read_b64_tr_b16 v[56:57], v250 offset:12288
    ds_read_b64_tr_b16 v[58:59], v250 offset:14336
    v_accvgpr_read_b32 v213, a197
    v_accvgpr_read_b32 v214, a198
    v_accvgpr_read_b32 v215, a199
    v_mul_f32 v208, v208, v22
    v_mul_f32 v209, v209, v22
    v_mul_f32 v210, v210, v22
    v_mul_f32 v211, v211, v22
    v_mul_f32 v212, v212, v22
    v_mul_f32 v213, v213, v22
    v_mul_f32 v214, v214, v22
    v_mul_f32 v215, v215, v22
    v_cvt_pk_bf16_f32 v228, v208, v209
    s_waitcnt lgkmcnt(11)
    v_mfma_f32_32x32x16_bf16 v[80:95], v[36:39], v[200:203], v[80:95]
    ds_read_b64_tr_b16 v[60:61], v251 offset:12288
    ds_read_b64_tr_b16 v[62:63], v251 offset:14336
    buffer_load_dwordx4 v0, s[16:19], s41 offen offset:3072 sc1 lds
    v_add_u32 v248, 4294836224, v248
    v_add_u32 v249, 4294836224, v249
    v_add_u32 v250, 4294836224, v250
    v_add_u32 v251, 4294836224, v251
    v_add_u32 v252, 4294836224, v252
    v_cvt_pk_bf16_f32 v229, v210, v211
    v_cvt_pk_bf16_f32 v230, v212, v213
    v_cvt_pk_bf16_f32 v231, v214, v215
    s_add_u32 s50, s36, 270592
    buffer_store_dwordx4 v[228:231], v0, s[28:31], s50 offen offset:0 sc1
    v_accvgpr_read_b32 v216, a200
    v_accvgpr_read_b32 v217, a201
    s_waitcnt lgkmcnt(10)
    v_mfma_f32_32x32x16_bf16 v[96:111], v[40:43], v[200:203], v[96:111]
    s_waitcnt vmcnt(29)
    s_barrier
    ds_read_b128 v[192:195], v252 offset:0
    ds_read_b64_tr_b16 v[32:33], v248 offset:0
    ds_read_b64_tr_b16 v[34:35], v248 offset:2048
    v_accvgpr_read_b32 v218, a202
    v_accvgpr_read_b32 v219, a203
    v_accvgpr_read_b32 v220, a204
    v_accvgpr_read_b32 v221, a205
    v_accvgpr_read_b32 v222, a206
    v_accvgpr_read_b32 v223, a207
    v_mul_f32 v216, v216, v22
    v_mul_f32 v217, v217, v22
    v_mul_f32 v218, v218, v22
    s_waitcnt lgkmcnt(11)
    v_mfma_f32_32x32x16_bf16 v[112:127], v[44:47], v[200:203], v[112:127]
    ds_read_b64_tr_b16 v[36:37], v249 offset:0
    ds_read_b64_tr_b16 v[38:39], v249 offset:2048
    s_add_u32 m0, s42, 98304
    s_add_u32 s40, s37, 262144
    buffer_load_dwordx4 v244, s[8:11], s40 offen lds
    v_mul_f32 v219, v219, v22
    v_mul_f32 v220, v220, v22
    v_mul_f32 v221, v221, v22
    v_mul_f32 v222, v222, v22
    v_mul_f32 v223, v223, v22
    v_cvt_pk_bf16_f32 v232, v216, v217
    v_cvt_pk_bf16_f32 v233, v218, v219
    s_waitcnt lgkmcnt(11)
    v_mfma_f32_32x32x16_bf16 v[64:79], v[48:51], v[204:207], v[64:79]
    ds_read_b128 v[196:199], v252 offset:1024
    ds_read_b64_tr_b16 v[40:41], v250 offset:0
    ds_read_b64_tr_b16 v[42:43], v250 offset:2048
    v_cvt_pk_bf16_f32 v234, v220, v221
    v_cvt_pk_bf16_f32 v235, v222, v223
    buffer_store_dwordx4 v[232:235], v0, s[28:31], s50 offen offset:1024 sc1
    v_accvgpr_read_b32 v208, a208
    v_accvgpr_read_b32 v209, a209
    v_accvgpr_read_b32 v210, a210
    v_accvgpr_read_b32 v211, a211
    v_accvgpr_read_b32 v212, a212
    v_accvgpr_read_b32 v213, a213
    v_accvgpr_read_b32 v214, a214
    v_accvgpr_read_b32 v215, a215
    s_waitcnt lgkmcnt(12)
    v_mfma_f32_32x32x16_bf16 v[80:95], v[52:55], v[204:207], v[80:95]
    ds_read_b64_tr_b16 v[44:45], v251 offset:0
    ds_read_b64_tr_b16 v[46:47], v251 offset:2048
    buffer_load_dwordx4 v245, s[8:11], s40 offen offset:1024 lds
    v_mul_f32 v208, v208, v22
    v_mul_f32 v209, v209, v22
    v_mul_f32 v210, v210, v22
    v_mul_f32 v211, v211, v22
    v_mul_f32 v212, v212, v22
    v_mul_f32 v213, v213, v22
    v_mul_f32 v214, v214, v22
    v_mul_f32 v215, v215, v22
    v_cvt_pk_bf16_f32 v224, v208, v209
    v_cvt_pk_bf16_f32 v225, v210, v211
    v_cvt_pk_bf16_f32 v226, v212, v213
    s_waitcnt lgkmcnt(12)
    v_mfma_f32_32x32x16_bf16 v[96:111], v[56:59], v[204:207], v[96:111]
    ds_read_b64_tr_b16 v[48:49], v248 offset:4096
    ds_read_b64_tr_b16 v[50:51], v248 offset:6144
    v_cvt_pk_bf16_f32 v227, v214, v215
    buffer_store_dwordx4 v[224:227], v0, s[28:31], s50 offen offset:2048 sc1
    v_accvgpr_read_b32 v216, a216
    v_accvgpr_read_b32 v217, a217
    v_accvgpr_read_b32 v218, a218
    v_accvgpr_read_b32 v219, a219
    v_accvgpr_read_b32 v220, a220
    v_accvgpr_read_b32 v221, a221
    v_accvgpr_read_b32 v222, a222
    v_accvgpr_read_b32 v223, a223
    v_mul_f32 v216, v216, v22
    v_mul_f32 v217, v217, v22
    s_waitcnt lgkmcnt(12)
    v_mfma_f32_32x32x16_bf16 v[112:127], v[60:63], v[204:207], v[112:127]
    ds_read_b64_tr_b16 v[52:53], v249 offset:4096
    ds_read_b64_tr_b16 v[54:55], v249 offset:6144
    buffer_load_dwordx4 v246, s[8:11], s40 offen offset:2048 lds
    v_mul_f32 v218, v218, v22
    v_mul_f32 v219, v219, v22
    v_mul_f32 v220, v220, v22
    v_mul_f32 v221, v221, v22
    v_mul_f32 v222, v222, v22
    v_mul_f32 v223, v223, v22
    v_cvt_pk_bf16_f32 v228, v216, v217
    v_cvt_pk_bf16_f32 v229, v218, v219
    v_cvt_pk_bf16_f32 v230, v220, v221
    v_cvt_pk_bf16_f32 v231, v222, v223
    buffer_store_dwordx4 v[228:231], v0, s[28:31], s50 offen offset:3072 sc1
    s_waitcnt lgkmcnt(11)
    v_mfma_f32_32x32x16_bf16 v[64:79], v[32:35], v[192:195], v[64:79]
    ds_read_b128 v[200:203], v252 offset:2048
    ds_read_b64_tr_b16 v[56:57], v250 offset:4096
    ds_read_b64_tr_b16 v[58:59], v250 offset:6144
    s_waitcnt lgkmcnt(12)
    v_mfma_f32_32x32x16_bf16 v[80:95], v[36:39], v[192:195], v[80:95]
    ds_read_b64_tr_b16 v[60:61], v251 offset:4096
    ds_read_b64_tr_b16 v[62:63], v251 offset:6144
    buffer_load_dwordx4 v247, s[8:11], s40 offen offset:3072 lds
    s_waitcnt lgkmcnt(11)
    v_mfma_f32_32x32x16_bf16 v[96:111], v[40:43], v[192:195], v[96:111]
    ds_read_b64_tr_b16 v[32:33], v248 offset:8192
    ds_read_b64_tr_b16 v[34:35], v248 offset:10240
    v_bfe_u32 v1, v0, 4, 5
    v_lshrrev_b32 v2, 9, v0
    v_lshlrev_b32 v253, 10, v1
    v_lshl_add_u32 v253, v2, 5, v253
    v_add_u32 v253, s78, v253
    v_lshrrev_b32 v254, 2, v0
    s_mov_b32 s20, s64
    s_mov_b32 s21, s65
    s_mov_b32 s22, 2097152
    s_mov_b32 s23, 0x00020000
    s_mov_b32 s24, s70
    s_mov_b32 s25, s71
    s_mov_b32 s26, 2097152
    s_mov_b32 s27, 0x00020000
    buffer_load_dwordx4 v[4:7], v253, s[20:23], 0 offen
    buffer_load_dwordx4 v[8:11], v253, s[20:23], 0 offen offset:16
    s_waitcnt lgkmcnt(11)
    v_mfma_f32_32x32x16_bf16 v[112:127], v[44:47], v[192:195], v[112:127]
    ds_read_b64_tr_b16 v[36:37], v249 offset:8192
    ds_read_b64_tr_b16 v[38:39], v249 offset:10240
    s_add_u32 m0, s42, 114688
    s_mov_b32 s41, 16384
    buffer_load_dwordx4 v0, s[16:19], s41 offen sc1 lds
    s_waitcnt lgkmcnt(11)
    v_mfma_f32_32x32x16_bf16 v[64:79], v[48:51], v[196:199], v[64:79]
    ds_read_b128 v[204:207], v252 offset:3072
    ds_read_b64_tr_b16 v[40:41], v250 offset:8192
    ds_read_b64_tr_b16 v[42:43], v250 offset:10240
    s_waitcnt lgkmcnt(12)
    v_mfma_f32_32x32x16_bf16 v[80:95], v[52:55], v[196:199], v[80:95]
    ds_read_b64_tr_b16 v[44:45], v251 offset:8192
    ds_read_b64_tr_b16 v[46:47], v251 offset:10240
    buffer_load_dwordx4 v0, s[16:19], s41 offen offset:1024 sc1 lds
    s_waitcnt lgkmcnt(11)
    v_mfma_f32_32x32x16_bf16 v[96:111], v[56:59], v[196:199], v[96:111]
    ds_read_b64_tr_b16 v[48:49], v248 offset:12288
    ds_read_b64_tr_b16 v[50:51], v248 offset:14336
    s_waitcnt lgkmcnt(11)
    v_mfma_f32_32x32x16_bf16 v[112:127], v[60:63], v[196:199], v[112:127]
    ds_read_b64_tr_b16 v[52:53], v249 offset:12288
    ds_read_b64_tr_b16 v[54:55], v249 offset:14336
    buffer_load_dwordx4 v0, s[16:19], s41 offen offset:2048 sc1 lds
    s_waitcnt lgkmcnt(11)
    v_mfma_f32_32x32x16_bf16 v[64:79], v[32:35], v[200:203], v[64:79]
    ds_read_b64_tr_b16 v[56:57], v250 offset:12288
    ds_read_b64_tr_b16 v[58:59], v250 offset:14336
    s_waitcnt lgkmcnt(11)
    v_mfma_f32_32x32x16_bf16 v[80:95], v[36:39], v[200:203], v[80:95]
    ds_read_b64_tr_b16 v[60:61], v251 offset:12288
    ds_read_b64_tr_b16 v[62:63], v251 offset:14336
    buffer_load_dwordx4 v0, s[16:19], s41 offen offset:3072 sc1 lds
    v_add_u32 v248, 32768, v248
    v_add_u32 v249, 32768, v249
    v_add_u32 v250, 32768, v250
    v_add_u32 v251, 32768, v251
    v_add_u32 v252, 32768, v252
    s_waitcnt lgkmcnt(10)
    v_mfma_f32_32x32x16_bf16 v[96:111], v[40:43], v[200:203], v[96:111]
    s_waitcnt vmcnt(22)
    s_barrier
    ds_read_b128 v[192:195], v252 offset:0
    ds_read_b64_tr_b16 v[32:33], v248 offset:0
    ds_read_b64_tr_b16 v[34:35], v248 offset:2048
    s_waitcnt lgkmcnt(11)
    v_mfma_f32_32x32x16_bf16 v[112:127], v[44:47], v[200:203], v[112:127]
    ds_read_b64_tr_b16 v[36:37], v249 offset:0
    ds_read_b64_tr_b16 v[38:39], v249 offset:2048
    s_add_u32 m0, s42, 131072
    s_add_u32 s40, s37, 327680
    buffer_load_dwordx4 v244, s[8:11], s40 offen lds
    s_waitcnt lgkmcnt(11)
    v_mfma_f32_32x32x16_bf16 v[64:79], v[48:51], v[204:207], v[64:79]
    ds_read_b128 v[196:199], v252 offset:1024
    ds_read_b64_tr_b16 v[40:41], v250 offset:0
    ds_read_b64_tr_b16 v[42:43], v250 offset:2048
    s_waitcnt lgkmcnt(12)
    v_mfma_f32_32x32x16_bf16 v[80:95], v[52:55], v[204:207], v[80:95]
    ds_read_b64_tr_b16 v[44:45], v251 offset:0
    ds_read_b64_tr_b16 v[46:47], v251 offset:2048
    buffer_load_dwordx4 v245, s[8:11], s40 offen offset:1024 lds
    s_waitcnt lgkmcnt(12)
    v_mfma_f32_32x32x16_bf16 v[96:111], v[56:59], v[204:207], v[96:111]
    ds_read_b64_tr_b16 v[48:49], v248 offset:4096
    ds_read_b64_tr_b16 v[50:51], v248 offset:6144
    s_waitcnt lgkmcnt(12)
    v_mfma_f32_32x32x16_bf16 v[112:127], v[60:63], v[204:207], v[112:127]
    ds_read_b64_tr_b16 v[52:53], v249 offset:4096
    ds_read_b64_tr_b16 v[54:55], v249 offset:6144
    buffer_load_dwordx4 v246, s[8:11], s40 offen offset:2048 lds
    s_waitcnt lgkmcnt(11)
    v_mfma_f32_32x32x16_bf16 v[64:79], v[32:35], v[192:195], v[64:79]
    ds_read_b128 v[200:203], v252 offset:2048
    ds_read_b64_tr_b16 v[56:57], v250 offset:4096
    ds_read_b64_tr_b16 v[58:59], v250 offset:6144
    s_waitcnt lgkmcnt(12)
    v_mfma_f32_32x32x16_bf16 v[80:95], v[36:39], v[192:195], v[80:95]
    ds_read_b64_tr_b16 v[60:61], v251 offset:4096
    ds_read_b64_tr_b16 v[62:63], v251 offset:6144
    buffer_load_dwordx4 v247, s[8:11], s40 offen offset:3072 lds
    s_waitcnt lgkmcnt(11)
    v_mfma_f32_32x32x16_bf16 v[96:111], v[40:43], v[192:195], v[96:111]
    ds_read_b64_tr_b16 v[32:33], v248 offset:8192
    ds_read_b64_tr_b16 v[34:35], v248 offset:10240
    s_waitcnt lgkmcnt(11)
    v_mfma_f32_32x32x16_bf16 v[112:127], v[44:47], v[192:195], v[112:127]
    ds_read_b64_tr_b16 v[36:37], v249 offset:8192
    ds_read_b64_tr_b16 v[38:39], v249 offset:10240
    s_add_u32 m0, s42, 147456
    s_mov_b32 s41, 20480
    buffer_load_dwordx4 v0, s[16:19], s41 offen sc1 lds
    s_waitcnt lgkmcnt(11)
    v_mfma_f32_32x32x16_bf16 v[64:79], v[48:51], v[196:199], v[64:79]
    ds_read_b128 v[204:207], v252 offset:3072
    ds_read_b64_tr_b16 v[40:41], v250 offset:8192
    ds_read_b64_tr_b16 v[42:43], v250 offset:10240
    s_waitcnt lgkmcnt(12)
    v_mfma_f32_32x32x16_bf16 v[80:95], v[52:55], v[196:199], v[80:95]
    ds_read_b64_tr_b16 v[44:45], v251 offset:8192
    ds_read_b64_tr_b16 v[46:47], v251 offset:10240
    buffer_load_dwordx4 v0, s[16:19], s41 offen offset:1024 sc1 lds
    s_waitcnt lgkmcnt(11)
    v_mfma_f32_32x32x16_bf16 v[96:111], v[56:59], v[196:199], v[96:111]
    ds_read_b64_tr_b16 v[48:49], v248 offset:12288
    ds_read_b64_tr_b16 v[50:51], v248 offset:14336
    s_waitcnt lgkmcnt(11)
    v_mfma_f32_32x32x16_bf16 v[112:127], v[60:63], v[196:199], v[112:127]
    ds_read_b64_tr_b16 v[52:53], v249 offset:12288
    ds_read_b64_tr_b16 v[54:55], v249 offset:14336
    buffer_load_dwordx4 v0, s[16:19], s41 offen offset:2048 sc1 lds
    s_waitcnt lgkmcnt(11)
    v_mfma_f32_32x32x16_bf16 v[64:79], v[32:35], v[200:203], v[64:79]
    ds_read_b64_tr_b16 v[56:57], v250 offset:12288
    ds_read_b64_tr_b16 v[58:59], v250 offset:14336
    s_waitcnt lgkmcnt(11)
    v_mfma_f32_32x32x16_bf16 v[80:95], v[36:39], v[200:203], v[80:95]
    ds_read_b64_tr_b16 v[60:61], v251 offset:12288
    ds_read_b64_tr_b16 v[62:63], v251 offset:14336
    buffer_load_dwordx4 v0, s[16:19], s41 offen offset:3072 sc1 lds
    v_add_u32 v248, 32768, v248
    v_add_u32 v249, 32768, v249
    v_add_u32 v250, 32768, v250
    v_add_u32 v251, 32768, v251
    v_add_u32 v252, 32768, v252
    s_waitcnt lgkmcnt(10)
    v_mfma_f32_32x32x16_bf16 v[96:111], v[40:43], v[200:203], v[96:111]
    s_waitcnt vmcnt(15)
    s_barrier
    s_cmp_eq_u32 s32, 0
    s_cbranch_scc0 K1_SIGA
    s_lshl_b32 s47, s33, 2
    v_mov_b32 v1, s47
    v_mov_b32 v2, 1
    s_mov_b64 exec, 1
    buffer_store_dword v2, v1, s[28:31], s55 offen offset:0 sc1
    s_mov_b64 exec, -1
K1_SIGA:
    ds_read_b128 v[192:195], v252 offset:0
    ds_read_b64_tr_b16 v[32:33], v248 offset:0
    ds_read_b64_tr_b16 v[34:35], v248 offset:2048
    s_waitcnt lgkmcnt(11)
    v_mfma_f32_32x32x16_bf16 v[112:127], v[44:47], v[200:203], v[112:127]
    ds_read_b64_tr_b16 v[36:37], v249 offset:0
    ds_read_b64_tr_b16 v[38:39], v249 offset:2048
    s_add_u32 m0, s42, 0
    s_lshl_b32 s47, s33, 1
    s_add_u32 s47, s47, 0
    s_and_b32 s47, s47, 15
    s_lshl_b32 s47, s47, 16
    s_add_u32 s40, s39, s47
    buffer_load_dwordx4 v244, s[12:15], s40 offen lds
    s_waitcnt lgkmcnt(11)
    v_mfma_f32_32x32x16_bf16 v[64:79], v[48:51], v[204:207], v[64:79]
    ds_read_b128 v[196:199], v252 offset:1024
    ds_read_b64_tr_b16 v[40:41], v250 offset:0
    ds_read_b64_tr_b16 v[42:43], v250 offset:2048
    s_waitcnt lgkmcnt(12)
    v_mfma_f32_32x32x16_bf16 v[80:95], v[52:55], v[204:207], v[80:95]
    ds_read_b64_tr_b16 v[44:45], v251 offset:0
    ds_read_b64_tr_b16 v[46:47], v251 offset:2048
    buffer_load_dwordx4 v245, s[12:15], s40 offen offset:1024 lds
    s_waitcnt lgkmcnt(12)
    v_mfma_f32_32x32x16_bf16 v[96:111], v[56:59], v[204:207], v[96:111]
    ds_read_b64_tr_b16 v[48:49], v248 offset:4096
    ds_read_b64_tr_b16 v[50:51], v248 offset:6144
    s_waitcnt lgkmcnt(12)
    v_mfma_f32_32x32x16_bf16 v[112:127], v[60:63], v[204:207], v[112:127]
    ds_read_b64_tr_b16 v[52:53], v249 offset:4096
    ds_read_b64_tr_b16 v[54:55], v249 offset:6144
    buffer_load_dwordx4 v246, s[12:15], s40 offen offset:2048 lds
    s_waitcnt lgkmcnt(11)
    v_mfma_f32_32x32x16_bf16 v[64:79], v[32:35], v[192:195], v[64:79]
    ds_read_b128 v[200:203], v252 offset:2048
    ds_read_b64_tr_b16 v[56:57], v250 offset:4096
    ds_read_b64_tr_b16 v[58:59], v250 offset:6144
    s_waitcnt lgkmcnt(12)
    v_mfma_f32_32x32x16_bf16 v[80:95], v[36:39], v[192:195], v[80:95]
    ds_read_b64_tr_b16 v[60:61], v251 offset:4096
    ds_read_b64_tr_b16 v[62:63], v251 offset:6144
    buffer_load_dwordx4 v247, s[12:15], s40 offen offset:3072 lds
    s_waitcnt lgkmcnt(11)
    v_mfma_f32_32x32x16_bf16 v[96:111], v[40:43], v[192:195], v[96:111]
    ds_read_b64_tr_b16 v[32:33], v248 offset:8192
    ds_read_b64_tr_b16 v[34:35], v248 offset:10240
    s_waitcnt lgkmcnt(11)
    v_mfma_f32_32x32x16_bf16 v[112:127], v[44:47], v[192:195], v[112:127]
    ds_read_b64_tr_b16 v[36:37], v249 offset:8192
    ds_read_b64_tr_b16 v[38:39], v249 offset:10240
    s_add_u32 m0, s42, 16384
    s_lshl_b32 s47, s33, 1
    s_add_u32 s47, s47, 0
    s_and_b32 s47, s47, 15
    s_lshl_b32 s41, s47, 12
    buffer_load_dwordx4 v0, s[4:7], s41 offen sc1 lds
    s_waitcnt lgkmcnt(11)
    v_mfma_f32_32x32x16_bf16 v[64:79], v[48:51], v[196:199], v[64:79]
    ds_read_b128 v[204:207], v252 offset:3072
    ds_read_b64_tr_b16 v[40:41], v250 offset:8192
    ds_read_b64_tr_b16 v[42:43], v250 offset:10240
    s_waitcnt lgkmcnt(12)
    v_mfma_f32_32x32x16_bf16 v[80:95], v[52:55], v[196:199], v[80:95]
    ds_read_b64_tr_b16 v[44:45], v251 offset:8192
    ds_read_b64_tr_b16 v[46:47], v251 offset:10240
    buffer_load_dwordx4 v0, s[4:7], s41 offen offset:1024 sc1 lds
    s_waitcnt lgkmcnt(11)
    v_mfma_f32_32x32x16_bf16 v[96:111], v[56:59], v[196:199], v[96:111]
    ds_read_b64_tr_b16 v[48:49], v248 offset:12288
    ds_read_b64_tr_b16 v[50:51], v248 offset:14336
    s_waitcnt lgkmcnt(11)
    v_mfma_f32_32x32x16_bf16 v[112:127], v[60:63], v[196:199], v[112:127]
    ds_read_b64_tr_b16 v[52:53], v249 offset:12288
    ds_read_b64_tr_b16 v[54:55], v249 offset:14336
    buffer_load_dwordx4 v0, s[4:7], s41 offen offset:2048 sc1 lds
    s_waitcnt lgkmcnt(11)
    v_mfma_f32_32x32x16_bf16 v[64:79], v[32:35], v[200:203], v[64:79]
    ds_read_b64_tr_b16 v[56:57], v250 offset:12288
    ds_read_b64_tr_b16 v[58:59], v250 offset:14336
    s_waitcnt lgkmcnt(11)
    v_mfma_f32_32x32x16_bf16 v[80:95], v[36:39], v[200:203], v[80:95]
    ds_read_b64_tr_b16 v[60:61], v251 offset:12288
    ds_read_b64_tr_b16 v[62:63], v251 offset:14336
    buffer_load_dwordx4 v0, s[4:7], s41 offen offset:3072 sc1 lds
    v_add_u32 v248, 32768, v248
    v_add_u32 v249, 32768, v249
    v_add_u32 v250, 32768, v250
    v_add_u32 v251, 32768, v251
    v_add_u32 v252, 32768, v252
    s_waitcnt lgkmcnt(10)
    v_mfma_f32_32x32x16_bf16 v[96:111], v[40:43], v[200:203], v[96:111]
    s_waitcnt vmcnt(16)
    s_barrier
    ds_read_b128 v[192:195], v252 offset:0
    ds_read_b64_tr_b16 v[32:33], v248 offset:0
    ds_read_b64_tr_b16 v[34:35], v248 offset:2048
    s_waitcnt lgkmcnt(11)
    v_mfma_f32_32x32x16_bf16 v[112:127], v[44:47], v[200:203], v[112:127]
    ds_read_b64_tr_b16 v[36:37], v249 offset:0
    ds_read_b64_tr_b16 v[38:39], v249 offset:2048
    s_add_u32 m0, s42, 32768
    s_lshl_b32 s47, s33, 1
    s_add_u32 s47, s47, 1
    s_and_b32 s47, s47, 15
    s_lshl_b32 s47, s47, 16
    s_add_u32 s40, s39, s47
    buffer_load_dwordx4 v244, s[12:15], s40 offen lds
    s_waitcnt lgkmcnt(11)
    v_mfma_f32_32x32x16_bf16 v[64:79], v[48:51], v[204:207], v[64:79]
    ds_read_b128 v[196:199], v252 offset:1024
    ds_read_b64_tr_b16 v[40:41], v250 offset:0
    ds_read_b64_tr_b16 v[42:43], v250 offset:2048
    s_waitcnt lgkmcnt(12)
    v_mfma_f32_32x32x16_bf16 v[80:95], v[52:55], v[204:207], v[80:95]
    ds_read_b64_tr_b16 v[44:45], v251 offset:0
    ds_read_b64_tr_b16 v[46:47], v251 offset:2048
    buffer_load_dwordx4 v245, s[12:15], s40 offen offset:1024 lds
    s_waitcnt lgkmcnt(12)
    v_mfma_f32_32x32x16_bf16 v[96:111], v[56:59], v[204:207], v[96:111]
    ds_read_b64_tr_b16 v[48:49], v248 offset:4096
    ds_read_b64_tr_b16 v[50:51], v248 offset:6144
    s_waitcnt lgkmcnt(12)
    v_mfma_f32_32x32x16_bf16 v[112:127], v[60:63], v[204:207], v[112:127]
    ds_read_b64_tr_b16 v[52:53], v249 offset:4096
    ds_read_b64_tr_b16 v[54:55], v249 offset:6144
    buffer_load_dwordx4 v246, s[12:15], s40 offen offset:2048 lds
    s_waitcnt lgkmcnt(11)
    v_mfma_f32_32x32x16_bf16 v[64:79], v[32:35], v[192:195], v[64:79]
    ds_read_b128 v[200:203], v252 offset:2048
    ds_read_b64_tr_b16 v[56:57], v250 offset:4096
    ds_read_b64_tr_b16 v[58:59], v250 offset:6144
    s_waitcnt lgkmcnt(12)
    v_mfma_f32_32x32x16_bf16 v[80:95], v[36:39], v[192:195], v[80:95]
    ds_read_b64_tr_b16 v[60:61], v251 offset:4096
    ds_read_b64_tr_b16 v[62:63], v251 offset:6144
    buffer_load_dwordx4 v247, s[12:15], s40 offen offset:3072 lds
    s_waitcnt lgkmcnt(11)
    v_mfma_f32_32x32x16_bf16 v[96:111], v[40:43], v[192:195], v[96:111]
    ds_read_b64_tr_b16 v[32:33], v248 offset:8192
    ds_read_b64_tr_b16 v[34:35], v248 offset:10240
    s_waitcnt lgkmcnt(11)
    v_mfma_f32_32x32x16_bf16 v[112:127], v[44:47], v[192:195], v[112:127]
    ds_read_b64_tr_b16 v[36:37], v249 offset:8192
    ds_read_b64_tr_b16 v[38:39], v249 offset:10240
    s_add_u32 m0, s42, 49152
    s_lshl_b32 s47, s33, 1
    s_add_u32 s47, s47, 1
    s_and_b32 s47, s47, 15
    s_lshl_b32 s41, s47, 12
    buffer_load_dwordx4 v0, s[4:7], s41 offen sc1 lds
    s_waitcnt lgkmcnt(11)
    v_mfma_f32_32x32x16_bf16 v[64:79], v[48:51], v[196:199], v[64:79]
    ds_read_b128 v[204:207], v252 offset:3072
    ds_read_b64_tr_b16 v[40:41], v250 offset:8192
    ds_read_b64_tr_b16 v[42:43], v250 offset:10240
    s_waitcnt lgkmcnt(12)
    v_mfma_f32_32x32x16_bf16 v[80:95], v[52:55], v[196:199], v[80:95]
    ds_read_b64_tr_b16 v[44:45], v251 offset:8192
    ds_read_b64_tr_b16 v[46:47], v251 offset:10240
    buffer_load_dwordx4 v0, s[4:7], s41 offen offset:1024 sc1 lds
    s_waitcnt lgkmcnt(11)
    v_mfma_f32_32x32x16_bf16 v[96:111], v[56:59], v[196:199], v[96:111]
    ds_read_b64_tr_b16 v[48:49], v248 offset:12288
    ds_read_b64_tr_b16 v[50:51], v248 offset:14336
    s_waitcnt lgkmcnt(11)
    v_mfma_f32_32x32x16_bf16 v[112:127], v[60:63], v[196:199], v[112:127]
    ds_read_b64_tr_b16 v[52:53], v249 offset:12288
    ds_read_b64_tr_b16 v[54:55], v249 offset:14336
    buffer_load_dwordx4 v0, s[4:7], s41 offen offset:2048 sc1 lds
    s_waitcnt lgkmcnt(11)
    v_mfma_f32_32x32x16_bf16 v[64:79], v[32:35], v[200:203], v[64:79]
    ds_read_b64_tr_b16 v[56:57], v250 offset:12288
    ds_read_b64_tr_b16 v[58:59], v250 offset:14336
    s_waitcnt lgkmcnt(11)
    v_mfma_f32_32x32x16_bf16 v[80:95], v[36:39], v[200:203], v[80:95]
    ds_read_b64_tr_b16 v[60:61], v251 offset:12288
    ds_read_b64_tr_b16 v[62:63], v251 offset:14336
    buffer_load_dwordx4 v0, s[4:7], s41 offen offset:3072 sc1 lds
    v_add_u32 v248, 32768, v248
    v_add_u32 v249, 32768, v249
    v_add_u32 v250, 32768, v250
    v_add_u32 v251, 32768, v251
    v_add_u32 v252, 32768, v252
    s_waitcnt lgkmcnt(10)
    v_mfma_f32_32x32x16_bf16 v[96:111], v[40:43], v[200:203], v[96:111]
    s_waitcnt vmcnt(16)
    s_barrier
    ds_read_b128 v[192:195], v252 offset:0
    ds_read_b64_tr_b16 v[32:33], v248 offset:0
    ds_read_b64_tr_b16 v[34:35], v248 offset:2048
    s_waitcnt lgkmcnt(11)
    v_mfma_f32_32x32x16_bf16 v[112:127], v[44:47], v[200:203], v[112:127]
    ds_read_b64_tr_b16 v[36:37], v249 offset:0
    ds_read_b64_tr_b16 v[38:39], v249 offset:2048
    s_add_u32 m0, s42, 65536
    s_lshl_b32 s47, s33, 1
    s_add_u32 s47, s47, 2
    s_and_b32 s47, s47, 15
    s_lshl_b32 s47, s47, 16
    s_add_u32 s40, s39, s47
    buffer_load_dwordx4 v244, s[12:15], s40 offen lds
    s_waitcnt lgkmcnt(11)
    v_mfma_f32_32x32x16_bf16 v[64:79], v[48:51], v[204:207], v[64:79]
    ds_read_b128 v[196:199], v252 offset:1024
    ds_read_b64_tr_b16 v[40:41], v250 offset:0
    ds_read_b64_tr_b16 v[42:43], v250 offset:2048
    s_waitcnt lgkmcnt(12)
    v_mfma_f32_32x32x16_bf16 v[80:95], v[52:55], v[204:207], v[80:95]
    ds_read_b64_tr_b16 v[44:45], v251 offset:0
    ds_read_b64_tr_b16 v[46:47], v251 offset:2048
    buffer_load_dwordx4 v245, s[12:15], s40 offen offset:1024 lds
    s_waitcnt lgkmcnt(12)
    v_mfma_f32_32x32x16_bf16 v[96:111], v[56:59], v[204:207], v[96:111]
    ds_read_b64_tr_b16 v[48:49], v248 offset:4096
    ds_read_b64_tr_b16 v[50:51], v248 offset:6144
    s_waitcnt lgkmcnt(12)
    v_mfma_f32_32x32x16_bf16 v[112:127], v[60:63], v[204:207], v[112:127]
    ds_read_b64_tr_b16 v[52:53], v249 offset:4096
    ds_read_b64_tr_b16 v[54:55], v249 offset:6144
    buffer_load_dwordx4 v246, s[12:15], s40 offen offset:2048 lds
    s_waitcnt lgkmcnt(11)
    v_mfma_f32_32x32x16_bf16 v[64:79], v[32:35], v[192:195], v[64:79]
    ds_read_b128 v[200:203], v252 offset:2048
    ds_read_b64_tr_b16 v[56:57], v250 offset:4096
    ds_read_b64_tr_b16 v[58:59], v250 offset:6144
    s_waitcnt lgkmcnt(12)
    v_mfma_f32_32x32x16_bf16 v[80:95], v[36:39], v[192:195], v[80:95]
    ds_read_b64_tr_b16 v[60:61], v251 offset:4096
    ds_read_b64_tr_b16 v[62:63], v251 offset:6144
    buffer_load_dwordx4 v247, s[12:15], s40 offen offset:3072 lds
    s_waitcnt lgkmcnt(11)
    v_mfma_f32_32x32x16_bf16 v[96:111], v[40:43], v[192:195], v[96:111]
    ds_read_b64_tr_b16 v[32:33], v248 offset:8192
    ds_read_b64_tr_b16 v[34:35], v248 offset:10240
    s_getpc_b64 s[76:77]
K1_CP4:
    s_add_u32 s76, s76, (K1_CODE_END+(-8192)-K1_CP4)&0xffffffff
    s_addc_u32 s77, s77, ((K1_CODE_END+(-8192)-K1_CP4)>>32)&0xffffffff
    global_load_dword a40, v28, s[76:77]
    s_waitcnt lgkmcnt(11)
    v_mfma_f32_32x32x16_bf16 v[112:127], v[44:47], v[192:195], v[112:127]
    ds_read_b64_tr_b16 v[36:37], v249 offset:8192
    ds_read_b64_tr_b16 v[38:39], v249 offset:10240
    s_waitcnt lgkmcnt(11)
    v_mfma_f32_32x32x16_bf16 v[64:79], v[48:51], v[196:199], v[64:79]
    ds_read_b128 v[204:207], v252 offset:3072
    ds_read_b64_tr_b16 v[40:41], v250 offset:8192
    ds_read_b64_tr_b16 v[42:43], v250 offset:10240
    s_waitcnt lgkmcnt(12)
    v_mfma_f32_32x32x16_bf16 v[80:95], v[52:55], v[196:199], v[80:95]
    ds_read_b64_tr_b16 v[44:45], v251 offset:8192
    ds_read_b64_tr_b16 v[46:47], v251 offset:10240
    s_waitcnt lgkmcnt(11)
    v_mfma_f32_32x32x16_bf16 v[96:111], v[56:59], v[196:199], v[96:111]
    ds_read_b64_tr_b16 v[48:49], v248 offset:12288
    ds_read_b64_tr_b16 v[50:51], v248 offset:14336
    s_waitcnt lgkmcnt(11)
    v_mfma_f32_32x32x16_bf16 v[112:127], v[60:63], v[196:199], v[112:127]
    ds_read_b64_tr_b16 v[52:53], v249 offset:12288
    ds_read_b64_tr_b16 v[54:55], v249 offset:14336
    s_waitcnt lgkmcnt(11)
    v_mfma_f32_32x32x16_bf16 v[64:79], v[32:35], v[200:203], v[64:79]
    ds_read_b64_tr_b16 v[56:57], v250 offset:12288
    ds_read_b64_tr_b16 v[58:59], v250 offset:14336
    s_waitcnt lgkmcnt(11)
    v_mfma_f32_32x32x16_bf16 v[80:95], v[36:39], v[200:203], v[80:95]
    ds_read_b64_tr_b16 v[60:61], v251 offset:12288
    ds_read_b64_tr_b16 v[62:63], v251 offset:14336
    v_add_u32 v248, 4294836224, v248
    v_add_u32 v249, 4294836224, v249
    v_add_u32 v250, 4294836224, v250
    v_add_u32 v251, 4294836224, v251
    v_add_u32 v252, 4294836224, v252
    s_waitcnt lgkmcnt(10)
    v_mfma_f32_32x32x16_bf16 v[96:111], v[40:43], v[200:203], v[96:111]
    s_waitcnt vmcnt(13)
    s_barrier
    ds_read_b128 v[192:195], v252 offset:0
    ds_read_b64_tr_b16 v[32:33], v248 offset:0
    ds_read_b64_tr_b16 v[34:35], v248 offset:2048
    s_waitcnt lgkmcnt(11)
    v_mfma_f32_32x32x16_bf16 v[112:127], v[44:47], v[200:203], v[112:127]
    ds_read_b64_tr_b16 v[36:37], v249 offset:0
    ds_read_b64_tr_b16 v[38:39], v249 offset:2048
    s_add_u32 m0, s42, 98304
    s_lshl_b32 s47, s33, 1
    s_add_u32 s47, s47, 3
    s_and_b32 s47, s47, 15
    s_lshl_b32 s47, s47, 16
    s_add_u32 s40, s39, s47
    buffer_load_dwordx4 v244, s[12:15], s40 offen lds
    s_waitcnt lgkmcnt(11)
    v_mfma_f32_32x32x16_bf16 v[64:79], v[48:51], v[204:207], v[64:79]
    ds_read_b128 v[196:199], v252 offset:1024
    ds_read_b64_tr_b16 v[40:41], v250 offset:0
    ds_read_b64_tr_b16 v[42:43], v250 offset:2048
    s_waitcnt lgkmcnt(12)
    v_mfma_f32_32x32x16_bf16 v[80:95], v[52:55], v[204:207], v[80:95]
    ds_read_b64_tr_b16 v[44:45], v251 offset:0
    ds_read_b64_tr_b16 v[46:47], v251 offset:2048
    buffer_load_dwordx4 v245, s[12:15], s40 offen offset:1024 lds
    s_waitcnt lgkmcnt(12)
    v_mfma_f32_32x32x16_bf16 v[96:111], v[56:59], v[204:207], v[96:111]
    ds_read_b64_tr_b16 v[48:49], v248 offset:4096
    ds_read_b64_tr_b16 v[50:51], v248 offset:6144
    s_waitcnt lgkmcnt(12)
    v_mfma_f32_32x32x16_bf16 v[112:127], v[60:63], v[204:207], v[112:127]
    ds_read_b64_tr_b16 v[52:53], v249 offset:4096
    ds_read_b64_tr_b16 v[54:55], v249 offset:6144
    buffer_load_dwordx4 v246, s[12:15], s40 offen offset:2048 lds
    s_waitcnt lgkmcnt(11)
    v_mfma_f32_32x32x16_bf16 v[128:143], v[32:35], v[192:195], 0
    ds_read_b128 v[200:203], v252 offset:2048
    ds_read_b64_tr_b16 v[56:57], v250 offset:4096
    ds_read_b64_tr_b16 v[58:59], v250 offset:6144
    s_waitcnt lgkmcnt(12)
    v_mfma_f32_32x32x16_bf16 v[144:159], v[36:39], v[192:195], 0
    ds_read_b64_tr_b16 v[60:61], v251 offset:4096
    ds_read_b64_tr_b16 v[62:63], v251 offset:6144
    buffer_load_dwordx4 v247, s[12:15], s40 offen offset:3072 lds
    s_waitcnt lgkmcnt(11)
    v_mfma_f32_32x32x16_bf16 v[160:175], v[40:43], v[192:195], 0
    ds_read_b64_tr_b16 v[32:33], v248 offset:8192
    ds_read_b64_tr_b16 v[34:35], v248 offset:10240
    s_waitcnt lgkmcnt(11)
    v_mfma_f32_32x32x16_bf16 v[176:191], v[44:47], v[192:195], 0
    ds_read_b64_tr_b16 v[36:37], v249 offset:8192
    ds_read_b64_tr_b16 v[38:39], v249 offset:10240
    s_waitcnt lgkmcnt(11)
    v_mfma_f32_32x32x16_bf16 v[128:143], v[48:51], v[196:199], v[128:143]
    ds_read_b128 v[204:207], v252 offset:3072
    ds_read_b64_tr_b16 v[40:41], v250 offset:8192
    ds_read_b64_tr_b16 v[42:43], v250 offset:10240
    s_waitcnt lgkmcnt(12)
    v_mfma_f32_32x32x16_bf16 v[144:159], v[52:55], v[196:199], v[144:159]
    ds_read_b64_tr_b16 v[44:45], v251 offset:8192
    ds_read_b64_tr_b16 v[46:47], v251 offset:10240
    s_waitcnt lgkmcnt(11)
    v_mfma_f32_32x32x16_bf16 v[160:175], v[56:59], v[196:199], v[160:175]
    ds_read_b64_tr_b16 v[48:49], v248 offset:12288
    ds_read_b64_tr_b16 v[50:51], v248 offset:14336
    s_waitcnt lgkmcnt(11)
    v_mfma_f32_32x32x16_bf16 v[176:191], v[60:63], v[196:199], v[176:191]
    ds_read_b64_tr_b16 v[52:53], v249 offset:12288
    ds_read_b64_tr_b16 v[54:55], v249 offset:14336
    s_waitcnt lgkmcnt(11)
    v_mfma_f32_32x32x16_bf16 v[128:143], v[32:35], v[200:203], v[128:143]
    ds_read_b64_tr_b16 v[56:57], v250 offset:12288
    ds_read_b64_tr_b16 v[58:59], v250 offset:14336
    s_waitcnt lgkmcnt(11)
    v_mfma_f32_32x32x16_bf16 v[144:159], v[36:39], v[200:203], v[144:159]
    ds_read_b64_tr_b16 v[60:61], v251 offset:12288
    ds_read_b64_tr_b16 v[62:63], v251 offset:14336
    v_add_u32 v248, 32768, v248
    v_add_u32 v249, 32768, v249
    v_add_u32 v250, 32768, v250
    v_add_u32 v251, 32768, v251
    v_add_u32 v252, 32768, v252
    s_waitcnt lgkmcnt(10)
    v_mfma_f32_32x32x16_bf16 v[160:175], v[40:43], v[200:203], v[160:175]
    s_cmp_eq_u32 s32, 0
    s_cbranch_scc0 K1_PA_DONE
K1_PA:
    buffer_load_dword v1, v254, s[28:31], s55 offen sc1
    s_waitcnt vmcnt(0)
    v_cmp_ne_u32 vcc, 0, v1
    s_nop 1
    s_cmp_eq_u32 vcc_lo, -1
    s_cbranch_scc1 K1_PA_DONE
    s_sleep 1
    s_branch K1_PA
K1_PA_DONE:
    s_waitcnt vmcnt(9)
    s_barrier
    ds_read_b128 v[192:195], v252 offset:0
    ds_read_b64_tr_b16 v[32:33], v248 offset:0
    ds_read_b64_tr_b16 v[34:35], v248 offset:2048
    s_add_u32 m0, s42, 81920
    s_lshl_b32 s47, s33, 1
    s_add_u32 s47, s47, 2
    s_and_b32 s47, s47, 15
    s_lshl_b32 s41, s47, 12
    buffer_load_dwordx4 v0, s[4:7], s41 offen sc1 lds
    buffer_load_dwordx4 v0, s[4:7], s41 offen offset:1024 sc1 lds
    s_waitcnt lgkmcnt(11)
    v_mfma_f32_32x32x16_bf16 v[176:191], v[44:47], v[200:203], v[176:191]
    ds_read_b64_tr_b16 v[36:37], v249 offset:0
    ds_read_b64_tr_b16 v[38:39], v249 offset:2048
    buffer_load_dwordx4 v0, s[4:7], s41 offen offset:2048 sc1 lds
    buffer_load_dwordx4 v0, s[4:7], s41 offen offset:3072 sc1 lds
    s_waitcnt lgkmcnt(11)
    v_mfma_f32_32x32x16_bf16 v[128:143], v[48:51], v[204:207], v[128:143]
    ds_read_b128 v[196:199], v252 offset:1024
    ds_read_b64_tr_b16 v[40:41], v250 offset:0
    ds_read_b64_tr_b16 v[42:43], v250 offset:2048
    s_add_u32 m0, s42, 114688
    s_lshl_b32 s47, s33, 1
    s_add_u32 s47, s47, 3
    s_and_b32 s47, s47, 15
    s_lshl_b32 s41, s47, 12
    buffer_load_dwordx4 v0, s[4:7], s41 offen sc1 lds
    s_waitcnt lgkmcnt(12)
    v_mfma_f32_32x32x16_bf16 v[144:159], v[52:55], v[204:207], v[144:159]
    ds_read_b64_tr_b16 v[44:45], v251 offset:0
    ds_read_b64_tr_b16 v[46:47], v251 offset:2048
    buffer_load_dwordx4 v0, s[4:7], s41 offen offset:1024 sc1 lds
    buffer_load_dwordx4 v0, s[4:7], s41 offen offset:2048 sc1 lds
    s_waitcnt lgkmcnt(12)
    v_mfma_f32_32x32x16_bf16 v[160:175], v[56:59], v[204:207], v[160:175]
    ds_read_b64_tr_b16 v[48:49], v248 offset:4096
    ds_read_b64_tr_b16 v[50:51], v248 offset:6144
    buffer_load_dwordx4 v0, s[4:7], s41 offen offset:3072 sc1 lds
    s_waitcnt lgkmcnt(12)
    v_mfma_f32_32x32x16_bf16 v[176:191], v[60:63], v[204:207], v[176:191]
    ds_read_b64_tr_b16 v[52:53], v249 offset:4096
    ds_read_b64_tr_b16 v[54:55], v249 offset:6144
    s_add_u32 m0, s42, 131072
    s_lshl_b32 s47, s33, 1
    s_add_u32 s47, s47, 4
    s_and_b32 s47, s47, 15
    s_lshl_b32 s47, s47, 16
    s_add_u32 s40, s39, s47
    buffer_load_dwordx4 v244, s[12:15], s40 offen lds
    buffer_load_dwordx4 v245, s[12:15], s40 offen offset:1024 lds
    buffer_load_dwordx4 v246, s[12:15], s40 offen offset:2048 lds
    s_waitcnt lgkmcnt(11)
    v_mfma_f32_32x32x16_bf16 v[128:143], v[32:35], v[192:195], v[128:143]
    ds_read_b128 v[200:203], v252 offset:2048
    ds_read_b64_tr_b16 v[56:57], v250 offset:4096
    ds_read_b64_tr_b16 v[58:59], v250 offset:6144
    v_cvt_pk_bf16_f32 v208, v64, v65
    v_cvt_pk_bf16_f32 v209, v66, v67
    v_cvt_pk_bf16_f32 v210, v68, v69
    v_cvt_pk_bf16_f32 v211, v70, v71
    v_cvt_pk_bf16_f32 v212, v72, v73
    s_waitcnt lgkmcnt(12)
    v_mfma_f32_32x32x16_bf16 v[144:159], v[36:39], v[192:195], v[144:159]
    ds_read_b64_tr_b16 v[60:61], v251 offset:4096
    ds_read_b64_tr_b16 v[62:63], v251 offset:6144
    buffer_load_dwordx4 v247, s[12:15], s40 offen offset:3072 lds
    v_cvt_pk_bf16_f32 v213, v74, v75
    v_cvt_pk_bf16_f32 v214, v76, v77
    v_cvt_pk_bf16_f32 v215, v78, v79
    s_waitcnt lgkmcnt(11)
    v_mfma_f32_32x32x16_bf16 v[160:175], v[40:43], v[192:195], v[160:175]
    ds_read_b64_tr_b16 v[32:33], v248 offset:8192
    ds_read_b64_tr_b16 v[34:35], v248 offset:10240
    s_waitcnt lgkmcnt(11)
    v_mfma_f32_32x32x16_bf16 v[176:191], v[44:47], v[192:195], v[176:191]
    ds_read_b64_tr_b16 v[36:37], v249 offset:8192
    ds_read_b64_tr_b16 v[38:39], v249 offset:10240
    s_add_u32 m0, s42, 147456
    s_lshl_b32 s47, s33, 1
    s_add_u32 s47, s47, 4
    s_and_b32 s47, s47, 15
    s_lshl_b32 s41, s47, 12
    buffer_load_dwordx4 v0, s[4:7], s41 offen sc1 lds
    s_cmp_eq_u32 s51, 0
    s_cbranch_scc1 K1_PS10
    s_cmp_gt_u32 s51, 0
    s_cselect_b32 s47, 1, 0
    s_sub_u32 s47, s51, s47
    s_lshl_b32 s47, s47, 11
    s_add_u32 s47, s47, s53
    s_add_u32 s47, s47, 6144
    buffer_store_dwordx4 v[208:211], v0, s[28:31], s47 offen offset:0 sc1
    buffer_store_dwordx4 v[212:215], v0, s[28:31], s47 offen offset:1024 sc1
K1_PS10:
    v_cvt_pk_bf16_f32 v216, v80, v81
    s_waitcnt lgkmcnt(11)
    v_mfma_f32_32x32x16_bf16 v[128:143], v[48:51], v[196:199], v[128:143]
    ds_read_b128 v[204:207], v252 offset:3072
    ds_read_b64_tr_b16 v[40:41], v250 offset:8192
    ds_read_b64_tr_b16 v[42:43], v250 offset:10240
    v_cvt_pk_bf16_f32 v217, v82, v83
    v_cvt_pk_bf16_f32 v218, v84, v85
    v_cvt_pk_bf16_f32 v219, v86, v87
    v_cvt_pk_bf16_f32 v220, v88, v89
    v_cvt_pk_bf16_f32 v221, v90, v91
    s_waitcnt lgkmcnt(12)
    v_mfma_f32_32x32x16_bf16 v[144:159], v[52:55], v[196:199], v[144:159]
    ds_read_b64_tr_b16 v[44:45], v251 offset:8192
    ds_read_b64_tr_b16 v[46:47], v251 offset:10240
    buffer_load_dwordx4 v0, s[4:7], s41 offen offset:1024 sc1 lds
    v_cvt_pk_bf16_f32 v222, v92, v93
    v_cvt_pk_bf16_f32 v223, v94, v95
    s_waitcnt lgkmcnt(11)
    v_mfma_f32_32x32x16_bf16 v[160:175], v[56:59], v[196:199], v[160:175]
    ds_read_b64_tr_b16 v[48:49], v248 offset:12288
    ds_read_b64_tr_b16 v[50:51], v248 offset:14336
    s_cmp_eq_u32 s51, 1
    s_cbranch_scc1 K1_PS11
    s_cmp_gt_u32 s51, 1
    s_cselect_b32 s47, 1, 0
    s_sub_u32 s47, s51, s47
    s_lshl_b32 s47, s47, 11
    s_add_u32 s47, s47, s53
    s_add_u32 s47, s47, 55296
    buffer_store_dwordx4 v[216:219], v0, s[28:31], s47 offen offset:0 sc1
    buffer_store_dwordx4 v[220:223], v0, s[28:31], s47 offen offset:1024 sc1
K1_PS11:
    s_waitcnt lgkmcnt(11)
    v_mfma_f32_32x32x16_bf16 v[176:191], v[60:63], v[196:199], v[176:191]
    ds_read_b64_tr_b16 v[52:53], v249 offset:12288
    ds_read_b64_tr_b16 v[54:55], v249 offset:14336
    buffer_load_dwordx4 v0, s[4:7], s41 offen offset:2048 sc1 lds
    v_cvt_pk_bf16_f32 v224, v96, v97
    v_cvt_pk_bf16_f32 v225, v98, v99
    v_cvt_pk_bf16_f32 v226, v100, v101
    v_cvt_pk_bf16_f32 v227, v102, v103
    v_cvt_pk_bf16_f32 v228, v104, v105
    s_waitcnt lgkmcnt(11)
    v_mfma_f32_32x32x16_bf16 v[128:143], v[32:35], v[200:203], v[128:143]
    ds_read_b64_tr_b16 v[56:57], v250 offset:12288
    ds_read_b64_tr_b16 v[58:59], v250 offset:14336
    v_cvt_pk_bf16_f32 v229, v106, v107
    v_cvt_pk_bf16_f32 v230, v108, v109
    v_cvt_pk_bf16_f32 v231, v110, v111
    s_waitcnt lgkmcnt(11)
    v_mfma_f32_32x32x16_bf16 v[144:159], v[36:39], v[200:203], v[144:159]
    ds_read_b64_tr_b16 v[60:61], v251 offset:12288
    ds_read_b64_tr_b16 v[62:63], v251 offset:14336
    buffer_load_dwordx4 v0, s[4:7], s41 offen offset:3072 sc1 lds
    v_add_u32 v248, 32768, v248
    v_add_u32 v249, 32768, v249
    v_add_u32 v250, 32768, v250
    v_add_u32 v251, 32768, v251
    v_add_u32 v252, 32768, v252
    s_waitcnt lgkmcnt(10)
    v_mfma_f32_32x32x16_bf16 v[160:175], v[40:43], v[200:203], v[160:175]
    s_waitcnt vmcnt(12)
    s_barrier
    ds_read_b128 v[192:195], v252 offset:0
    ds_read_b64_tr_b16 v[32:33], v248 offset:0
    ds_read_b64_tr_b16 v[34:35], v248 offset:2048
    s_waitcnt lgkmcnt(11)
    v_mfma_f32_32x32x16_bf16 v[176:191], v[44:47], v[200:203], v[176:191]
    ds_read_b64_tr_b16 v[36:37], v249 offset:0
    ds_read_b64_tr_b16 v[38:39], v249 offset:2048
    s_add_u32 m0, s42, 0
    s_lshl_b32 s47, s33, 1
    s_add_u32 s47, s47, 5
    s_and_b32 s47, s47, 15
    s_lshl_b32 s47, s47, 16
    s_add_u32 s40, s39, s47
    buffer_load_dwordx4 v244, s[12:15], s40 offen lds
    s_waitcnt lgkmcnt(11)
    v_mfma_f32_32x32x16_bf16 v[128:143], v[48:51], v[204:207], v[128:143]
    ds_read_b128 v[196:199], v252 offset:1024
    ds_read_b64_tr_b16 v[40:41], v250 offset:0
    ds_read_b64_tr_b16 v[42:43], v250 offset:2048
    s_cmp_eq_u32 s51, 2
    s_cbranch_scc1 K1_PS12
    s_cmp_gt_u32 s51, 2
    s_cselect_b32 s47, 1, 0
    s_sub_u32 s47, s51, s47
    s_lshl_b32 s47, s47, 11
    s_add_u32 s47, s47, s53
    s_add_u32 s47, s47, 104448
    buffer_store_dwordx4 v[224:227], v0, s[28:31], s47 offen offset:0 sc1
    buffer_store_dwordx4 v[228:231], v0, s[28:31], s47 offen offset:1024 sc1
K1_PS12:
    v_cvt_pk_bf16_f32 v232, v112, v113
    s_waitcnt lgkmcnt(12)
    v_mfma_f32_32x32x16_bf16 v[144:159], v[52:55], v[204:207], v[144:159]
    ds_read_b64_tr_b16 v[44:45], v251 offset:0
    ds_read_b64_tr_b16 v[46:47], v251 offset:2048
    buffer_load_dwordx4 v245, s[12:15], s40 offen offset:1024 lds
    v_cvt_pk_bf16_f32 v233, v114, v115
    v_cvt_pk_bf16_f32 v234, v116, v117
    v_cvt_pk_bf16_f32 v235, v118, v119
    v_cvt_pk_bf16_f32 v236, v120, v121
    v_cvt_pk_bf16_f32 v237, v122, v123
    s_waitcnt lgkmcnt(12)
    v_mfma_f32_32x32x16_bf16 v[160:175], v[56:59], v[204:207], v[160:175]
    ds_read_b64_tr_b16 v[48:49], v248 offset:4096
    ds_read_b64_tr_b16 v[50:51], v248 offset:6144
    v_cvt_pk_bf16_f32 v238, v124, v125
    v_cvt_pk_bf16_f32 v239, v126, v127
    s_waitcnt lgkmcnt(12)
    v_mfma_f32_32x32x16_bf16 v[176:191], v[60:63], v[204:207], v[176:191]
    ds_read_b64_tr_b16 v[52:53], v249 offset:4096
    ds_read_b64_tr_b16 v[54:55], v249 offset:6144
    buffer_load_dwordx4 v246, s[12:15], s40 offen offset:2048 lds
    s_cmp_eq_u32 s51, 3
    s_cbranch_scc1 K1_PS13
    s_cmp_gt_u32 s51, 3
    s_cselect_b32 s47, 1, 0
    s_sub_u32 s47, s51, s47
    s_lshl_b32 s47, s47, 11
    s_add_u32 s47, s47, s53
    s_add_u32 s47, s47, 153600
    buffer_store_dwordx4 v[232:235], v0, s[28:31], s47 offen offset:0 sc1
    buffer_store_dwordx4 v[236:239], v0, s[28:31], s47 offen offset:1024 sc1
K1_PS13:
    s_mov_b32 s60, 1160
    s_mov_b32 s45, 2
    s_mov_b32 s38, 0
    s_mov_b32 s62, 4294836224
    s_mov_b32 s44, s42
    s_lshl_b32 s96, s33, 1
    s_add_u32 s96, s96, 5
    s_lshl_b32 s47, s33, 1
    s_add_u32 s47, s47, 5
    s_and_b32 s47, s47, 15
    s_lshl_b32 s41, s47, 12
    s_mov_b32 m0, s44
.p2align 6
K1_BLOOP:
    s_waitcnt lgkmcnt(11)
    v_mfma_f32_32x32x16_bf16 v[128:143], v[32:35], v[192:195], v[128:143]
    ds_read_b128 v[200:203], v252 offset:2048
    ds_read_b64_tr_b16 v[56:57], v250 offset:4096
    ds_read_b64_tr_b16 v[58:59], v250 offset:6144
    s_bitcmp1_b32 s60, s38
    s_cbranch_scc1 K1_BSP
K1_BSP_RET:
    s_waitcnt lgkmcnt(12)
    v_mfma_f32_32x32x16_bf16 v[144:159], v[36:39], v[192:195], v[144:159]
    ds_read_b64_tr_b16 v[60:61], v251 offset:4096
    ds_read_b64_tr_b16 v[62:63], v251 offset:6144
    buffer_load_dwordx4 v247, s[12:15], s40 offen offset:3072 lds
    s_add_u32 m0, s44, 16384
    s_waitcnt lgkmcnt(11)
    v_mfma_f32_32x32x16_bf16 v[160:175], v[40:43], v[192:195], v[160:175]
    ds_read_b64_tr_b16 v[32:33], v248 offset:8192
    ds_read_b64_tr_b16 v[34:35], v248 offset:10240
    s_add_u32 s45, s45, 1
    s_cmp_eq_u32 s45, 5
    s_cselect_b32 s46, s62, 32768
    s_cselect_b32 s45, 0, s45
    s_waitcnt lgkmcnt(11)
    v_mfma_f32_32x32x16_bf16 v[176:191], v[44:47], v[192:195], v[176:191]
    ds_read_b64_tr_b16 v[36:37], v249 offset:8192
    ds_read_b64_tr_b16 v[38:39], v249 offset:10240
    buffer_load_dwordx4 v0, s[4:7], s41 offen sc1 lds
    s_waitcnt lgkmcnt(11)
    v_mfma_f32_32x32x16_bf16 v[128:143], v[48:51], v[196:199], v[128:143]
    ds_read_b128 v[204:207], v252 offset:3072
    ds_read_b64_tr_b16 v[40:41], v250 offset:8192
    ds_read_b64_tr_b16 v[42:43], v250 offset:10240
    s_waitcnt lgkmcnt(12)
    v_mfma_f32_32x32x16_bf16 v[144:159], v[52:55], v[196:199], v[144:159]
    ds_read_b64_tr_b16 v[44:45], v251 offset:8192
    ds_read_b64_tr_b16 v[46:47], v251 offset:10240
    buffer_load_dwordx4 v0, s[4:7], s41 offen offset:1024 sc1 lds
    s_waitcnt lgkmcnt(11)
    v_mfma_f32_32x32x16_bf16 v[160:175], v[56:59], v[196:199], v[160:175]
    ds_read_b64_tr_b16 v[48:49], v248 offset:12288
    ds_read_b64_tr_b16 v[50:51], v248 offset:14336
    s_waitcnt lgkmcnt(11)
    v_mfma_f32_32x32x16_bf16 v[176:191], v[60:63], v[196:199], v[176:191]
    ds_read_b64_tr_b16 v[52:53], v249 offset:12288
    ds_read_b64_tr_b16 v[54:55], v249 offset:14336
    buffer_load_dwordx4 v0, s[4:7], s41 offen offset:2048 sc1 lds
    s_waitcnt lgkmcnt(11)
    v_mfma_f32_32x32x16_bf16 v[128:143], v[32:35], v[200:203], v[128:143]
    ds_read_b64_tr_b16 v[56:57], v250 offset:12288
    ds_read_b64_tr_b16 v[58:59], v250 offset:14336
    s_waitcnt lgkmcnt(11)
    v_mfma_f32_32x32x16_bf16 v[144:159], v[36:39], v[200:203], v[144:159]
    ds_read_b64_tr_b16 v[60:61], v251 offset:12288
    ds_read_b64_tr_b16 v[62:63], v251 offset:14336
    buffer_load_dwordx4 v0, s[4:7], s41 offen offset:3072 sc1 lds
    v_add_u32 v248, s46, v248
    v_add_u32 v249, s46, v249
    v_add_u32 v250, s46, v250
    v_add_u32 v251, s46, v251
    v_add_u32 v252, s46, v252
    s_add_u32 s96, s96, 1
    s_and_b32 s47, s96, 15
    s_cmp_ge_u32 s38, 10
    s_cselect_b32 s47, 0x4000, s47
    s_lshl_b32 s41, s47, 12
    s_lshl_b32 s47, s47, 16
    s_add_u32 s40, s39, s47
    s_add_u32 s44, s44, 32768
    s_cmp_ge_u32 s44, 163840
    s_cselect_b32 s47, 163840, 0
    s_sub_u32 s44, s44, s47
    s_waitcnt lgkmcnt(10)
    v_mfma_f32_32x32x16_bf16 v[160:175], v[40:43], v[200:203], v[160:175]
    s_waitcnt vmcnt(16)
    s_barrier
    s_mov_b32 m0, s44
    ds_read_b128 v[192:195], v252 offset:0
    ds_read_b64_tr_b16 v[32:33], v248 offset:0
    ds_read_b64_tr_b16 v[34:35], v248 offset:2048
    s_waitcnt lgkmcnt(11)
    v_mfma_f32_32x32x16_bf16 v[176:191], v[44:47], v[200:203], v[176:191]
    ds_read_b64_tr_b16 v[36:37], v249 offset:0
    ds_read_b64_tr_b16 v[38:39], v249 offset:2048
    buffer_load_dwordx4 v244, s[12:15], s40 offen lds
    s_waitcnt lgkmcnt(11)
    v_mfma_f32_32x32x16_bf16 v[128:143], v[48:51], v[204:207], v[128:143]
    ds_read_b128 v[196:199], v252 offset:1024
    ds_read_b64_tr_b16 v[40:41], v250 offset:0
    ds_read_b64_tr_b16 v[42:43], v250 offset:2048
    s_waitcnt lgkmcnt(12)
    v_mfma_f32_32x32x16_bf16 v[144:159], v[52:55], v[204:207], v[144:159]
    ds_read_b64_tr_b16 v[44:45], v251 offset:0
    ds_read_b64_tr_b16 v[46:47], v251 offset:2048
    buffer_load_dwordx4 v245, s[12:15], s40 offen offset:1024 lds
    s_waitcnt lgkmcnt(12)
    v_mfma_f32_32x32x16_bf16 v[160:175], v[56:59], v[204:207], v[160:175]
    ds_read_b64_tr_b16 v[48:49], v248 offset:4096
    ds_read_b64_tr_b16 v[50:51], v248 offset:6144
    s_waitcnt lgkmcnt(12)
    v_mfma_f32_32x32x16_bf16 v[176:191], v[60:63], v[204:207], v[176:191]
    ds_read_b64_tr_b16 v[52:53], v249 offset:4096
    ds_read_b64_tr_b16 v[54:55], v249 offset:6144
    buffer_load_dwordx4 v246, s[12:15], s40 offen offset:2048 lds
    s_add_u32 s38, s38, 1
    s_cmp_lt_u32 s38, 14
    s_cbranch_scc1 K1_BLOOP
    s_nop 7
    s_nop 3
    v_cvt_pk_bf16_f32 v208, v128, v129
    v_cvt_pk_bf16_f32 v209, v130, v131
    v_cvt_pk_bf16_f32 v210, v132, v133
    v_cvt_pk_bf16_f32 v211, v134, v135
    v_cvt_pk_bf16_f32 v212, v136, v137
    v_cvt_pk_bf16_f32 v213, v138, v139
    v_cvt_pk_bf16_f32 v214, v140, v141
    v_cvt_pk_bf16_f32 v215, v142, v143
    v_min_u32 v208, -2, v208
    v_min_u32 v209, -2, v209
    v_min_u32 v210, -2, v210
    v_min_u32 v211, -2, v211
    v_min_u32 v212, -2, v212
    v_min_u32 v213, -2, v213
    v_min_u32 v214, -2, v214
    v_min_u32 v215, -2, v215
    s_cmp_eq_u32 s51, 0
    s_cbranch_scc1 K1_PS00
    s_cmp_gt_u32 s51, 0
    s_cselect_b32 s47, 1, 0
    s_sub_u32 s47, s51, s47
    s_lshl_b32 s47, s47, 11
    s_add_u32 s47, s47, s53
    s_add_u32 s47, s47, 0
    buffer_store_dwordx4 v[208:211], v0, s[28:31], s47 offen offset:0 sc1
    buffer_store_dwordx4 v[212:215], v0, s[28:31], s47 offen offset:1024 sc1
K1_PS00:
    v_cvt_pk_bf16_f32 v216, v144, v145
    v_cvt_pk_bf16_f32 v217, v146, v147
    v_cvt_pk_bf16_f32 v218, v148, v149
    v_cvt_pk_bf16_f32 v219, v150, v151
    v_cvt_pk_bf16_f32 v220, v152, v153
    v_cvt_pk_bf16_f32 v221, v154, v155
    v_cvt_pk_bf16_f32 v222, v156, v157
    v_cvt_pk_bf16_f32 v223, v158, v159
    v_min_u32 v216, -2, v216
    v_min_u32 v217, -2, v217
    v_min_u32 v218, -2, v218
    v_min_u32 v219, -2, v219
    v_min_u32 v220, -2, v220
    v_min_u32 v221, -2, v221
    v_min_u32 v222, -2, v222
    v_min_u32 v223, -2, v223
    s_cmp_eq_u32 s51, 1
    s_cbranch_scc1 K1_PS01
    s_cmp_gt_u32 s51, 1
    s_cselect_b32 s47, 1, 0
    s_sub_u32 s47, s51, s47
    s_lshl_b32 s47, s47, 11
    s_add_u32 s47, s47, s53
    s_add_u32 s47, s47, 49152
    buffer_store_dwordx4 v[216:219], v0, s[28:31], s47 offen offset:0 sc1
    buffer_store_dwordx4 v[220:223], v0, s[28:31], s47 offen offset:1024 sc1
K1_PS01:
    v_cvt_pk_bf16_f32 v224, v160, v161
    v_cvt_pk_bf16_f32 v225, v162, v163
    v_cvt_pk_bf16_f32 v226, v164, v165
    v_cvt_pk_bf16_f32 v227, v166, v167
    v_cvt_pk_bf16_f32 v228, v168, v169
    v_cvt_pk_bf16_f32 v229, v170, v171
    v_cvt_pk_bf16_f32 v230, v172, v173
    v_cvt_pk_bf16_f32 v231, v174, v175
    v_min_u32 v224, -2, v224
    v_min_u32 v225, -2, v225
    v_min_u32 v226, -2, v226
    v_min_u32 v227, -2, v227
    v_min_u32 v228, -2, v228
    v_min_u32 v229, -2, v229
    v_min_u32 v230, -2, v230
    v_min_u32 v231, -2, v231
    s_cmp_eq_u32 s51, 2
    s_cbranch_scc1 K1_PS02
    s_cmp_gt_u32 s51, 2
    s_cselect_b32 s47, 1, 0
    s_sub_u32 s47, s51, s47
    s_lshl_b32 s47, s47, 11
    s_add_u32 s47, s47, s53
    s_add_u32 s47, s47, 98304
    buffer_store_dwordx4 v[224:227], v0, s[28:31], s47 offen offset:0 sc1
    buffer_store_dwordx4 v[228:231], v0, s[28:31], s47 offen offset:1024 sc1
K1_PS02:
    v_cvt_pk_bf16_f32 v232, v176, v177
    v_cvt_pk_bf16_f32 v233, v178, v179
    v_cvt_pk_bf16_f32 v234, v180, v181
    v_cvt_pk_bf16_f32 v235, v182, v183
    v_cvt_pk_bf16_f32 v236, v184, v185
    v_cvt_pk_bf16_f32 v237, v186, v187
    v_cvt_pk_bf16_f32 v238, v188, v189
    v_cvt_pk_bf16_f32 v239, v190, v191
    v_min_u32 v232, -2, v232
    v_min_u32 v233, -2, v233
    v_min_u32 v234, -2, v234
    v_min_u32 v235, -2, v235
    v_min_u32 v236, -2, v236
    v_min_u32 v237, -2, v237
    v_min_u32 v238, -2, v238
    v_min_u32 v239, -2, v239
    s_cmp_eq_u32 s51, 3
    s_cbranch_scc1 K1_PS03
    s_cmp_gt_u32 s51, 3
    s_cselect_b32 s47, 1, 0
    s_sub_u32 s47, s51, s47
    s_lshl_b32 s47, s47, 11
    s_add_u32 s47, s47, s53
    s_add_u32 s47, s47, 147456
    buffer_store_dwordx4 v[232:235], v0, s[28:31], s47 offen offset:0 sc1
    buffer_store_dwordx4 v[236:239], v0, s[28:31], s47 offen offset:1024 sc1
K1_PS03:
    s_waitcnt lgkmcnt(0)
    s_mul_i32 s47, s51, 49152
    s_add_u32 s47, s47, s53
    s_add_u32 s48, s47, 4096
    s_mov_b32 s62, 0xffff0000
    s_cmp_eq_u32 s51, 0
    s_cbranch_scc0 K1_OW0
    v_mov_b32 v192, v128
    v_mov_b32 v12, v64
    v_mov_b32 v193, v129
    v_mov_b32 v13, v65
    v_mov_b32 v194, v130
    v_mov_b32 v14, v66
    v_mov_b32 v195, v131
    v_mov_b32 v15, v67
    v_mov_b32 v196, v132
    v_mov_b32 v16, v68
    v_mov_b32 v197, v133
    v_mov_b32 v17, v69
    v_mov_b32 v198, v134
    v_mov_b32 v18, v70
    v_mov_b32 v199, v135
    v_mov_b32 v19, v71
    v_mov_b32 v200, v136
    v_mov_b32 v20, v72
    v_mov_b32 v201, v137
    v_mov_b32 v21, v73
    v_mov_b32 v202, v138
    v_mov_b32 v22, v74
    v_mov_b32 v203, v139
    v_mov_b32 v23, v75
    v_mov_b32 v204, v140
    v_mov_b32 v24, v76
    v_mov_b32 v205, v141
    v_mov_b32 v25, v77
    v_mov_b32 v206, v142
    v_mov_b32 v26, v78
    v_mov_b32 v207, v143
    v_mov_b32 v27, v79
K1_OW0:
    s_cmp_eq_u32 s51, 1
    s_cbranch_scc0 K1_OW1
    v_mov_b32 v192, v144
    v_mov_b32 v12, v80
    v_mov_b32 v193, v145
    v_mov_b32 v13, v81
    v_mov_b32 v194, v146
    v_mov_b32 v14, v82
    v_mov_b32 v195, v147
    v_mov_b32 v15, v83
    v_mov_b32 v196, v148
    v_mov_b32 v16, v84
    v_mov_b32 v197, v149
    v_mov_b32 v17, v85
    v_mov_b32 v198, v150
    v_mov_b32 v18, v86
    v_mov_b32 v199, v151
    v_mov_b32 v19, v87
    v_mov_b32 v200, v152
    v_mov_b32 v20, v88
    v_mov_b32 v201, v153
    v_mov_b32 v21, v89
    v_mov_b32 v202, v154
    v_mov_b32 v22, v90
    v_mov_b32 v203, v155
    v_mov_b32 v23, v91
    v_mov_b32 v204, v156
    v_mov_b32 v24, v92
    v_mov_b32 v205, v157
    v_mov_b32 v25, v93
    v_mov_b32 v206, v158
    v_mov_b32 v26, v94
    v_mov_b32 v207, v159
    v_mov_b32 v27, v95
K1_OW1:
    s_cmp_eq_u32 s51, 2
    s_cbranch_scc0 K1_OW2
    v_mov_b32 v192, v160
    v_mov_b32 v12, v96
    v_mov_b32 v193, v161
    v_mov_b32 v13, v97
    v_mov_b32 v194, v162
    v_mov_b32 v14, v98
    v_mov_b32 v195, v163
    v_mov_b32 v15, v99
    v_mov_b32 v196, v164
    v_mov_b32 v16, v100
    v_mov_b32 v197, v165
    v_mov_b32 v17, v101
    v_mov_b32 v198, v166
    v_mov_b32 v18, v102
    v_mov_b32 v199, v167
    v_mov_b32 v19, v103
    v_mov_b32 v200, v168
    v_mov_b32 v20, v104
    v_mov_b32 v201, v169
    v_mov_b32 v21, v105
    v_mov_b32 v202, v170
    v_mov_b32 v22, v106
    v_mov_b32 v203, v171
    v_mov_b32 v23, v107
    v_mov_b32 v204, v172
    v_mov_b32 v24, v108
    v_mov_b32 v205, v173
    v_mov_b32 v25, v109
    v_mov_b32 v206, v174
    v_mov_b32 v26, v110
    v_mov_b32 v207, v175
    v_mov_b32 v27, v111
K1_OW2:
    s_cmp_eq_u32 s51, 3
    s_cbranch_scc0 K1_OW3
    v_mov_b32 v192, v176
    v_mov_b32 v12, v112
    v_mov_b32 v193, v177
    v_mov_b32 v13, v113
    v_mov_b32 v194, v178
    v_mov_b32 v14, v114
    v_mov_b32 v195, v179
    v_mov_b32 v15, v115
    v_mov_b32 v196, v180
    v_mov_b32 v16, v116
    v_mov_b32 v197, v181
    v_mov_b32 v17, v117
    v_mov_b32 v198, v182
    v_mov_b32 v18, v118
    v_mov_b32 v199, v183
    v_mov_b32 v19, v119
    v_mov_b32 v200, v184
    v_mov_b32 v20, v120
    v_mov_b32 v201, v185
    v_mov_b32 v21, v121
    v_mov_b32 v202, v186
    v_mov_b32 v22, v122
    v_mov_b32 v203, v187
    v_mov_b32 v23, v123
    v_mov_b32 v204, v188
    v_mov_b32 v24, v124
    v_mov_b32 v205, v189
    v_mov_b32 v25, v125
    v_mov_b32 v206, v190
    v_mov_b32 v26, v126
    v_mov_b32 v207, v191
    v_mov_b32 v27, v127
K1_OW3:
    v_accvgpr_read_b32 v113, a48
    v_accvgpr_read_b32 v115, a49
    v_accvgpr_read_b32 v117, a50
    v_accvgpr_read_b32 v119, a51
    v_accvgpr_read_b32 v121, a52
    v_accvgpr_read_b32 v123, a53
    v_accvgpr_read_b32 v125, a54
    v_accvgpr_read_b32 v127, a55
    v_lshlrev_b32 v112, 16, v113
    v_and_b32 v113, s62, v113
    v_lshlrev_b32 v114, 16, v115
    v_and_b32 v115, s62, v115
    v_lshlrev_b32 v116, 16, v117
    v_and_b32 v117, s62, v117
    v_lshlrev_b32 v118, 16, v119
    v_and_b32 v119, s62, v119
    v_lshlrev_b32 v120, 16, v121
    v_and_b32 v121, s62, v121
    v_lshlrev_b32 v122, 16, v123
    v_and_b32 v123, s62, v123
    v_lshlrev_b32 v124, 16, v125
    v_and_b32 v125, s62, v125
    v_lshlrev_b32 v126, 16, v127
    v_and_b32 v127, s62, v127
    v_pk_add_f32 v[12:13], v[12:13], v[112:113]
    v_pk_add_f32 v[14:15], v[14:15], v[114:115]
    v_pk_add_f32 v[16:17], v[16:17], v[116:117]
    v_pk_add_f32 v[18:19], v[18:19], v[118:119]
    v_pk_add_f32 v[20:21], v[20:21], v[120:121]
    v_pk_add_f32 v[22:23], v[22:23], v[122:123]
    v_pk_add_f32 v[24:25], v[24:25], v[124:125]
    v_pk_add_f32 v[26:27], v[26:27], v[126:127]
    v_accvgpr_read_b32 v113, a56
    v_accvgpr_read_b32 v115, a57
    v_accvgpr_read_b32 v117, a58
    v_accvgpr_read_b32 v119, a59
    v_accvgpr_read_b32 v121, a60
    v_accvgpr_read_b32 v123, a61
    v_accvgpr_read_b32 v125, a62
    v_accvgpr_read_b32 v127, a63
    v_lshlrev_b32 v112, 16, v113
    v_and_b32 v113, s62, v113
    v_lshlrev_b32 v114, 16, v115
    v_and_b32 v115, s62, v115
    v_lshlrev_b32 v116, 16, v117
    v_and_b32 v117, s62, v117
    v_lshlrev_b32 v118, 16, v119
    v_and_b32 v119, s62, v119
    v_lshlrev_b32 v120, 16, v121
    v_and_b32 v121, s62, v121
    v_lshlrev_b32 v122, 16, v123
    v_and_b32 v123, s62, v123
    v_lshlrev_b32 v124, 16, v125
    v_and_b32 v125, s62, v125
    v_lshlrev_b32 v126, 16, v127
    v_and_b32 v127, s62, v127
    v_pk_add_f32 v[12:13], v[12:13], v[112:113]
    v_pk_add_f32 v[14:15], v[14:15], v[114:115]
    v_pk_add_f32 v[16:17], v[16:17], v[116:117]
    v_pk_add_f32 v[18:19], v[18:19], v[118:119]
    v_pk_add_f32 v[20:21], v[20:21], v[120:121]
    v_pk_add_f32 v[22:23], v[22:23], v[122:123]
    v_pk_add_f32 v[24:25], v[24:25], v[124:125]
    v_pk_add_f32 v[26:27], v[26:27], v[126:127]
    v_accvgpr_read_b32 v113, a64
    v_accvgpr_read_b32 v115, a65
    v_accvgpr_read_b32 v117, a66
    v_accvgpr_read_b32 v119, a67
    v_accvgpr_read_b32 v121, a68
    v_accvgpr_read_b32 v123, a69
    v_accvgpr_read_b32 v125, a70
    v_accvgpr_read_b32 v127, a71
    v_lshlrev_b32 v112, 16, v113
    v_and_b32 v113, s62, v113
    v_lshlrev_b32 v114, 16, v115
    v_and_b32 v115, s62, v115
    v_lshlrev_b32 v116, 16, v117
    v_and_b32 v117, s62, v117
    v_lshlrev_b32 v118, 16, v119
    v_and_b32 v119, s62, v119
    v_lshlrev_b32 v120, 16, v121
    v_and_b32 v121, s62, v121
    v_lshlrev_b32 v122, 16, v123
    v_and_b32 v123, s62, v123
    v_lshlrev_b32 v124, 16, v125
    v_and_b32 v125, s62, v125
    v_lshlrev_b32 v126, 16, v127
    v_and_b32 v127, s62, v127
    v_pk_add_f32 v[12:13], v[12:13], v[112:113]
    v_pk_add_f32 v[14:15], v[14:15], v[114:115]
    v_pk_add_f32 v[16:17], v[16:17], v[116:117]
    v_pk_add_f32 v[18:19], v[18:19], v[118:119]
    v_pk_add_f32 v[20:21], v[20:21], v[120:121]
    v_pk_add_f32 v[22:23], v[22:23], v[122:123]
    v_pk_add_f32 v[24:25], v[24:25], v[124:125]
    v_pk_add_f32 v[26:27], v[26:27], v[126:127]
    buffer_load_dwordx4 v[32:35], v0, s[28:31], s47 offen offset:0 sc1
    buffer_load_dwordx4 v[36:39], v0, s[28:31], s47 offen offset:1024 sc1
    buffer_load_dwordx4 v[40:43], v0, s[28:31], s47 offen offset:2048 sc1
    buffer_load_dwordx4 v[44:47], v0, s[28:31], s47 offen offset:3072 sc1
    buffer_load_dwordx4 v[48:51], v0, s[28:31], s48 offen offset:0 sc1
    buffer_load_dwordx4 v[52:55], v0, s[28:31], s48 offen offset:1024 sc1
    v_mul_f32 v144, 3216550459, v12
    v_mul_f32 v145, 3216550459, v13
    v_mul_f32 v146, 3216550459, v14
    v_mul_f32 v147, 3216550459, v15
    v_mul_f32 v148, 3216550459, v16
    v_mul_f32 v149, 3216550459, v17
    v_mul_f32 v150, 3216550459, v18
    v_mul_f32 v151, 3216550459, v19
    v_mul_f32 v152, 3216550459, v20
    v_mul_f32 v153, 3216550459, v21
    v_mul_f32 v154, 3216550459, v22
    v_mul_f32 v155, 3216550459, v23
    v_mul_f32 v156, 3216550459, v24
    v_mul_f32 v157, 3216550459, v25
    v_mul_f32 v158, 3216550459, v26
    v_mul_f32 v159, 3216550459, v27
    v_exp_f32 v144, v144
    v_exp_f32 v145, v145
    v_exp_f32 v146, v146
    v_exp_f32 v147, v147
    v_exp_f32 v148, v148
    v_exp_f32 v149, v149
    v_exp_f32 v150, v150
    v_exp_f32 v151, v151
    v_exp_f32 v152, v152
    v_exp_f32 v153, v153
    v_exp_f32 v154, v154
    v_exp_f32 v155, v155
    v_exp_f32 v156, v156
    v_exp_f32 v157, v157
    v_exp_f32 v158, v158
    v_exp_f32 v159, v159
    v_lshlrev_b32 v128, 16, v4
    v_and_b32 v129, s62, v4
    v_lshlrev_b32 v130, 16, v5
    v_and_b32 v131, s62, v5
    v_lshlrev_b32 v132, 16, v6
    v_and_b32 v133, s62, v6
    v_lshlrev_b32 v134, 16, v7
    v_and_b32 v135, s62, v7
    v_lshlrev_b32 v136, 16, v8
    v_and_b32 v137, s62, v8
    v_lshlrev_b32 v138, 16, v9
    v_and_b32 v139, s62, v9
    v_lshlrev_b32 v140, 16, v10
    v_and_b32 v141, s62, v10
    v_lshlrev_b32 v142, 16, v11
    v_and_b32 v143, s62, v11
    v_add_f32 v144, 1.0, v144
    v_add_f32 v145, 1.0, v145
    v_add_f32 v146, 1.0, v146
    v_add_f32 v147, 1.0, v147
    v_add_f32 v148, 1.0, v148
    v_add_f32 v149, 1.0, v149
    v_add_f32 v150, 1.0, v150
    v_add_f32 v151, 1.0, v151
    v_add_f32 v152, 1.0, v152
    v_add_f32 v153, 1.0, v153
    v_add_f32 v154, 1.0, v154
    v_add_f32 v155, 1.0, v155
    v_add_f32 v156, 1.0, v156
    v_add_f32 v157, 1.0, v157
    v_add_f32 v158, 1.0, v158
    v_add_f32 v159, 1.0, v159
    v_rcp_f32 v144, v144
    v_rcp_f32 v145, v145
    v_rcp_f32 v146, v146
    v_rcp_f32 v147, v147
    v_rcp_f32 v148, v148
    v_rcp_f32 v149, v149
    v_rcp_f32 v150, v150
    v_rcp_f32 v151, v151
    v_rcp_f32 v152, v152
    v_rcp_f32 v153, v153
    v_rcp_f32 v154, v154
    v_rcp_f32 v155, v155
    v_rcp_f32 v156, v156
    v_rcp_f32 v157, v157
    v_rcp_f32 v158, v158
    v_rcp_f32 v159, v159
    s_nop 0
    v_pk_mul_f32 v[144:145], v[144:145], v[12:13]
    v_pk_mul_f32 v[146:147], v[146:147], v[14:15]
    v_pk_mul_f32 v[148:149], v[148:149], v[16:17]
    v_pk_mul_f32 v[150:151], v[150:151], v[18:19]
    v_pk_mul_f32 v[152:153], v[152:153], v[20:21]
    v_pk_mul_f32 v[154:155], v[154:155], v[22:23]
    v_pk_mul_f32 v[156:157], v[156:157], v[24:25]
    v_pk_mul_f32 v[158:159], v[158:159], v[26:27]
K1_POLL:
    s_waitcnt vmcnt(0)
    v_max_u32 v1, v32, v33
    v_max3_u32 v1, v34, v35, v1
    v_max3_u32 v1, v36, v37, v1
    v_max3_u32 v1, v38, v39, v1
    v_max3_u32 v1, v40, v41, v1
    v_max3_u32 v1, v42, v43, v1
    v_max3_u32 v1, v44, v45, v1
    v_max3_u32 v1, v46, v47, v1
    v_max3_u32 v1, v48, v49, v1
    v_max3_u32 v1, v50, v51, v1
    v_max3_u32 v1, v52, v53, v1
    v_max3_u32 v1, v54, v55, v1
    v_cmp_eq_u32 vcc, -1, v1
    s_nop 1
    s_cbranch_vccnz K1_POLL2
    v_lshlrev_b32 v112, 16, v32
    v_and_b32 v113, s62, v32
    v_lshlrev_b32 v114, 16, v33
    v_and_b32 v115, s62, v33
    v_lshlrev_b32 v116, 16, v34
    v_and_b32 v117, s62, v34
    v_lshlrev_b32 v118, 16, v35
    v_and_b32 v119, s62, v35
    v_lshlrev_b32 v120, 16, v36
    v_and_b32 v121, s62, v36
    v_lshlrev_b32 v122, 16, v37
    v_and_b32 v123, s62, v37
    v_lshlrev_b32 v124, 16, v38
    v_and_b32 v125, s62, v38
    v_lshlrev_b32 v126, 16, v39
    v_and_b32 v127, s62, v39
    v_pk_add_f32 v[192:193], v[192:193], v[112:113]
    v_pk_add_f32 v[194:195], v[194:195], v[114:115]
    v_pk_add_f32 v[196:197], v[196:197], v[116:117]
    v_pk_add_f32 v[198:199], v[198:199], v[118:119]
    v_pk_add_f32 v[200:201], v[200:201], v[120:121]
    v_pk_add_f32 v[202:203], v[202:203], v[122:123]
    v_pk_add_f32 v[204:205], v[204:205], v[124:125]
    v_pk_add_f32 v[206:207], v[206:207], v[126:127]
    v_lshlrev_b32 v112, 16, v40
    v_and_b32 v113, s62, v40
    v_lshlrev_b32 v114, 16, v41
    v_and_b32 v115, s62, v41
    v_lshlrev_b32 v116, 16, v42
    v_and_b32 v117, s62, v42
    v_lshlrev_b32 v118, 16, v43
    v_and_b32 v119, s62, v43
    v_lshlrev_b32 v120, 16, v44
    v_and_b32 v121, s62, v44
    v_lshlrev_b32 v122, 16, v45
    v_and_b32 v123, s62, v45
    v_lshlrev_b32 v124, 16, v46
    v_and_b32 v125, s62, v46
    v_lshlrev_b32 v126, 16, v47
    v_and_b32 v127, s62, v47
    v_pk_add_f32 v[192:193], v[192:193], v[112:113]
    v_pk_add_f32 v[194:195], v[194:195], v[114:115]
    v_pk_add_f32 v[196:197], v[196:197], v[116:117]
    v_pk_add_f32 v[198:199], v[198:199], v[118:119]
    v_pk_add_f32 v[200:201], v[200:201], v[120:121]
    v_pk_add_f32 v[202:203], v[202:203], v[122:123]
    v_pk_add_f32 v[204:205], v[204:205], v[124:125]
    v_pk_add_f32 v[206:207], v[206:207], v[126:127]
    v_lshlrev_b32 v112, 16, v48
    v_and_b32 v113, s62, v48
    v_lshlrev_b32 v114, 16, v49
    v_and_b32 v115, s62, v49
    v_lshlrev_b32 v116, 16, v50
    v_and_b32 v117, s62, v50
    v_lshlrev_b32 v118, 16, v51
    v_and_b32 v119, s62, v51
    v_lshlrev_b32 v120, 16, v52
    v_and_b32 v121, s62, v52
    v_lshlrev_b32 v122, 16, v53
    v_and_b32 v123, s62, v53
    v_lshlrev_b32 v124, 16, v54
    v_and_b32 v125, s62, v54
    v_lshlrev_b32 v126, 16, v55
    v_and_b32 v127, s62, v55
    v_pk_add_f32 v[192:193], v[192:193], v[112:113]
    v_pk_add_f32 v[194:195], v[194:195], v[114:115]
    v_pk_add_f32 v[196:197], v[196:197], v[116:117]
    v_pk_add_f32 v[198:199], v[198:199], v[118:119]
    v_pk_add_f32 v[200:201], v[200:201], v[120:121]
    v_pk_add_f32 v[202:203], v[202:203], v[122:123]
    v_pk_add_f32 v[204:205], v[204:205], v[124:125]
    v_pk_add_f32 v[206:207], v[206:207], v[126:127]
    v_pk_fma_f32 v[128:129], v[192:193], v[144:145], v[128:129]
    v_pk_fma_f32 v[130:131], v[194:195], v[146:147], v[130:131]
    v_pk_fma_f32 v[132:133], v[196:197], v[148:149], v[132:133]
    v_pk_fma_f32 v[134:135], v[198:199], v[150:151], v[134:135]
    v_pk_fma_f32 v[136:137], v[200:201], v[152:153], v[136:137]
    v_pk_fma_f32 v[138:139], v[202:203], v[154:155], v[138:139]
    v_pk_fma_f32 v[140:141], v[204:205], v[156:157], v[140:141]
    v_pk_fma_f32 v[142:143], v[206:207], v[158:159], v[142:143]
    v_cvt_pk_bf16_f32 v160, v128, v129
    v_cvt_pk_bf16_f32 v161, v130, v131
    v_cvt_pk_bf16_f32 v162, v132, v133
    v_cvt_pk_bf16_f32 v163, v134, v135
    v_cvt_pk_bf16_f32 v164, v136, v137
    v_cvt_pk_bf16_f32 v165, v138, v139
    v_cvt_pk_bf16_f32 v166, v140, v141
    v_cvt_pk_bf16_f32 v167, v142, v143
    buffer_store_dwordx4 v[160:163], v253, s[24:27], 0 offen
    buffer_store_dwordx4 v[164:167], v253, s[24:27], 0 offen offset:16
K1_END:
    s_endpgm
K1_POLL2:
    buffer_load_dwordx4 v[32:35], v0, s[28:31], s47 offen offset:0 sc1
    buffer_load_dwordx4 v[36:39], v0, s[28:31], s47 offen offset:1024 sc1
    buffer_load_dwordx4 v[40:43], v0, s[28:31], s47 offen offset:2048 sc1
    buffer_load_dwordx4 v[44:47], v0, s[28:31], s47 offen offset:3072 sc1
    buffer_load_dwordx4 v[48:51], v0, s[28:31], s48 offen offset:0 sc1
    buffer_load_dwordx4 v[52:55], v0, s[28:31], s48 offen offset:1024 sc1
    s_branch K1_POLL
K1_BSP:
    s_cmp_eq_u32 s38, 3
    s_cbranch_scc0 K1_BSP7
    v_lshlrev_b32 v255, 5, v0
    s_lshl_b32 s47, s51, 2
    s_add_u32 s47, s47, s54
    v_mov_b32 v29, 1
    s_mov_b64 exec, 15
    buffer_store_dword v29, v255, s[28:31], s47 offen sc1
    s_mov_b64 exec, -1
    s_branch K1_BSP_RET
K1_BSP7:
    s_lshl_b32 s50, s51, 9
    s_add_u32 s50, s50, s54
    v_mov_b32 v31, 0
    s_cmp_eq_u32 s38, 7
    s_cbranch_scc0 K1_BSP10
    buffer_load_dwordx4 v[240:243], v31, s[28:31], s50 offen sc1
    s_branch K1_BSP_RET
K1_BSP10:
    v_min_u32 v1, v240, v241
    v_min3_u32 v1, v242, v243, v1
    s_nop 0
    v_readfirstlane_b32 s47, v1
    s_nop 0
    s_cmp_lg_u32 s47, 0
    s_cbranch_scc1 K1_BSP11
    buffer_load_dwordx4 v[240:243], v31, s[28:31], s50 offen sc1
    s_waitcnt vmcnt(0)
    s_branch K1_BSP10
K1_BSP11:
    s_mul_i32 s47, s51, 49152
    s_add_u32 s47, s47, s53
    s_add_u32 s47, s47, 6144
    s_add_u32 s48, s47, 4096
    buffer_load_dwordx4 a[48:51], v0, s[28:31], s47 offen offset:0 sc1
    buffer_load_dwordx4 a[52:55], v0, s[28:31], s47 offen offset:1024 sc1
    buffer_load_dwordx4 a[56:59], v0, s[28:31], s47 offen offset:2048 sc1
    buffer_load_dwordx4 a[60:63], v0, s[28:31], s47 offen offset:3072 sc1
    buffer_load_dwordx4 a[64:67], v0, s[28:31], s48 offen offset:0 sc1
    buffer_load_dwordx4 a[68:71], v0, s[28:31], s48 offen offset:1024 sc1
    s_branch K1_BSP_RET
K1_PB_SPIN:
    s_sleep 1
    v_lshrrev_b32 v63, 2, v0
    buffer_load_dword v63, v63, s[28:31], s55 offen sc1
    s_waitcnt vmcnt(0)
    s_branch K1_PB
K1_ST_SPIN:
    v_and_b32 v29, 31, v0
    v_lshlrev_b32 v29, 3, v29
    s_lshl_b32 s3, s32, 9
    s_add_u32 s3, s3, s55
    buffer_load_dwordx2 v[116:117], v29, s[28:31], s3 offen offset:2048 sc1
    buffer_load_dwordx2 v[118:119], v29, s[28:31], s3 offen offset:2304 sc1
    s_waitcnt vmcnt(0)
    s_branch K1_ST
K1_P1_SPECIAL:
    s_cmp_ge_u32 s38, 6
    s_cbranch_scc1 K1_SP6
    s_lshl_b32 s3, s34, 2
    v_mov_b32 v29, s3
    s_cmp_eq_u32 s38, 2
    s_cbranch_scc1 K1_SP2
    s_cmp_eq_u32 s38, 4
    s_cbranch_scc1 K1_SP4
    s_or_b32 s3, s33, s32
    s_cbranch_scc1 K1_NOZ2
    v_mov_b32 v30, 1
    s_mov_b64 exec, 1
    global_store_dword v29, v30, s[72:73] sc1
    s_mov_b64 exec, -1
K1_NOZ2:
    v_lshlrev_b32 v48, 16, v112
    v_and_b32 v49, s44, v112
    v_lshlrev_b32 v50, 16, v113
    v_and_b32 v51, s44, v113
    v_lshlrev_b32 v52, 16, v114
    v_and_b32 v53, s44, v114
    v_lshlrev_b32 v54, 16, v115
    v_and_b32 v55, s44, v115
    v_lshlrev_b32 v56, 16, v116
    v_and_b32 v57, s44, v116
    v_lshlrev_b32 v58, 16, v117
    v_and_b32 v59, s44, v117
    v_lshlrev_b32 v60, 16, v118
    v_and_b32 v61, s44, v118
    v_lshlrev_b32 v62, 16, v119
    v_and_b32 v63, s44, v119
    v_add_f32 v1, v48, v49
    v_add_f32 v2, v56, v57
    v_add_f32 v1, v1, v50
    v_add_f32 v2, v2, v58
    v_add_f32 v1, v1, v51
    v_add_f32 v2, v2, v59
    v_add_f32 v1, v1, v52
    v_add_f32 v2, v2, v60
    v_add_f32 v1, v1, v53
    v_add_f32 v2, v2, v61
    v_add_f32 v1, v1, v54
    v_add_f32 v2, v2, v62
    v_add_f32 v1, v1, v55
    v_add_f32 v2, v2, v63
    s_nop 0
    v_add_f32_dpp v1, v1, v1 quad_perm:[1,0,3,2] row_mask:0xf bank_mask:0xf
    v_add_f32_dpp v2, v2, v2 quad_perm:[1,0,3,2] row_mask:0xf bank_mask:0xf
    s_nop 0
    v_add_f32_dpp v1, v1, v1 quad_perm:[2,3,0,1] row_mask:0xf bank_mask:0xf
    v_add_f32_dpp v2, v2, v2 quad_perm:[2,3,0,1] row_mask:0xf bank_mask:0xf
    s_nop 0
    v_add_f32_dpp v1, v1, v1 row_half_mirror row_mask:0xf bank_mask:0xf
    v_add_f32_dpp v2, v2, v2 row_half_mirror row_mask:0xf bank_mask:0xf
    s_nop 0
    v_add_f32_dpp v1, v1, v1 row_mirror row_mask:0xf bank_mask:0xf
    v_add_f32_dpp v2, v2, v2 row_mirror row_mask:0xf bank_mask:0xf
    v_mov_b32 v3, v1
    v_mov_b32 v30, v2
    s_nop 1
    v_permlane16_swap_b32 v3, v1
    v_permlane16_swap_b32 v30, v2
    v_add_f32 v1, v1, v3
    v_add_f32 v2, v2, v30
    v_mov_b32 v3, v1
    v_mov_b32 v30, v2
    s_nop 1
    v_permlane32_swap_b32 v3, v1
    v_permlane32_swap_b32 v30, v2
    v_add_f32 v1, v1, v3
    v_add_f32 v2, v2, v30
    v_mul_f32 v112, 989855744, v1
    v_mul_f32 v114, 989855744, v2
    v_sub_f32 v48, v48, v112
    v_sub_f32 v56, v56, v114
    v_sub_f32 v49, v49, v112
    v_sub_f32 v57, v57, v114
    v_sub_f32 v50, v50, v112
    v_sub_f32 v58, v58, v114
    v_sub_f32 v51, v51, v112
    v_sub_f32 v59, v59, v114
    v_sub_f32 v52, v52, v112
    v_sub_f32 v60, v60, v114
    v_sub_f32 v53, v53, v112
    v_sub_f32 v61, v61, v114
    v_sub_f32 v54, v54, v112
    v_sub_f32 v62, v62, v114
    v_sub_f32 v55, v55, v112
    v_sub_f32 v63, v63, v114
    v_mul_f32 v1, v48, v48
    v_mul_f32 v2, v56, v56
    v_fmac_f32 v1, v49, v49
    v_fmac_f32 v2, v57, v57
    v_fmac_f32 v1, v50, v50
    v_fmac_f32 v2, v58, v58
    v_fmac_f32 v1, v51, v51
    v_fmac_f32 v2, v59, v59
    v_fmac_f32 v1, v52, v52
    v_fmac_f32 v2, v60, v60
    v_fmac_f32 v1, v53, v53
    v_fmac_f32 v2, v61, v61
    v_fmac_f32 v1, v54, v54
    v_fmac_f32 v2, v62, v62
    v_fmac_f32 v1, v55, v55
    v_fmac_f32 v2, v63, v63
    s_nop 0
    v_add_f32_dpp v1, v1, v1 quad_perm:[1,0,3,2] row_mask:0xf bank_mask:0xf
    v_add_f32_dpp v2, v2, v2 quad_perm:[1,0,3,2] row_mask:0xf bank_mask:0xf
    s_nop 0
    v_add_f32_dpp v1, v1, v1 quad_perm:[2,3,0,1] row_mask:0xf bank_mask:0xf
    v_add_f32_dpp v2, v2, v2 quad_perm:[2,3,0,1] row_mask:0xf bank_mask:0xf
    s_nop 0
    v_add_f32_dpp v1, v1, v1 row_half_mirror row_mask:0xf bank_mask:0xf
    v_add_f32_dpp v2, v2, v2 row_half_mirror row_mask:0xf bank_mask:0xf
    s_nop 0
    v_add_f32_dpp v1, v1, v1 row_mirror row_mask:0xf bank_mask:0xf
    v_add_f32_dpp v2, v2, v2 row_mirror row_mask:0xf bank_mask:0xf
    v_mov_b32 v3, v1
    v_mov_b32 v30, v2
    s_nop 1
    v_permlane16_swap_b32 v3, v1
    v_permlane16_swap_b32 v30, v2
    v_add_f32 v1, v1, v3
    v_add_f32 v2, v2, v30
    v_mov_b32 v3, v1
    v_mov_b32 v30, v2
    s_nop 1
    v_permlane32_swap_b32 v3, v1
    v_permlane32_swap_b32 v30, v2
    v_add_f32 v1, v1, v3
    v_add_f32 v2, v2, v30
    v_mov_b32 v3, 925353388
    v_fmac_f32 v3, 989855744, v1
    v_mov_b32 v30, 925353388
    v_fmac_f32 v30, 989855744, v2
    v_rsq_f32 v113, v3
    v_rsq_f32 v115, v30
    s_nop 0
    v_mul_f32 v112, v112, v113
    v_max_u32 v113, 1, v113
    v_sub_f32 v112, 0, v112
    v_mul_f32 v114, v114, v115
    v_max_u32 v115, 1, v115
    v_sub_f32 v114, 0, v114
    s_branch K1_P1_SPECIAL_RET
K1_SP2:
    global_load_dword v116, v29, s[72:73] sc1
    s_branch K1_P1_SPECIAL_RET
K1_SP4:
    v_readfirstlane_b32 s47, v116
    s_nop 0
    s_cmp_lg_u32 s47, 0
    s_cbranch_scc1 K1_SP4B
    global_load_dword v116, v29, s[72:73] sc1
    s_waitcnt vmcnt(0)
    s_branch K1_SP4
K1_SP4B:
    s_lshl_b32 s3, s33, 6
    s_lshl_b32 s4, s32, 4
    s_add_u32 s3, s3, s4
    v_mov_b32 v29, s3
    s_mov_b64 exec, 1
    buffer_store_dwordx2 v[112:113], v29, s[28:31], s55 offen offset:2048 sc1
    buffer_store_dwordx2 v[114:115], v29, s[28:31], s55 offen offset:2056 sc1
    s_mov_b64 exec, -1
    s_branch K1_P1_SPECIAL_RET
K1_SP6:
    v_lshlrev_b32 v30, 7, v0
    s_sub_u32 s3, s38, 6
    s_lshl_b32 s3, s3, 13
    v_add_u32 v30, s3, v30
    s_getpc_b64 s[76:77]
K1_CP5:
    s_add_u32 s76, s76, (K1_E1+(0)-K1_CP5)&0xffffffff
    s_addc_u32 s77, s77, ((K1_E1+(0)-K1_CP5)>>32)&0xffffffff
    global_load_dword v127, v30, s[76:77]
    s_cmp_eq_u32 s38, 7
    s_cbranch_scc0 K1_SP6B
    v_and_b32 v29, 31, v0
    v_lshlrev_b32 v29, 3, v29
    s_lshl_b32 s3, s32, 9
    s_add_u32 s3, s3, s55
    buffer_load_dwordx2 v[116:117], v29, s[28:31], s3 offen offset:2048 sc1
    buffer_load_dwordx2 v[118:119], v29, s[28:31], s3 offen offset:2304 sc1
K1_SP6B:
    s_mov_b32 s12, s20
    s_mov_b32 s13, s21
    s_mov_b32 s14, s22
    s_mov_b32 s15, s23
    s_mov_b32 s18, 0
    s_mov_b32 s98, 159744
    s_sub_u32 s48, s38, 6
    s_lshl_b32 s47, s48, 15
    s_add_u32 s36, s43, s47
    v_mov_b32 v104, v16
    v_mov_b32 v105, v17
    v_mov_b32 v106, v18
    v_mov_b32 v107, v19
    s_sub_u32 s35, s43, s42
    s_and_b32 s49, s32, 1
    s_lshl_b32 s49, s49, 13
    s_add_u32 s35, s35, s49
    s_cmp_lt_u32 s32, 2
    s_cbranch_scc0 K1_SPV
    s_mov_b32 s8, s20
    s_mov_b32 s9, s21
    s_mov_b32 s10, s22
    s_mov_b32 s11, s23
    s_add_u32 s35, s35, s47
    s_add_u32 s35, s35, 16384
    v_add_u32 v96, 0, v16
    v_add_u32 v97, 0, v17
    v_add_u32 v98, 0, v18
    v_add_u32 v99, 0, v19
    v_add_u32 v100, 4096, v16
    v_add_u32 v101, 4096, v17
    v_add_u32 v102, 4096, v18
    v_add_u32 v103, 4096, v19
    s_branch K1_P1_SPECIAL_RET
K1_SPV:
    s_mov_b32 s8, s24
    s_mov_b32 s9, s25
    s_mov_b32 s10, s26
    s_mov_b32 s11, s27
    s_lshl_b32 s47, s48, 14
    s_add_u32 s35, s35, s47
    v_add_u32 v96, 0, v20
    v_add_u32 v97, 0, v20
    v_add_u32 v98, 0, v20
    v_add_u32 v99, 0, v20
    v_add_u32 v100, 4096, v20
    v_add_u32 v101, 4096, v20
    v_add_u32 v102, 4096, v20
    v_add_u32 v103, 4096, v20
    s_branch K1_P1_SPECIAL_RET
K1_REDO:
    s_waitcnt vmcnt(0) lgkmcnt(0)
    s_barrier
    s_mov_b32 s57, 1
    s_mov_b32 s63, 99
    v_add_u32 v4, 81920, v4
    v_add_u32 v5, 81920, v5
    v_add_u32 v6, 81920, v6
    v_add_u32 v7, 81920, v7
    v_add_u32 v8, 81920, v8
    v_add_u32 v9, 81920, v9
    v_add_u32 v10, 81920, v10
    v_add_u32 v11, 81920, v11
    v_add_u32 v12, 4294885376, v12
    v_add_u32 v13, 4294885376, v13
    v_add_u32 v14, 4294885376, v14
    v_add_u32 v15, 4294885376, v15
    v_mov_b32 v27, 4286578688
    v_mov_b32 v28, 4286578688
    s_mov_b32 s38, 0
    s_mov_b32 s46, s43
K1_RLOOP:
    s_add_u32 m0, s42, 131072
    s_nop 0
    buffer_load_dwordx4 v16, s[20:23], s46 offen lds
    buffer_load_dwordx4 v17, s[20:23], s46 offen offset:1024 lds
    buffer_load_dwordx4 v18, s[20:23], s46 offen offset:2048 lds
    buffer_load_dwordx4 v19, s[20:23], s46 offen offset:3072 lds
    s_add_u32 s46, s46, 16384
    s_waitcnt vmcnt(0)
    s_barrier
    ds_read_b128 a[224:227], v4 offset:0
    ds_read_b128 a[228:231], v5 offset:0
    ds_read_b128 a[232:235], v6 offset:0
    ds_read_b128 a[236:239], v7 offset:0
    ds_read_b128 a[240:243], v8 offset:0
    ds_read_b128 a[244:247], v9 offset:0
    ds_read_b128 a[248:251], v10 offset:0
    ds_read_b128 a[252:255], v11 offset:0
    s_waitcnt lgkmcnt(7)
    v_mfma_f32_32x32x16_bf16 v[128:143], a[224:227], v[64:67], 0
    s_waitcnt lgkmcnt(6)
    v_mfma_f32_32x32x16_bf16 v[128:143], a[228:231], v[68:71], v[128:143]
    s_waitcnt lgkmcnt(5)
    v_mfma_f32_32x32x16_bf16 v[128:143], a[232:235], v[72:75], v[128:143]
    s_waitcnt lgkmcnt(4)
    v_mfma_f32_32x32x16_bf16 v[128:143], a[236:239], v[76:79], v[128:143]
    s_waitcnt lgkmcnt(3)
    v_mfma_f32_32x32x16_bf16 v[128:143], a[240:243], v[80:83], v[128:143]
    s_waitcnt lgkmcnt(2)
    v_mfma_f32_32x32x16_bf16 v[128:143], a[244:247], v[84:87], v[128:143]
    s_waitcnt lgkmcnt(1)
    v_mfma_f32_32x32x16_bf16 v[128:143], a[248:251], v[88:91], v[128:143]
    s_waitcnt lgkmcnt(0)
    v_mfma_f32_32x32x16_bf16 v[128:143], a[252:255], v[92:95], v[128:143]
    v_mfma_f32_32x32x16_bf16 v[144:159], a[224:227], v[96:99], 0
    v_mfma_f32_32x32x16_bf16 v[144:159], a[228:231], v[100:103], v[144:159]
    v_mfma_f32_32x32x16_bf16 v[144:159], a[232:235], v[104:107], v[144:159]
    v_mfma_f32_32x32x16_bf16 v[144:159], a[236:239], v[108:111], v[144:159]
    v_mfma_f32_32x32x16_bf16 v[144:159], a[240:243], v[112:115], v[144:159]
    v_mfma_f32_32x32x16_bf16 v[144:159], a[244:247], v[116:119], v[144:159]
    v_mfma_f32_32x32x16_bf16 v[144:159], a[248:251], v[120:123], v[144:159]
    v_mfma_f32_32x32x16_bf16 v[144:159], a[252:255], v[124:127], v[144:159]
    s_nop 15
    v_max3_f32 v27, v128, v129, v27
    v_max3_f32 v27, v130, v131, v27
    v_max3_f32 v27, v132, v133, v27
    v_max3_f32 v27, v134, v135, v27
    v_max3_f32 v27, v136, v137, v27
    v_max3_f32 v27, v138, v139, v27
    v_max3_f32 v27, v140, v141, v27
    v_max3_f32 v27, v142, v143, v27
    v_max3_f32 v28, v144, v145, v28
    v_max3_f32 v28, v146, v147, v28
    v_max3_f32 v28, v148, v149, v28
    v_max3_f32 v28, v150, v151, v28
    v_max3_f32 v28, v152, v153, v28
    v_max3_f32 v28, v154, v155, v28
    v_max3_f32 v28, v156, v157, v28
    v_max3_f32 v28, v158, v159, v28
    ds_read_b128 a[224:227], v4 offset:8192
    ds_read_b128 a[228:231], v5 offset:8192
    ds_read_b128 a[232:235], v6 offset:8192
    ds_read_b128 a[236:239], v7 offset:8192
    ds_read_b128 a[240:243], v8 offset:8192
    ds_read_b128 a[244:247], v9 offset:8192
    ds_read_b128 a[248:251], v10 offset:8192
    ds_read_b128 a[252:255], v11 offset:8192
    s_waitcnt lgkmcnt(7)
    v_mfma_f32_32x32x16_bf16 v[128:143], a[224:227], v[64:67], 0
    s_waitcnt lgkmcnt(6)
    v_mfma_f32_32x32x16_bf16 v[128:143], a[228:231], v[68:71], v[128:143]
    s_waitcnt lgkmcnt(5)
    v_mfma_f32_32x32x16_bf16 v[128:143], a[232:235], v[72:75], v[128:143]
    s_waitcnt lgkmcnt(4)
    v_mfma_f32_32x32x16_bf16 v[128:143], a[236:239], v[76:79], v[128:143]
    s_waitcnt lgkmcnt(3)
    v_mfma_f32_32x32x16_bf16 v[128:143], a[240:243], v[80:83], v[128:143]
    s_waitcnt lgkmcnt(2)
    v_mfma_f32_32x32x16_bf16 v[128:143], a[244:247], v[84:87], v[128:143]
    s_waitcnt lgkmcnt(1)
    v_mfma_f32_32x32x16_bf16 v[128:143], a[248:251], v[88:91], v[128:143]
    s_waitcnt lgkmcnt(0)
    v_mfma_f32_32x32x16_bf16 v[128:143], a[252:255], v[92:95], v[128:143]
    v_mfma_f32_32x32x16_bf16 v[144:159], a[224:227], v[96:99], 0
    v_mfma_f32_32x32x16_bf16 v[144:159], a[228:231], v[100:103], v[144:159]
    v_mfma_f32_32x32x16_bf16 v[144:159], a[232:235], v[104:107], v[144:159]
    v_mfma_f32_32x32x16_bf16 v[144:159], a[236:239], v[108:111], v[144:159]
    v_mfma_f32_32x32x16_bf16 v[144:159], a[240:243], v[112:115], v[144:159]
    v_mfma_f32_32x32x16_bf16 v[144:159], a[244:247], v[116:119], v[144:159]
    v_mfma_f32_32x32x16_bf16 v[144:159], a[248:251], v[120:123], v[144:159]
    v_mfma_f32_32x32x16_bf16 v[144:159], a[252:255], v[124:127], v[144:159]
    s_nop 15
    v_max3_f32 v27, v128, v129, v27
    v_max3_f32 v27, v130, v131, v27
    v_max3_f32 v27, v132, v133, v27
    v_max3_f32 v27, v134, v135, v27
    v_max3_f32 v27, v136, v137, v27
    v_max3_f32 v27, v138, v139, v27
    v_max3_f32 v27, v140, v141, v27
    v_max3_f32 v27, v142, v143, v27
    v_max3_f32 v28, v144, v145, v28
    v_max3_f32 v28, v146, v147, v28
    v_max3_f32 v28, v148, v149, v28
    v_max3_f32 v28, v150, v151, v28
    v_max3_f32 v28, v152, v153, v28
    v_max3_f32 v28, v154, v155, v28
    v_max3_f32 v28, v156, v157, v28
    v_max3_f32 v28, v158, v159, v28
    s_barrier
    s_add_u32 s38, s38, 1
    s_cmp_lt_u32 s38, 8
    s_cbranch_scc1 K1_RLOOP
    s_add_u32 m0, s42, 131072
    s_add_u32 s47, s43, 0
    buffer_load_dwordx4 v16, s[20:23], s47 offen lds
    buffer_load_dwordx4 v17, s[20:23], s47 offen offset:1024 lds
    buffer_load_dwordx4 v18, s[20:23], s47 offen offset:2048 lds
    buffer_load_dwordx4 v19, s[20:23], s47 offen offset:3072 lds
    s_add_u32 m0, s42, 0
    s_add_u32 s47, s43, 16384
    buffer_load_dwordx4 v16, s[20:23], s47 offen lds
    buffer_load_dwordx4 v17, s[20:23], s47 offen offset:1024 lds
    buffer_load_dwordx4 v18, s[20:23], s47 offen offset:2048 lds
    buffer_load_dwordx4 v19, s[20:23], s47 offen offset:3072 lds
    s_add_u32 m0, s42, 16384
    s_add_u32 s47, s43, 0
    buffer_load_dwordx4 v20, s[24:27], s47 offen lds
    buffer_load_dwordx4 v20, s[24:27], s47 offen offset:1024 lds
    buffer_load_dwordx4 v20, s[24:27], s47 offen offset:2048 lds
    buffer_load_dwordx4 v20, s[24:27], s47 offen offset:3072 lds
    s_add_u32 m0, s42, 65536
    s_add_u32 s47, s43, 32768
    buffer_load_dwordx4 v16, s[20:23], s47 offen lds
    buffer_load_dwordx4 v17, s[20:23], s47 offen offset:1024 lds
    buffer_load_dwordx4 v18, s[20:23], s47 offen offset:2048 lds
    buffer_load_dwordx4 v19, s[20:23], s47 offen offset:3072 lds
    s_add_u32 m0, s42, 49152
    s_add_u32 s47, s43, 16384
    buffer_load_dwordx4 v20, s[24:27], s47 offen lds
    buffer_load_dwordx4 v20, s[24:27], s47 offen offset:1024 lds
    buffer_load_dwordx4 v20, s[24:27], s47 offen offset:2048 lds
    buffer_load_dwordx4 v20, s[24:27], s47 offen offset:3072 lds
    s_add_u32 m0, s42, 32768
    s_add_u32 s47, s43, 49152
    buffer_load_dwordx4 v16, s[20:23], s47 offen lds
    buffer_load_dwordx4 v17, s[20:23], s47 offen offset:1024 lds
    buffer_load_dwordx4 v18, s[20:23], s47 offen offset:2048 lds
    buffer_load_dwordx4 v19, s[20:23], s47 offen offset:3072 lds
    s_add_u32 m0, s42, 114688
    s_add_u32 s47, s43, 32768
    buffer_load_dwordx4 v20, s[24:27], s47 offen lds
    buffer_load_dwordx4 v20, s[24:27], s47 offen offset:1024 lds
    buffer_load_dwordx4 v20, s[24:27], s47 offen offset:2048 lds
    buffer_load_dwordx4 v20, s[24:27], s47 offen offset:3072 lds
    s_add_u32 m0, s42, 98304
    s_add_u32 s47, s43, 65536
    buffer_load_dwordx4 v16, s[20:23], s47 offen lds
    buffer_load_dwordx4 v17, s[20:23], s47 offen offset:1024 lds
    buffer_load_dwordx4 v18, s[20:23], s47 offen offset:2048 lds
    buffer_load_dwordx4 v19, s[20:23], s47 offen offset:3072 lds
    s_add_u32 m0, s42, 81920
    s_add_u32 s47, s43, 49152
    buffer_load_dwordx4 v20, s[24:27], s47 offen lds
    buffer_load_dwordx4 v20, s[24:27], s47 offen offset:1024 lds
    buffer_load_dwordx4 v20, s[24:27], s47 offen offset:2048 lds
    buffer_load_dwordx4 v20, s[24:27], s47 offen offset:3072 lds
    s_waitcnt vmcnt(0)
    s_branch K1_P2_ENTRY
K1_CODE_END:

.section .rodata,"a"
.p2align 6
.amdhsa_kernel recurrent_scan__sliding_block_cached__glu_gated_glu__prompt_kernel
  .amdhsa_next_free_vgpr 512
  .amdhsa_next_free_sgpr 102
  .amdhsa_accum_offset 256
  .amdhsa_group_segment_fixed_size 0
  .amdhsa_kernarg_size 96
  .amdhsa_user_sgpr_count 2
  .amdhsa_user_sgpr_kernarg_segment_ptr 1
  .amdhsa_system_sgpr_workgroup_id_x 1
.end_amdhsa_kernel
```
